```python
import torch

def _softmax(x, axis=-1):
    return torch.softmax(x, dim=axis)
def _gelu(x):
    return torch.nn.functional.gelu(x, approximate="tanh")
def _silu(x):
    return torch.nn.functional.silu(x)
def _sigmoid(x):
    return torch.sigmoid(x)
def _layernorm(x, axis=-1, eps=1e-5):
    m = x.mean(dim=axis, keepdim=True)
    v = x.var(dim=axis, keepdim=True, unbiased=False)
    return (x - m) / torch.sqrt(v + eps)
def _scatter_add(tgt, idx, src, axis=0):
    return tgt.clone().index_add_(axis, idx, src)
def _segment_sum(src, seg, n):
    out = torch.zeros((n,) + src.shape[1:], dtype=src.dtype)
    return out.index_add_(0, seg, src)
def _pad(x, pw):
    flat = tuple(v for pair in reversed(pw) for v in pair)
    return torch.nn.functional.pad(x, flat)

kernel_name = 'parallel_sum__linear_attn_block__mixer_s_mlp__prompt'

def setup_inputs():

    _w = (lambda a: (lambda t: t.to(torch.bfloat16) if t.is_floating_point() else t)(torch.as_tensor(a)))
    def _A_setup():
        B, S, D = 1, 2048, 512
        return {
            "x": _w((lambda *s: torch.randn(*s, dtype=torch.bfloat16) * 0.05)(B, S, D)),
            "wqkv": _w((lambda *s: torch.randn(*s, dtype=torch.bfloat16) * 0.4)(D, 3 * D)),
            "wo": _w((lambda *s: torch.randn(*s, dtype=torch.bfloat16) * 0.4)(D, D)),
        }
    _A_in = _A_setup()

    def _B_setup():
        B, S, D, F = 1, 2048, 512, 1376
        return {
            "x":  _w((lambda *s: torch.randn(*s, dtype=torch.bfloat16) * 0.05)(B, S, D)),
            "w1": _w((lambda *s: torch.randn(*s, dtype=torch.bfloat16) * 3.2)(D, D) * (D ** -0.5)),
            "w2": _w((lambda *s: torch.randn(*s, dtype=torch.bfloat16) * 3.2)(D, D) * (D ** -0.5)),
            "w3": _w((lambda *s: torch.randn(*s, dtype=torch.bfloat16) * 3.2)(D, F) * (D ** -0.5)),
            "w4": _w((lambda *s: torch.randn(*s, dtype=torch.bfloat16) * 3.2)(F, D) * (F ** -0.5)),
        }
    _B_in = _B_setup()

    return {
        "A_x": _A_in["x"],
        "A_wqkv": _A_in["wqkv"],
        "A_wo": _A_in["wo"],
        "B_x": _B_in["x"],
        "B_w1": _B_in["w1"],
        "B_w2": _B_in["w2"],
        "B_w3": _B_in["w3"],
        "B_w4": _B_in["w4"],
    }

def reference(A_x, A_wqkv, A_wo, B_x, B_w1, B_w2, B_w3, B_w4):
    def _A_ref(x, wqkv, wo):
        B, S, D = x.shape
        H = 32; Dh = D // H
        qkv = (lambda x, *d: x.permute(*d))((x @ wqkv).reshape(B, S, 3, H, Dh), 2, 0, 3, 1, 4)
        q, k, v = qkv[0], qkv[1], qkv[2]
        phi = lambda t: torch.where(t > 0, t + 1, torch.exp(t)) + 1e-6
        pq, pk = phi(q), phi(k)
        kv = torch.einsum("bhsd,bhse->bhde", pk, v)
        z = torch.einsum("bhsd->bhd", pk)
        num = torch.einsum("bhqd,bhde->bhqe", pq, kv)
        den = torch.einsum("bhqd,bhd->bhq", pq, z)[..., None] + 1e-6
        o = num / den
        return (lambda x, *d: x.permute(*d))(o, 0, 2, 1, 3).reshape(B, S, D) @ wo

    def _B_ref(x, w1, w2, w3, w4):
        B, S, D = x.shape
        h = _gelu(_layernorm(x, axis=-1) @ w1)
        c = D // 4
        g0 = _pad(h[:, :, 0*c:1*c], ((0, 0), (1, 0), (0, 0)))[:, :S, :]
        g1 = _pad(h[:, :, 1*c:2*c], ((0, 0), (0, 1), (0, 0)))[:, 1:, :]
        g2 = _pad(h[:, :, 2*c:3*c], ((0, 0), (2, 0), (0, 0)))[:, :S, :]
        g3 = _pad(h[:, :, 3*c:   ], ((0, 0), (0, 2), (0, 0)))[:, 2:, :]
        hs = torch.concatenate([g0, g1, g2, g3], axis=-1) @ w2
        x1 = x + hs
        h2 = _gelu(_layernorm(x1, axis=-1) @ w3) @ w4
        return x1 + h2

    x = A_x
    xn = _layernorm(x, axis=-1)
    return x + _A_ref(xn, A_wqkv, A_wo) + _B_ref(xn, B_w1, B_w2, B_w3, B_w4)
```

```asm
; @launch grid=(256,1,1) block=(512,1,1) lds=157952
.amdgcn_target "amdgcn-amd-amdhsa--gfx950"
.text
.globl parallel_sum__linear_attn_block__mixer_s_mlp__prompt_kernel
.p2align 8
.type parallel_sum__linear_attn_block__mixer_s_mlp__prompt_kernel,@function
parallel_sum__linear_attn_block__mixer_s_mlp__prompt_kernel:
  s_cmp_ge_u32 s2, 256
  s_cbranch_scc1 parallel_sum__linear_attn_block__mixer_s_mlp__prompt_kernel_exit
  s_load_dwordx16 s[36:51], s[0:1], 0
  s_load_dwordx4 s[52:55], s[0:1], 64
  s_load_dwordx2 s[56:57], s[0:1], 80
  v_lshrrev_b32 v1, 6, v0
  v_and_b32 v0, 63, v0
  v_readfirstlane_b32 s3, v1
  s_nop 3
  s_cmp_lg_u32 s3, 4
  s_cbranch_scc1 L_cod_1
  s_lshr_b32 s4, s2, 3
  s_lshl_b32 s4, s4, 11
  v_lshl_add_u32 v2, v0, 7, s4
  s_mov_b32 exec_lo, 0xffff
  s_mov_b32 exec_hi, 0x0
  s_getpc_b64 s[6:7]
L_pc_here:
  s_sub_u32 s6, s6, L_pc_here-parallel_sum__linear_attn_block__mixer_s_mlp__prompt_kernel
  s_subb_u32 s7, s7, 0
  v_min_u32 v2, parallel_sum__linear_attn_block__mixer_s_mlp__prompt_kernel_exit-parallel_sum__linear_attn_block__mixer_s_mlp__prompt_kernel, v2
  global_load_dword v248, v2, s[6:7]
  s_mov_b64 exec, -1
L_cod_1:
  s_and_b32 s4, s2, 7
  s_lshr_b32 s5, s2, 3
  s_lshr_b32 s6, s4, 1
  s_lshl_b32 s6, s6, 2
  s_and_b32 s7, s5, 3
  s_add_u32 s32, s6, s7
  s_lshr_b32 s5, s5, 2
  s_and_b32 s6, s4, 1
  s_lshl_b32 s6, s6, 2
  s_and_b32 s33, s5, 3
  s_add_u32 s33, s33, s6
  s_lshr_b32 s94, s5, 2
  s_lshl_b32 s7, s7, 1
  s_add_u32 s7, s7, s5
  s_and_b32 s58, s7, 7
  s_cmp_lt_u32 s3, 4
  s_cbranch_scc1 cons
  s_sub_u32 s71, s3, 4
  s_lshl_b32 s87, s71, 12
  s_lshl_b32 s95, s71, 11
  s_lshl_b32 s78, s32, 7
  s_mov_b32 s79, 1024
  s_mov_b32 s80, 32
  s_mov_b32 s85, 128
  v_lshrrev_b32 v5, 4, v0
  v_and_b32 v2, 7, v0
  v_xor_b32 v2, v2, v5
  v_lshrrev_b32 v3, 1, v2
  v_xor_b32 v4, 2, v3
  v_mul_u32_u24 v3, s80, v3
  v_mul_u32_u24 v4, s80, v4
  v_and_b32 v2, 1, v2
  v_lshlrev_b32 v2, 4, v2
  v_add_u32 v3, v3, v2
  v_add_u32 v4, v4, v2
  s_lshl_b32 s62, s71, 5
  s_add_u32 s62, s62, s78
  v_lshrrev_b32 v2, 3, v0
  v_add_u32 v2, s62, v2
  v_mul_u32_u24 v2, s79, v2
  s_lshl_b32 s62, s79, 3
  s_lshl_b32 s63, s79, 4
  v_add_u32 v8, v2, v3
  v_add3_u32 v9, v2, v4, s62
  v_add_u32 v10, s63, v8
  v_add_u32 v11, s63, v9
  s_cmp_eq_u32 s94, 1
  s_cbranch_scc1 p_mixer
  s_mov_b32 s81, 3072
  s_mov_b32 s83, 32
  s_mov_b32 s84, 1024
  s_lshl_b32 s82, s33, 7
  s_add_u32 s82, s82, 1024
  v_lshrrev_b32 v5, 4, v0
  v_bfe_u32 v2, v0, 1, 3
  v_xor_b32 v2, v2, v5
  v_lshrrev_b32 v3, 1, v2
  v_xor_b32 v4, 2, v3
  v_mul_u32_u24 v3, s83, v3
  v_mul_u32_u24 v4, s83, v4
  v_and_b32 v2, 1, v2
  v_mul_u32_u24 v2, s84, v2
  v_and_b32 v12, 1, v0
  v_lshl_add_u32 v2, v12, 4, v2
  v_add3_u32 v3, v3, v2, s82
  v_add3_u32 v4, v4, v2, s82
  s_lshl_b32 s62, s71, 4
  v_add_u32 v2, s62, v5
  v_mul_u32_u24 v2, s81, v2
  s_lshl_b32 s62, s81, 2
  s_lshl_b32 s63, s81, 3
  v_add_u32 v12, v2, v3
  v_add_u32 v13, s62, v12
  v_add3_u32 v14, v2, v4, s63
  v_add_u32 v15, s62, v14
  s_lshl_b32 s86, s81, 6
  s_waitcnt lgkmcnt(0)
  s_mov_b32 s8, s36
  s_mov_b32 s9, s37
  s_mov_b32 s10, 0x200000
  s_mov_b32 s11, 0x00020000
  s_mov_b32 s12, s38
  s_mov_b32 s13, s39
  s_mov_b32 s14, 0x180000
  s_mov_b32 s15, 0x00020000
  s_add_u32 s59, s58, 0
  s_and_b32 s59, s59, 7
  s_mul_i32 s60, s59, s85
  s_add_u32 m0, s87, 0x0
  s_nop 0
  buffer_load_dwordx4 v8, s[8:11], s60 offen lds
  s_add_u32 m0, s87, 0x400
  s_nop 0
  buffer_load_dwordx4 v9, s[8:11], s60 offen lds
  s_add_u32 m0, s87, 0x800
  s_nop 0
  buffer_load_dwordx4 v10, s[8:11], s60 offen lds
  s_add_u32 m0, s87, 0xc00
  s_nop 0
  buffer_load_dwordx4 v11, s[8:11], s60 offen lds
  s_add_u32 s59, s58, 0
  s_and_b32 s59, s59, 7
  s_mul_i32 s61, s59, s86
  s_add_u32 m0, s87, 0x4000
  s_nop 0
  buffer_load_dwordx4 v12, s[12:15], s61 offen lds
  s_add_u32 m0, s87, 0x4400
  s_nop 0
  buffer_load_dwordx4 v13, s[12:15], s61 offen lds
  s_add_u32 m0, s87, 0x4800
  s_nop 0
  buffer_load_dwordx4 v14, s[12:15], s61 offen lds
  s_add_u32 m0, s87, 0x4c00
  s_nop 0
  buffer_load_dwordx4 v15, s[12:15], s61 offen lds
  s_add_u32 s59, s58, 1
  s_and_b32 s59, s59, 7
  s_mul_i32 s60, s59, s85
  s_add_u32 m0, s87, 0x8000
  s_nop 0
  buffer_load_dwordx4 v8, s[8:11], s60 offen lds
  s_add_u32 m0, s87, 0x8400
  s_nop 0
  buffer_load_dwordx4 v9, s[8:11], s60 offen lds
  s_add_u32 m0, s87, 0x8800
  s_nop 0
  buffer_load_dwordx4 v10, s[8:11], s60 offen lds
  s_add_u32 m0, s87, 0x8c00
  s_nop 0
  buffer_load_dwordx4 v11, s[8:11], s60 offen lds
  s_add_u32 s59, s58, 1
  s_and_b32 s59, s59, 7
  s_mul_i32 s61, s59, s86
  s_add_u32 m0, s87, 0xc000
  s_nop 0
  buffer_load_dwordx4 v12, s[12:15], s61 offen lds
  s_add_u32 m0, s87, 0xc400
  s_nop 0
  buffer_load_dwordx4 v13, s[12:15], s61 offen lds
  s_add_u32 m0, s87, 0xc800
  s_nop 0
  buffer_load_dwordx4 v14, s[12:15], s61 offen lds
  s_add_u32 m0, s87, 0xcc00
  s_nop 0
  buffer_load_dwordx4 v15, s[12:15], s61 offen lds
  s_add_u32 s59, s58, 2
  s_and_b32 s59, s59, 7
  s_mul_i32 s60, s59, s85
  s_add_u32 m0, s87, 0x10000
  s_nop 0
  buffer_load_dwordx4 v8, s[8:11], s60 offen lds
  s_add_u32 m0, s87, 0x10400
  s_nop 0
  buffer_load_dwordx4 v9, s[8:11], s60 offen lds
  s_add_u32 m0, s87, 0x10800
  s_nop 0
  buffer_load_dwordx4 v10, s[8:11], s60 offen lds
  s_add_u32 m0, s87, 0x10c00
  s_nop 0
  buffer_load_dwordx4 v11, s[8:11], s60 offen lds
  s_add_u32 s59, s58, 2
  s_and_b32 s59, s59, 7
  s_mul_i32 s61, s59, s86
  s_add_u32 m0, s87, 0x14000
  s_nop 0
  buffer_load_dwordx4 v12, s[12:15], s61 offen lds
  s_add_u32 m0, s87, 0x14400
  s_nop 0
  buffer_load_dwordx4 v13, s[12:15], s61 offen lds
  s_add_u32 m0, s87, 0x14800
  s_nop 0
  buffer_load_dwordx4 v14, s[12:15], s61 offen lds
  s_add_u32 m0, s87, 0x14c00
  s_nop 0
  buffer_load_dwordx4 v15, s[12:15], s61 offen lds
  s_waitcnt vmcnt(16)
  s_barrier
  s_add_u32 s59, s58, 3
  s_and_b32 s59, s59, 7
  s_mul_i32 s60, s59, s85
  s_add_u32 m0, s87, 0x18000
  s_nop 0
  buffer_load_dwordx4 v8, s[8:11], s60 offen lds
  s_add_u32 m0, s87, 0x18400
  s_nop 0
  buffer_load_dwordx4 v9, s[8:11], s60 offen lds
  s_add_u32 m0, s87, 0x18800
  s_nop 0
  buffer_load_dwordx4 v10, s[8:11], s60 offen lds
  s_add_u32 m0, s87, 0x18c00
  s_nop 0
  buffer_load_dwordx4 v11, s[8:11], s60 offen lds
  s_add_u32 s59, s58, 3
  s_and_b32 s59, s59, 7
  s_mul_i32 s61, s59, s86
  s_add_u32 m0, s87, 0x1c000
  s_nop 0
  buffer_load_dwordx4 v12, s[12:15], s61 offen lds
  s_add_u32 m0, s87, 0x1c400
  s_nop 0
  buffer_load_dwordx4 v13, s[12:15], s61 offen lds
  s_add_u32 m0, s87, 0x1c800
  s_nop 0
  buffer_load_dwordx4 v14, s[12:15], s61 offen lds
  s_add_u32 m0, s87, 0x1cc00
  s_nop 0
  buffer_load_dwordx4 v15, s[12:15], s61 offen lds
  s_waitcnt vmcnt(16)
  s_barrier
  s_add_u32 s59, s58, 4
  s_and_b32 s59, s59, 7
  s_mul_i32 s60, s59, s85
  s_add_u32 m0, s87, 0x0
  s_nop 0
  buffer_load_dwordx4 v8, s[8:11], s60 offen lds
  s_add_u32 m0, s87, 0x400
  s_nop 0
  buffer_load_dwordx4 v9, s[8:11], s60 offen lds
  s_add_u32 m0, s87, 0x800
  s_nop 0
  buffer_load_dwordx4 v10, s[8:11], s60 offen lds
  s_add_u32 m0, s87, 0xc00
  s_nop 0
  buffer_load_dwordx4 v11, s[8:11], s60 offen lds
  s_add_u32 s59, s58, 4
  s_and_b32 s59, s59, 7
  s_mul_i32 s61, s59, s86
  s_add_u32 m0, s87, 0x4000
  s_nop 0
  buffer_load_dwordx4 v12, s[12:15], s61 offen lds
  s_add_u32 m0, s87, 0x4400
  s_nop 0
  buffer_load_dwordx4 v13, s[12:15], s61 offen lds
  s_add_u32 m0, s87, 0x4800
  s_nop 0
  buffer_load_dwordx4 v14, s[12:15], s61 offen lds
  s_add_u32 m0, s87, 0x4c00
  s_nop 0
  buffer_load_dwordx4 v15, s[12:15], s61 offen lds
  s_waitcnt vmcnt(16)
  s_barrier
  s_add_u32 s59, s58, 5
  s_and_b32 s59, s59, 7
  s_mul_i32 s60, s59, s85
  s_add_u32 m0, s87, 0x8000
  s_nop 0
  buffer_load_dwordx4 v8, s[8:11], s60 offen lds
  s_add_u32 m0, s87, 0x8400
  s_nop 0
  buffer_load_dwordx4 v9, s[8:11], s60 offen lds
  s_add_u32 m0, s87, 0x8800
  s_nop 0
  buffer_load_dwordx4 v10, s[8:11], s60 offen lds
  s_add_u32 m0, s87, 0x8c00
  s_nop 0
  buffer_load_dwordx4 v11, s[8:11], s60 offen lds
  s_add_u32 s59, s58, 5
  s_and_b32 s59, s59, 7
  s_mul_i32 s61, s59, s86
  s_add_u32 m0, s87, 0xc000
  s_nop 0
  buffer_load_dwordx4 v12, s[12:15], s61 offen lds
  s_add_u32 m0, s87, 0xc400
  s_nop 0
  buffer_load_dwordx4 v13, s[12:15], s61 offen lds
  s_add_u32 m0, s87, 0xc800
  s_nop 0
  buffer_load_dwordx4 v14, s[12:15], s61 offen lds
  s_add_u32 m0, s87, 0xcc00
  s_nop 0
  buffer_load_dwordx4 v15, s[12:15], s61 offen lds
  s_and_b32 s4, s32, 3
  s_lshl_b32 s4, s4, 2
  s_add_u32 s4, s4, s71
  s_lshl_b32 s4, s4, 5
  v_lshrrev_b32 v48, 3, v0
  v_add_u32 v48, s4, v48
  v_mul_u32_u24 v48, s81, v48
  v_and_b32 v49, 7, v0
  v_lshl_add_u32 v48, v49, 4, v48
  s_lshl_b32 s4, s33, 7
  v_add_u32 v48, s4, v48
  s_mov_b32 s4, 0
  buffer_load_dwordx4 v[52:55], v48, s[12:15], s4 offen
  s_mov_b32 s4, 24576
  buffer_load_dwordx4 v[56:59], v48, s[12:15], s4 offen
  s_mov_b32 s4, 49152
  buffer_load_dwordx4 v[60:63], v48, s[12:15], s4 offen
  s_mov_b32 s4, 73728
  buffer_load_dwordx4 v[64:67], v48, s[12:15], s4 offen
  s_waitcnt vmcnt(20)
  s_barrier
  s_add_u32 s59, s58, 6
  s_and_b32 s59, s59, 7
  s_mul_i32 s60, s59, s85
  s_add_u32 m0, s87, 0x10000
  s_nop 0
  buffer_load_dwordx4 v8, s[8:11], s60 offen lds
  s_add_u32 m0, s87, 0x10400
  s_nop 0
  buffer_load_dwordx4 v9, s[8:11], s60 offen lds
  s_add_u32 m0, s87, 0x10800
  s_nop 0
  buffer_load_dwordx4 v10, s[8:11], s60 offen lds
  s_add_u32 m0, s87, 0x10c00
  s_nop 0
  buffer_load_dwordx4 v11, s[8:11], s60 offen lds
  s_add_u32 s59, s58, 6
  s_and_b32 s59, s59, 7
  s_mul_i32 s61, s59, s86
  s_add_u32 m0, s87, 0x14000
  s_nop 0
  buffer_load_dwordx4 v12, s[12:15], s61 offen lds
  s_add_u32 m0, s87, 0x14400
  s_nop 0
  buffer_load_dwordx4 v13, s[12:15], s61 offen lds
  s_add_u32 m0, s87, 0x14800
  s_nop 0
  buffer_load_dwordx4 v14, s[12:15], s61 offen lds
  s_add_u32 m0, s87, 0x14c00
  s_nop 0
  buffer_load_dwordx4 v15, s[12:15], s61 offen lds
  s_waitcnt vmcnt(20)
  s_barrier
  s_add_u32 s59, s58, 7
  s_and_b32 s59, s59, 7
  s_mul_i32 s60, s59, s85
  s_add_u32 m0, s87, 0x18000
  s_nop 0
  buffer_load_dwordx4 v8, s[8:11], s60 offen lds
  s_add_u32 m0, s87, 0x18400
  s_nop 0
  buffer_load_dwordx4 v9, s[8:11], s60 offen lds
  s_add_u32 m0, s87, 0x18800
  s_nop 0
  buffer_load_dwordx4 v10, s[8:11], s60 offen lds
  s_add_u32 m0, s87, 0x18c00
  s_nop 0
  buffer_load_dwordx4 v11, s[8:11], s60 offen lds
  s_add_u32 s59, s58, 7
  s_and_b32 s59, s59, 7
  s_mul_i32 s61, s59, s86
  s_add_u32 m0, s87, 0x1c000
  s_nop 0
  buffer_load_dwordx4 v12, s[12:15], s61 offen lds
  s_add_u32 m0, s87, 0x1c400
  s_nop 0
  buffer_load_dwordx4 v13, s[12:15], s61 offen lds
  s_add_u32 m0, s87, 0x1c800
  s_nop 0
  buffer_load_dwordx4 v14, s[12:15], s61 offen lds
  s_add_u32 m0, s87, 0x1cc00
  s_nop 0
  buffer_load_dwordx4 v15, s[12:15], s61 offen lds
  s_mov_b32 s16, s54
  s_mov_b32 s17, s55
  s_mov_b32 s18, 0x100
  s_mov_b32 s19, 0x00020000
  v_mov_b32 v2, 0
  buffer_load_dword v44, v2, s[16:19], 0 offen sc1
  s_mov_b32 s16, s46
  s_mov_b32 s17, s47
  s_mov_b32 s18, 0x80000
  s_mov_b32 s19, 0x00020000
  s_mov_b32 s24, s48
  s_mov_b32 s25, s49
  s_mov_b32 s26, 0x158000
  s_mov_b32 s27, 0x00020000
  s_lshl_b32 s4, s2, 2
  s_add_u32 s4, s4, s71
  s_lshl_b32 s4, s4, 10
  v_lshl_add_u32 v16, v0, 4, s4
  v_add_u32 v17, 0x100000, v16
  s_mov_b32 s20, s40
  s_mov_b32 s21, s41
  s_mov_b32 s22, 0x80000
  s_mov_b32 s23, 0x00020000
  s_mov_b32 s28, s50
  s_mov_b32 s29, s51
  s_mov_b32 s30, 0x158000
  s_mov_b32 s31, 0x00020000
  v_add_u32 v18, 0xfff80000, v16
  buffer_load_dwordx4 v[20:23], v16, s[16:19], 0 offen
  buffer_load_dwordx4 v[28:31], v16, s[24:27], 0 offen
  buffer_load_dwordx4 v[32:35], v17, s[24:27], 0 offen
  buffer_load_dwordx4 v[24:27], v18, s[20:23], 0 offen
  buffer_load_dwordx4 v[36:39], v16, s[28:31], 0 offen
  buffer_load_dwordx4 v[40:43], v17, s[28:31], 0 offen
  s_waitcnt vmcnt(27)
  s_barrier
  s_waitcnt vmcnt(15)
  s_barrier
  s_waitcnt vmcnt(7)
  s_barrier
  s_barrier
  s_waitcnt vmcnt(6)
  v_readfirstlane_b32 s4, v44
  s_cmp_lg_u32 s4, 0
  s_cbranch_scc1 L_ini_2
  s_mov_b32 s28, s54
  s_mov_b32 s29, s55
  s_mov_b32 s30, 0x100
  s_mov_b32 s31, 0x00020000
  v_mov_b32 v2, 0
  v_mov_b32 v3, 1
  s_mov_b32 s88, 0
L_poll_3:
  buffer_load_dword v4, v2, s[28:31], 0 offen sc1
  s_waitcnt vmcnt(0)
  v_cmp_lt_u32 vcc, v4, v3
  s_add_u32 s88, s88, 1
  s_cmp_ge_u32 s88, 200000
  s_cbranch_scc1 L_polled_4
  s_cbranch_vccz L_polled_4
  s_sleep 1
  s_branch L_poll_3
L_polled_4:
L_ini_2:
  s_barrier
  s_lshl_b32 s82, s33, 7
  v_bfe_u32 v3, v0, 4, 1
  v_bfe_u32 v4, v0, 1, 2
  v_xor_b32 v3, v3, v4
  v_lshlrev_b32 v3, 5, v3
  v_and_b32 v4, 1, v0
  v_lshl_add_u32 v3, v4, 4, v3
  v_xor_b32 v4, 64, v3
  s_lshl_b32 s62, s71, 4
  v_lshrrev_b32 v2, 3, v0
  v_add_u32 v2, s62, v2
  v_mul_u32_u24 v2, s81, v2
  v_add_u32 v2, s82, v2
  v_add_u32 v12, v2, v3
  s_lshl_b32 s62, s81, 3
  v_add3_u32 v13, v2, v4, s62
  s_mul_i32 s60, s85, 0
  s_add_u32 m0, s87, 0x0
  s_nop 0
  buffer_load_dwordx4 v8, s[8:11], s60 offen lds
  s_add_u32 m0, s87, 0x400
  s_nop 0
  buffer_load_dwordx4 v9, s[8:11], s60 offen lds
  s_add_u32 m0, s87, 0x800
  s_nop 0
  buffer_load_dwordx4 v10, s[8:11], s60 offen lds
  s_add_u32 m0, s87, 0xc00
  s_nop 0
  buffer_load_dwordx4 v11, s[8:11], s60 offen lds
  s_mul_i32 s61, s86, 0
  s_add_u32 m0, s95, 0x4000
  s_nop 0
  buffer_load_dwordx4 v12, s[12:15], s61 offen lds
  s_add_u32 m0, s95, 0x4400
  s_nop 0
  buffer_load_dwordx4 v13, s[12:15], s61 offen lds
  s_mul_i32 s60, s85, 1
  s_add_u32 m0, s87, 0x8000
  s_nop 0
  buffer_load_dwordx4 v8, s[8:11], s60 offen lds
  s_add_u32 m0, s87, 0x8400
  s_nop 0
  buffer_load_dwordx4 v9, s[8:11], s60 offen lds
  s_add_u32 m0, s87, 0x8800
  s_nop 0
  buffer_load_dwordx4 v10, s[8:11], s60 offen lds
  s_add_u32 m0, s87, 0x8c00
  s_nop 0
  buffer_load_dwordx4 v11, s[8:11], s60 offen lds
  s_mul_i32 s61, s86, 1
  s_add_u32 m0, s95, 0xc000
  s_nop 0
  buffer_load_dwordx4 v12, s[12:15], s61 offen lds
  s_add_u32 m0, s95, 0xc400
  s_nop 0
  buffer_load_dwordx4 v13, s[12:15], s61 offen lds
  s_mul_i32 s60, s85, 2
  s_add_u32 m0, s87, 0x10000
  s_nop 0
  buffer_load_dwordx4 v8, s[8:11], s60 offen lds
  s_add_u32 m0, s87, 0x10400
  s_nop 0
  buffer_load_dwordx4 v9, s[8:11], s60 offen lds
  s_add_u32 m0, s87, 0x10800
  s_nop 0
  buffer_load_dwordx4 v10, s[8:11], s60 offen lds
  s_add_u32 m0, s87, 0x10c00
  s_nop 0
  buffer_load_dwordx4 v11, s[8:11], s60 offen lds
  s_mul_i32 s61, s86, 2
  s_add_u32 m0, s95, 0x14000
  s_nop 0
  buffer_load_dwordx4 v12, s[12:15], s61 offen lds
  s_add_u32 m0, s95, 0x14400
  s_nop 0
  buffer_load_dwordx4 v13, s[12:15], s61 offen lds
  s_mul_i32 s60, s85, 3
  s_add_u32 m0, s87, 0x18000
  s_nop 0
  buffer_load_dwordx4 v8, s[8:11], s60 offen lds
  s_add_u32 m0, s87, 0x18400
  s_nop 0
  buffer_load_dwordx4 v9, s[8:11], s60 offen lds
  s_add_u32 m0, s87, 0x18800
  s_nop 0
  buffer_load_dwordx4 v10, s[8:11], s60 offen lds
  s_add_u32 m0, s87, 0x18c00
  s_nop 0
  buffer_load_dwordx4 v11, s[8:11], s60 offen lds
  s_mul_i32 s61, s86, 3
  s_add_u32 m0, s95, 0x1c000
  s_nop 0
  buffer_load_dwordx4 v12, s[12:15], s61 offen lds
  s_add_u32 m0, s95, 0x1c400
  s_nop 0
  buffer_load_dwordx4 v13, s[12:15], s61 offen lds
  s_barrier
  s_waitcnt vmcnt(18)
  s_barrier
  s_waitcnt vmcnt(12)
  s_barrier
  s_mul_i32 s60, s85, 4
  s_add_u32 m0, s87, 0x0
  s_nop 0
  buffer_load_dwordx4 v8, s[8:11], s60 offen lds
  s_add_u32 m0, s87, 0x400
  s_nop 0
  buffer_load_dwordx4 v9, s[8:11], s60 offen lds
  s_add_u32 m0, s87, 0x800
  s_nop 0
  buffer_load_dwordx4 v10, s[8:11], s60 offen lds
  s_add_u32 m0, s87, 0xc00
  s_nop 0
  buffer_load_dwordx4 v11, s[8:11], s60 offen lds
  s_mul_i32 s61, s86, 4
  s_add_u32 m0, s95, 0x6000
  s_nop 0
  buffer_load_dwordx4 v12, s[12:15], s61 offen lds
  s_add_u32 m0, s95, 0x6400
  s_nop 0
  buffer_load_dwordx4 v13, s[12:15], s61 offen lds
  s_waitcnt vmcnt(12)
  s_barrier
  s_mul_i32 s60, s85, 5
  s_add_u32 m0, s87, 0x8000
  s_nop 0
  buffer_load_dwordx4 v8, s[8:11], s60 offen lds
  s_add_u32 m0, s87, 0x8400
  s_nop 0
  buffer_load_dwordx4 v9, s[8:11], s60 offen lds
  s_add_u32 m0, s87, 0x8800
  s_nop 0
  buffer_load_dwordx4 v10, s[8:11], s60 offen lds
  s_add_u32 m0, s87, 0x8c00
  s_nop 0
  buffer_load_dwordx4 v11, s[8:11], s60 offen lds
  s_mul_i32 s61, s86, 5
  s_add_u32 m0, s95, 0xe000
  s_nop 0
  buffer_load_dwordx4 v12, s[12:15], s61 offen lds
  s_add_u32 m0, s95, 0xe400
  s_nop 0
  buffer_load_dwordx4 v13, s[12:15], s61 offen lds
  s_waitcnt vmcnt(12)
  s_barrier
  s_mul_i32 s60, s85, 6
  s_add_u32 m0, s87, 0x10000
  s_nop 0
  buffer_load_dwordx4 v8, s[8:11], s60 offen lds
  s_add_u32 m0, s87, 0x10400
  s_nop 0
  buffer_load_dwordx4 v9, s[8:11], s60 offen lds
  s_add_u32 m0, s87, 0x10800
  s_nop 0
  buffer_load_dwordx4 v10, s[8:11], s60 offen lds
  s_add_u32 m0, s87, 0x10c00
  s_nop 0
  buffer_load_dwordx4 v11, s[8:11], s60 offen lds
  s_mul_i32 s61, s86, 6
  s_add_u32 m0, s95, 0x16000
  s_nop 0
  buffer_load_dwordx4 v12, s[12:15], s61 offen lds
  s_add_u32 m0, s95, 0x16400
  s_nop 0
  buffer_load_dwordx4 v13, s[12:15], s61 offen lds
  s_waitcnt vmcnt(12)
  s_barrier
  s_mul_i32 s60, s85, 7
  s_add_u32 m0, s87, 0x18000
  s_nop 0
  buffer_load_dwordx4 v8, s[8:11], s60 offen lds
  s_add_u32 m0, s87, 0x18400
  s_nop 0
  buffer_load_dwordx4 v9, s[8:11], s60 offen lds
  s_add_u32 m0, s87, 0x18800
  s_nop 0
  buffer_load_dwordx4 v10, s[8:11], s60 offen lds
  s_add_u32 m0, s87, 0x18c00
  s_nop 0
  buffer_load_dwordx4 v11, s[8:11], s60 offen lds
  s_mul_i32 s61, s86, 7
  s_add_u32 m0, s95, 0x1e000
  s_nop 0
  buffer_load_dwordx4 v12, s[12:15], s61 offen lds
  s_add_u32 m0, s95, 0x1e400
  s_nop 0
  buffer_load_dwordx4 v13, s[12:15], s61 offen lds
  s_mov_b32 s28, s56
  s_mov_b32 s29, s57
  s_mov_b32 s30, 0x5800
  s_mov_b32 s31, 0x00020000
  s_add_u32 s4, s33, 32
  s_lshl_b32 s4, s4, 8
  v_mov_b32 v2, s4
  buffer_load_dword v46, v2, s[28:31], 0 offen sc1
  s_waitcnt vmcnt(13)
  s_barrier
  s_waitcnt vmcnt(7)
  s_barrier
  s_waitcnt vmcnt(1)
  s_waitcnt vmcnt(0)
  v_cmp_gt_u32 vcc, 16, v46
  s_mov_b32 s90, 0
  s_nop 0
  s_cbranch_vccnz lq_late
  s_add_u32 s16, s56, 0x40000
  s_addc_u32 s17, s57, 0
  s_mov_b32 s18, 0x88000
  s_mov_b32 s19, 0x00020000
  s_lshl_b32 s6, s33, 2
  s_add_u32 s6, s6, s71
  s_mul_i32 s89, s6, 1088
  v_and_b32 v2, 15, v0
  v_lshrrev_b32 v3, 4, v0
  v_lshlrev_b32 v2, 6, v2
  v_lshl_add_u32 v2, v3, 4, v2
  v_lshrrev_b32 v4, 2, v0
  v_mul_u32_u24 v4, 34816, v4
  v_and_b32 v5, 3, v0
  v_lshl_add_u32 v4, v5, 4, v4
  v_add_u32 v4, 1024, v4
  buffer_load_dwordx4 v[112:115], v4, s[16:19], s89 offen sc1
  s_add_u32 s4, s89, 0
  buffer_load_dwordx4 v[48:51], v2, s[16:19], s4 offen sc1
  s_add_u32 s4, s89, 34816
  buffer_load_dwordx4 v[52:55], v2, s[16:19], s4 offen sc1
  s_add_u32 s4, s89, 69632
  buffer_load_dwordx4 v[56:59], v2, s[16:19], s4 offen sc1
  s_add_u32 s4, s89, 104448
  buffer_load_dwordx4 v[60:63], v2, s[16:19], s4 offen sc1
  s_add_u32 s4, s89, 139264
  buffer_load_dwordx4 v[64:67], v2, s[16:19], s4 offen sc1
  s_add_u32 s4, s89, 174080
  buffer_load_dwordx4 v[68:71], v2, s[16:19], s4 offen sc1
  s_add_u32 s4, s89, 208896
  buffer_load_dwordx4 v[72:75], v2, s[16:19], s4 offen sc1
  s_add_u32 s4, s89, 243712
  buffer_load_dwordx4 v[76:79], v2, s[16:19], s4 offen sc1
  s_add_u32 s4, s89, 278528
  buffer_load_dwordx4 v[80:83], v2, s[16:19], s4 offen sc1
  s_add_u32 s4, s89, 313344
  buffer_load_dwordx4 v[84:87], v2, s[16:19], s4 offen sc1
  s_add_u32 s4, s89, 348160
  buffer_load_dwordx4 v[88:91], v2, s[16:19], s4 offen sc1
  s_add_u32 s4, s89, 382976
  buffer_load_dwordx4 v[92:95], v2, s[16:19], s4 offen sc1
  s_add_u32 s4, s89, 417792
  buffer_load_dwordx4 v[96:99], v2, s[16:19], s4 offen sc1
  s_add_u32 s4, s89, 452608
  buffer_load_dwordx4 v[100:103], v2, s[16:19], s4 offen sc1
  s_add_u32 s4, s89, 487424
  buffer_load_dwordx4 v[104:107], v2, s[16:19], s4 offen sc1
  s_add_u32 s4, s89, 522240
  buffer_load_dwordx4 v[108:111], v2, s[16:19], s4 offen sc1
  s_mov_b32 s90, 1
lq_late:
  s_barrier
  s_barrier
  s_cmp_eq_u32 s90, 1
  s_cbranch_scc1 lq_have
  s_add_u32 s5, s33, 32
  s_lshl_b32 s89, s5, 8
  s_mov_b32 s28, s56
  s_mov_b32 s29, s57
  s_mov_b32 s30, 0x5800
  s_mov_b32 s31, 0x00020000
  v_mov_b32 v2, s89
  v_mov_b32 v3, 16
  s_mov_b32 s88, 0
L_poll_5:
  buffer_load_dword v4, v2, s[28:31], 0 offen sc1
  s_waitcnt vmcnt(0)
  v_cmp_lt_u32 vcc, v4, v3
  s_add_u32 s88, s88, 1
  s_cmp_ge_u32 s88, 200000
  s_cbranch_scc1 L_polled_6
  s_cbranch_vccz L_polled_6
  s_sleep 1
  s_branch L_poll_5
L_polled_6:
  s_add_u32 s16, s56, 0x40000
  s_addc_u32 s17, s57, 0
  s_mov_b32 s18, 0x88000
  s_mov_b32 s19, 0x00020000
  s_lshl_b32 s6, s33, 2
  s_add_u32 s6, s6, s71
  s_mul_i32 s89, s6, 1088
  v_and_b32 v2, 15, v0
  v_lshrrev_b32 v3, 4, v0
  v_lshlrev_b32 v2, 6, v2
  v_lshl_add_u32 v2, v3, 4, v2
  v_lshrrev_b32 v4, 2, v0
  v_mul_u32_u24 v4, 34816, v4
  v_and_b32 v5, 3, v0
  v_lshl_add_u32 v4, v5, 4, v4
  v_add_u32 v4, 1024, v4
  buffer_load_dwordx4 v[112:115], v4, s[16:19], s89 offen sc1
  s_add_u32 s4, s89, 0
  buffer_load_dwordx4 v[48:51], v2, s[16:19], s4 offen sc1
  s_add_u32 s4, s89, 34816
  buffer_load_dwordx4 v[52:55], v2, s[16:19], s4 offen sc1
  s_add_u32 s4, s89, 69632
  buffer_load_dwordx4 v[56:59], v2, s[16:19], s4 offen sc1
  s_add_u32 s4, s89, 104448
  buffer_load_dwordx4 v[60:63], v2, s[16:19], s4 offen sc1
  s_add_u32 s4, s89, 139264
  buffer_load_dwordx4 v[64:67], v2, s[16:19], s4 offen sc1
  s_add_u32 s4, s89, 174080
  buffer_load_dwordx4 v[68:71], v2, s[16:19], s4 offen sc1
  s_add_u32 s4, s89, 208896
  buffer_load_dwordx4 v[72:75], v2, s[16:19], s4 offen sc1
  s_add_u32 s4, s89, 243712
  buffer_load_dwordx4 v[76:79], v2, s[16:19], s4 offen sc1
  s_add_u32 s4, s89, 278528
  buffer_load_dwordx4 v[80:83], v2, s[16:19], s4 offen sc1
  s_add_u32 s4, s89, 313344
  buffer_load_dwordx4 v[84:87], v2, s[16:19], s4 offen sc1
  s_add_u32 s4, s89, 348160
  buffer_load_dwordx4 v[88:91], v2, s[16:19], s4 offen sc1
  s_add_u32 s4, s89, 382976
  buffer_load_dwordx4 v[92:95], v2, s[16:19], s4 offen sc1
  s_add_u32 s4, s89, 417792
  buffer_load_dwordx4 v[96:99], v2, s[16:19], s4 offen sc1
  s_add_u32 s4, s89, 452608
  buffer_load_dwordx4 v[100:103], v2, s[16:19], s4 offen sc1
  s_add_u32 s4, s89, 487424
  buffer_load_dwordx4 v[104:107], v2, s[16:19], s4 offen sc1
  s_add_u32 s4, s89, 522240
  buffer_load_dwordx4 v[108:111], v2, s[16:19], s4 offen sc1
lq_have:
  s_waitcnt vmcnt(16)
  v_add_f32_dpp v112, v112, v112 row_ror:8 row_mask:0xf bank_mask:0xf
  v_add_f32_dpp v113, v113, v113 row_ror:8 row_mask:0xf bank_mask:0xf
  v_add_f32_dpp v114, v114, v114 row_ror:8 row_mask:0xf bank_mask:0xf
  v_add_f32_dpp v115, v115, v115 row_ror:8 row_mask:0xf bank_mask:0xf
  s_nop 1
  v_add_f32_dpp v112, v112, v112 row_ror:4 row_mask:0xf bank_mask:0xf
  v_add_f32_dpp v113, v113, v113 row_ror:4 row_mask:0xf bank_mask:0xf
  v_add_f32_dpp v114, v114, v114 row_ror:4 row_mask:0xf bank_mask:0xf
  v_add_f32_dpp v115, v115, v115 row_ror:4 row_mask:0xf bank_mask:0xf
  s_nop 1
  v_mov_b32 v116, v112
  v_mov_b32 v117, v113
  v_mov_b32 v118, v114
  v_mov_b32 v119, v115
  s_nop 1
  v_permlane32_swap_b32 v116, v112
  v_permlane32_swap_b32 v117, v113
  v_permlane32_swap_b32 v118, v114
  v_permlane32_swap_b32 v119, v115
  s_nop 1
  v_add_f32 v112, v112, v116
  v_add_f32 v113, v113, v117
  v_add_f32 v114, v114, v118
  v_add_f32 v115, v115, v119
  v_mov_b32 v116, v112
  v_mov_b32 v117, v113
  v_mov_b32 v118, v114
  v_mov_b32 v119, v115
  s_nop 1
  v_permlane16_swap_b32 v116, v112
  v_permlane16_swap_b32 v117, v113
  v_permlane16_swap_b32 v118, v114
  v_permlane16_swap_b32 v119, v115
  s_nop 1
  v_add_f32 v112, v112, v116
  v_add_f32 v113, v113, v117
  v_add_f32 v114, v114, v118
  v_add_f32 v115, v115, v119
  v_cvt_pk_bf16_f32 v116, v112, v113
  v_cvt_pk_bf16_f32 v117, v114, v115
  s_lshl_b32 s4, s71, 5
  s_add_u32 s4, s4, 0x21000
  v_lshl_add_u32 v5, v0, 3, s4
  s_mov_b32 exec_lo, 0xf
  s_mov_b32 exec_hi, 0x0
  ds_write_b64 v5, v[116:117]
  s_mov_b64 exec, -1
  s_waitcnt vmcnt(0)
  v_pk_add_f32 v[48:49], v[48:49], v[80:81]
  v_pk_add_f32 v[50:51], v[50:51], v[82:83]
  v_pk_add_f32 v[52:53], v[52:53], v[84:85]
  v_pk_add_f32 v[54:55], v[54:55], v[86:87]
  v_pk_add_f32 v[56:57], v[56:57], v[88:89]
  v_pk_add_f32 v[58:59], v[58:59], v[90:91]
  v_pk_add_f32 v[60:61], v[60:61], v[92:93]
  v_pk_add_f32 v[62:63], v[62:63], v[94:95]
  v_pk_add_f32 v[64:65], v[64:65], v[96:97]
  v_pk_add_f32 v[66:67], v[66:67], v[98:99]
  v_pk_add_f32 v[68:69], v[68:69], v[100:101]
  v_pk_add_f32 v[70:71], v[70:71], v[102:103]
  v_pk_add_f32 v[72:73], v[72:73], v[104:105]
  v_pk_add_f32 v[74:75], v[74:75], v[106:107]
  v_pk_add_f32 v[76:77], v[76:77], v[108:109]
  v_pk_add_f32 v[78:79], v[78:79], v[110:111]
  v_pk_add_f32 v[48:49], v[48:49], v[64:65]
  v_pk_add_f32 v[50:51], v[50:51], v[66:67]
  v_pk_add_f32 v[52:53], v[52:53], v[68:69]
  v_pk_add_f32 v[54:55], v[54:55], v[70:71]
  v_pk_add_f32 v[56:57], v[56:57], v[72:73]
  v_pk_add_f32 v[58:59], v[58:59], v[74:75]
  v_pk_add_f32 v[60:61], v[60:61], v[76:77]
  v_pk_add_f32 v[62:63], v[62:63], v[78:79]
  v_pk_add_f32 v[48:49], v[48:49], v[56:57]
  v_pk_add_f32 v[50:51], v[50:51], v[58:59]
  v_pk_add_f32 v[52:53], v[52:53], v[60:61]
  v_pk_add_f32 v[54:55], v[54:55], v[62:63]
  v_pk_add_f32 v[48:49], v[48:49], v[52:53]
  v_pk_add_f32 v[50:51], v[50:51], v[54:55]
  v_cvt_pk_bf16_f32 v52, v48, v49
  v_cvt_pk_bf16_f32 v53, v50, v51
  s_lshl_b32 s4, s71, 9
  s_add_u32 s4, s4, 0x20800
  v_lshl_add_u32 v5, v0, 3, s4
  ds_write_b64 v5, v[52:53]
  s_waitcnt lgkmcnt(0)
  s_barrier
  s_branch p3_pre
p_mixer:
  s_mov_b32 s81, 1024
  s_lshl_b32 s82, s33, 7
  v_bfe_u32 v3, v0, 4, 1
  v_bfe_u32 v4, v0, 1, 2
  v_xor_b32 v3, v3, v4
  v_lshlrev_b32 v3, 5, v3
  v_and_b32 v4, 1, v0
  v_lshl_add_u32 v3, v4, 4, v3
  v_xor_b32 v4, 64, v3
  s_lshl_b32 s62, s71, 4
  v_lshrrev_b32 v2, 3, v0
  v_add_u32 v2, s62, v2
  v_mul_u32_u24 v2, s81, v2
  v_add_u32 v2, s82, v2
  v_add_u32 v12, v2, v3
  s_lshl_b32 s62, s81, 3
  v_add3_u32 v13, v2, v4, s62
  s_lshl_b32 s86, s81, 6
  s_waitcnt lgkmcnt(0)
  s_mov_b32 s8, s36
  s_mov_b32 s9, s37
  s_mov_b32 s10, 0x200000
  s_mov_b32 s11, 0x00020000
  s_mov_b32 s12, s44
  s_mov_b32 s13, s45
  s_mov_b32 s14, 0x80000
  s_mov_b32 s15, 0x00020000
  s_add_u32 s59, s58, 0
  s_and_b32 s59, s59, 7
  s_mul_i32 s60, s59, s85
  s_add_u32 m0, s87, 0x0
  s_nop 0
  buffer_load_dwordx4 v8, s[8:11], s60 offen lds
  s_add_u32 m0, s87, 0x400
  s_nop 0
  buffer_load_dwordx4 v9, s[8:11], s60 offen lds
  s_add_u32 m0, s87, 0x800
  s_nop 0
  buffer_load_dwordx4 v10, s[8:11], s60 offen lds
  s_add_u32 m0, s87, 0xc00
  s_nop 0
  buffer_load_dwordx4 v11, s[8:11], s60 offen lds
  s_add_u32 s59, s58, 0
  s_and_b32 s59, s59, 7
  s_mul_i32 s61, s59, s86
  s_add_u32 m0, s95, 0x4000
  s_nop 0
  buffer_load_dwordx4 v12, s[12:15], s61 offen lds
  s_add_u32 m0, s95, 0x4400
  s_nop 0
  buffer_load_dwordx4 v13, s[12:15], s61 offen lds
  s_add_u32 s59, s58, 1
  s_and_b32 s59, s59, 7
  s_mul_i32 s60, s59, s85
  s_add_u32 m0, s87, 0x8000
  s_nop 0
  buffer_load_dwordx4 v8, s[8:11], s60 offen lds
  s_add_u32 m0, s87, 0x8400
  s_nop 0
  buffer_load_dwordx4 v9, s[8:11], s60 offen lds
  s_add_u32 m0, s87, 0x8800
  s_nop 0
  buffer_load_dwordx4 v10, s[8:11], s60 offen lds
  s_add_u32 m0, s87, 0x8c00
  s_nop 0
  buffer_load_dwordx4 v11, s[8:11], s60 offen lds
  s_add_u32 s59, s58, 1
  s_and_b32 s59, s59, 7
  s_mul_i32 s61, s59, s86
  s_add_u32 m0, s95, 0xc000
  s_nop 0
  buffer_load_dwordx4 v12, s[12:15], s61 offen lds
  s_add_u32 m0, s95, 0xc400
  s_nop 0
  buffer_load_dwordx4 v13, s[12:15], s61 offen lds
  s_add_u32 s59, s58, 2
  s_and_b32 s59, s59, 7
  s_mul_i32 s60, s59, s85
  s_add_u32 m0, s87, 0x10000
  s_nop 0
  buffer_load_dwordx4 v8, s[8:11], s60 offen lds
  s_add_u32 m0, s87, 0x10400
  s_nop 0
  buffer_load_dwordx4 v9, s[8:11], s60 offen lds
  s_add_u32 m0, s87, 0x10800
  s_nop 0
  buffer_load_dwordx4 v10, s[8:11], s60 offen lds
  s_add_u32 m0, s87, 0x10c00
  s_nop 0
  buffer_load_dwordx4 v11, s[8:11], s60 offen lds
  s_add_u32 s59, s58, 2
  s_and_b32 s59, s59, 7
  s_mul_i32 s61, s59, s86
  s_add_u32 m0, s95, 0x14000
  s_nop 0
  buffer_load_dwordx4 v12, s[12:15], s61 offen lds
  s_add_u32 m0, s95, 0x14400
  s_nop 0
  buffer_load_dwordx4 v13, s[12:15], s61 offen lds
  s_add_u32 s59, s58, 3
  s_and_b32 s59, s59, 7
  s_mul_i32 s60, s59, s85
  s_add_u32 m0, s87, 0x18000
  s_nop 0
  buffer_load_dwordx4 v8, s[8:11], s60 offen lds
  s_add_u32 m0, s87, 0x18400
  s_nop 0
  buffer_load_dwordx4 v9, s[8:11], s60 offen lds
  s_add_u32 m0, s87, 0x18800
  s_nop 0
  buffer_load_dwordx4 v10, s[8:11], s60 offen lds
  s_add_u32 m0, s87, 0x18c00
  s_nop 0
  buffer_load_dwordx4 v11, s[8:11], s60 offen lds
  s_add_u32 s59, s58, 3
  s_and_b32 s59, s59, 7
  s_mul_i32 s61, s59, s86
  s_add_u32 m0, s95, 0x1c000
  s_nop 0
  buffer_load_dwordx4 v12, s[12:15], s61 offen lds
  s_add_u32 m0, s95, 0x1c400
  s_nop 0
  buffer_load_dwordx4 v13, s[12:15], s61 offen lds
  s_waitcnt vmcnt(18)
  s_barrier
  s_waitcnt vmcnt(12)
  s_barrier
  s_add_u32 s59, s58, 4
  s_and_b32 s59, s59, 7
  s_mul_i32 s60, s59, s85
  s_add_u32 m0, s87, 0x0
  s_nop 0
  buffer_load_dwordx4 v8, s[8:11], s60 offen lds
  s_add_u32 m0, s87, 0x400
  s_nop 0
  buffer_load_dwordx4 v9, s[8:11], s60 offen lds
  s_add_u32 m0, s87, 0x800
  s_nop 0
  buffer_load_dwordx4 v10, s[8:11], s60 offen lds
  s_add_u32 m0, s87, 0xc00
  s_nop 0
  buffer_load_dwordx4 v11, s[8:11], s60 offen lds
  s_add_u32 s59, s58, 4
  s_and_b32 s59, s59, 7
  s_mul_i32 s61, s59, s86
  s_add_u32 m0, s95, 0x6000
  s_nop 0
  buffer_load_dwordx4 v12, s[12:15], s61 offen lds
  s_add_u32 m0, s95, 0x6400
  s_nop 0
  buffer_load_dwordx4 v13, s[12:15], s61 offen lds
  s_waitcnt vmcnt(12)
  s_barrier
  s_add_u32 s59, s58, 5
  s_and_b32 s59, s59, 7
  s_mul_i32 s60, s59, s85
  s_add_u32 m0, s87, 0x8000
  s_nop 0
  buffer_load_dwordx4 v8, s[8:11], s60 offen lds
  s_add_u32 m0, s87, 0x8400
  s_nop 0
  buffer_load_dwordx4 v9, s[8:11], s60 offen lds
  s_add_u32 m0, s87, 0x8800
  s_nop 0
  buffer_load_dwordx4 v10, s[8:11], s60 offen lds
  s_add_u32 m0, s87, 0x8c00
  s_nop 0
  buffer_load_dwordx4 v11, s[8:11], s60 offen lds
  s_add_u32 s59, s58, 5
  s_and_b32 s59, s59, 7
  s_mul_i32 s61, s59, s86
  s_add_u32 m0, s95, 0xe000
  s_nop 0
  buffer_load_dwordx4 v12, s[12:15], s61 offen lds
  s_add_u32 m0, s95, 0xe400
  s_nop 0
  buffer_load_dwordx4 v13, s[12:15], s61 offen lds
  s_waitcnt vmcnt(12)
  s_barrier
  s_add_u32 s59, s58, 6
  s_and_b32 s59, s59, 7
  s_mul_i32 s60, s59, s85
  s_add_u32 m0, s87, 0x10000
  s_nop 0
  buffer_load_dwordx4 v8, s[8:11], s60 offen lds
  s_add_u32 m0, s87, 0x10400
  s_nop 0
  buffer_load_dwordx4 v9, s[8:11], s60 offen lds
  s_add_u32 m0, s87, 0x10800
  s_nop 0
  buffer_load_dwordx4 v10, s[8:11], s60 offen lds
  s_add_u32 m0, s87, 0x10c00
  s_nop 0
  buffer_load_dwordx4 v11, s[8:11], s60 offen lds
  s_add_u32 s59, s58, 6
  s_and_b32 s59, s59, 7
  s_mul_i32 s61, s59, s86
  s_add_u32 m0, s95, 0x16000
  s_nop 0
  buffer_load_dwordx4 v12, s[12:15], s61 offen lds
  s_add_u32 m0, s95, 0x16400
  s_nop 0
  buffer_load_dwordx4 v13, s[12:15], s61 offen lds
  s_waitcnt vmcnt(12)
  s_barrier
  s_add_u32 s59, s58, 7
  s_and_b32 s59, s59, 7
  s_mul_i32 s60, s59, s85
  s_add_u32 m0, s87, 0x18000
  s_nop 0
  buffer_load_dwordx4 v8, s[8:11], s60 offen lds
  s_add_u32 m0, s87, 0x18400
  s_nop 0
  buffer_load_dwordx4 v9, s[8:11], s60 offen lds
  s_add_u32 m0, s87, 0x18800
  s_nop 0
  buffer_load_dwordx4 v10, s[8:11], s60 offen lds
  s_add_u32 m0, s87, 0x18c00
  s_nop 0
  buffer_load_dwordx4 v11, s[8:11], s60 offen lds
  s_add_u32 s59, s58, 7
  s_and_b32 s59, s59, 7
  s_mul_i32 s61, s59, s86
  s_add_u32 m0, s95, 0x1e000
  s_nop 0
  buffer_load_dwordx4 v12, s[12:15], s61 offen lds
  s_add_u32 m0, s95, 0x1e400
  s_nop 0
  buffer_load_dwordx4 v13, s[12:15], s61 offen lds
  s_mov_b32 s16, s54
  s_mov_b32 s17, s55
  s_mov_b32 s18, 0x100
  s_mov_b32 s19, 0x00020000
  v_mov_b32 v2, 0
  buffer_load_dword v44, v2, s[16:19], 0 offen sc1
  s_mov_b32 s16, s46
  s_mov_b32 s17, s47
  s_mov_b32 s18, 0x80000
  s_mov_b32 s19, 0x00020000
  s_mov_b32 s24, s48
  s_mov_b32 s25, s49
  s_mov_b32 s26, 0x158000
  s_mov_b32 s27, 0x00020000
  s_lshl_b32 s4, s2, 2
  s_add_u32 s4, s4, s71
  s_lshl_b32 s4, s4, 10
  v_lshl_add_u32 v16, v0, 4, s4
  v_add_u32 v17, 0x100000, v16
  s_mov_b32 s20, s40
  s_mov_b32 s21, s41
  s_mov_b32 s22, 0x80000
  s_mov_b32 s23, 0x00020000
  s_mov_b32 s28, s50
  s_mov_b32 s29, s51
  s_mov_b32 s30, 0x158000
  s_mov_b32 s31, 0x00020000
  v_add_u32 v18, 0xfff80000, v16
  buffer_load_dwordx4 v[20:23], v16, s[16:19], 0 offen
  buffer_load_dwordx4 v[28:31], v16, s[24:27], 0 offen
  buffer_load_dwordx4 v[32:35], v17, s[24:27], 0 offen
  buffer_load_dwordx4 v[24:27], v18, s[20:23], 0 offen
  buffer_load_dwordx4 v[36:39], v16, s[28:31], 0 offen
  buffer_load_dwordx4 v[40:43], v17, s[28:31], 0 offen
  s_waitcnt vmcnt(19)
  s_barrier
  s_waitcnt vmcnt(13)
  s_barrier
  s_waitcnt vmcnt(7)
  s_barrier
  s_waitcnt vmcnt(6)
  v_readfirstlane_b32 s4, v44
  s_cmp_lg_u32 s4, 0
  s_cbranch_scc1 L_ini_7
  s_mov_b32 s28, s54
  s_mov_b32 s29, s55
  s_mov_b32 s30, 0x100
  s_mov_b32 s31, 0x00020000
  v_mov_b32 v2, 0
  v_mov_b32 v3, 1
  s_mov_b32 s88, 0
L_poll_8:
  buffer_load_dword v4, v2, s[28:31], 0 offen sc1
  s_waitcnt vmcnt(0)
  v_cmp_lt_u32 vcc, v4, v3
  s_add_u32 s88, s88, 1
  s_cmp_ge_u32 s88, 200000
  s_cbranch_scc1 L_polled_9
  s_cbranch_vccz L_polled_9
  s_sleep 1
  s_branch L_poll_8
L_polled_9:
L_ini_7:
  s_barrier
  s_mov_b32 s12, s46
  s_mov_b32 s13, s47
  s_mov_b32 s14, 0x80000
  s_mov_b32 s15, 0x00020000
  s_mul_i32 s61, s86, 0
  s_add_u32 m0, s95, 0x4000
  s_nop 0
  buffer_load_dwordx4 v12, s[12:15], s61 offen lds
  s_add_u32 m0, s95, 0x4400
  s_nop 0
  buffer_load_dwordx4 v13, s[12:15], s61 offen lds
  s_mul_i32 s61, s86, 1
  s_add_u32 m0, s95, 0xc000
  s_nop 0
  buffer_load_dwordx4 v12, s[12:15], s61 offen lds
  s_add_u32 m0, s95, 0xc400
  s_nop 0
  buffer_load_dwordx4 v13, s[12:15], s61 offen lds
  s_mul_i32 s61, s86, 2
  s_add_u32 m0, s95, 0x14000
  s_nop 0
  buffer_load_dwordx4 v12, s[12:15], s61 offen lds
  s_add_u32 m0, s95, 0x14400
  s_nop 0
  buffer_load_dwordx4 v13, s[12:15], s61 offen lds
  s_mul_i32 s61, s86, 3
  s_add_u32 m0, s95, 0x1c000
  s_nop 0
  buffer_load_dwordx4 v12, s[12:15], s61 offen lds
  s_add_u32 m0, s95, 0x1c400
  s_nop 0
  buffer_load_dwordx4 v13, s[12:15], s61 offen lds
  s_mov_b32 s79, 1152
  v_lshrrev_b32 v5, 4, v0
  v_and_b32 v2, 7, v0
  v_xor_b32 v2, v2, v5
  v_lshrrev_b32 v3, 1, v2
  v_xor_b32 v4, 2, v3
  v_mul_u32_u24 v3, s80, v3
  v_mul_u32_u24 v4, s80, v4
  v_and_b32 v2, 1, v2
  v_lshlrev_b32 v2, 4, v2
  v_add_u32 v3, v3, v2
  v_add_u32 v4, v4, v2
  s_lshl_b32 s62, s71, 5
  s_add_u32 s62, s62, s78
  v_lshrrev_b32 v2, 3, v0
  v_add_u32 v2, s62, v2
  v_mul_u32_u24 v2, s79, v2
  s_lshl_b32 s62, s79, 3
  s_lshl_b32 s63, s79, 4
  v_add_u32 v8, v2, v3
  v_add3_u32 v9, v2, v4, s62
  v_add_u32 v10, s63, v8
  v_add_u32 v11, s63, v9
  s_add_u32 s8, s56, 0x500000
  s_addc_u32 s9, s57, 0
  s_mov_b32 s10, 0x240000
  s_mov_b32 s11, 0x00020000
  s_barrier
  v_add_u32 v16, 0xfffffb80, v8
  v_add_u32 v17, 0xfffffb80, v9
  v_add_u32 v18, 0xfffffb80, v10
  v_add_u32 v19, 0xfffffb80, v11
  s_add_u32 m0, s87, 0x0
  s_nop 0
  buffer_load_dwordx4 v16, s[8:11], 0 offen sc1 lds
  s_add_u32 m0, s87, 0x400
  s_nop 0
  buffer_load_dwordx4 v17, s[8:11], 0 offen sc1 lds
  s_add_u32 m0, s87, 0x800
  s_nop 0
  buffer_load_dwordx4 v18, s[8:11], 0 offen sc1 lds
  s_add_u32 m0, s87, 0xc00
  s_nop 0
  buffer_load_dwordx4 v19, s[8:11], 0 offen sc1 lds
  v_add_u32 v16, 0xfffffc00, v8
  v_add_u32 v17, 0xfffffc00, v9
  v_add_u32 v18, 0xfffffc00, v10
  v_add_u32 v19, 0xfffffc00, v11
  s_add_u32 m0, s87, 0x8000
  s_nop 0
  buffer_load_dwordx4 v16, s[8:11], 0 offen sc1 lds
  s_add_u32 m0, s87, 0x8400
  s_nop 0
  buffer_load_dwordx4 v17, s[8:11], 0 offen sc1 lds
  s_add_u32 m0, s87, 0x8800
  s_nop 0
  buffer_load_dwordx4 v18, s[8:11], 0 offen sc1 lds
  s_add_u32 m0, s87, 0x8c00
  s_nop 0
  buffer_load_dwordx4 v19, s[8:11], 0 offen sc1 lds
  v_add_u32 v16, 0x580, v8
  v_add_u32 v17, 0x580, v9
  v_add_u32 v18, 0x580, v10
  v_add_u32 v19, 0x580, v11
  s_add_u32 m0, s87, 0x10000
  s_nop 0
  buffer_load_dwordx4 v16, s[8:11], 0 offen sc1 lds
  s_add_u32 m0, s87, 0x10400
  s_nop 0
  buffer_load_dwordx4 v17, s[8:11], 0 offen sc1 lds
  s_add_u32 m0, s87, 0x10800
  s_nop 0
  buffer_load_dwordx4 v18, s[8:11], 0 offen sc1 lds
  s_add_u32 m0, s87, 0x10c00
  s_nop 0
  buffer_load_dwordx4 v19, s[8:11], 0 offen sc1 lds
  v_add_u32 v16, 0x600, v8
  v_add_u32 v17, 0x600, v9
  v_add_u32 v18, 0x600, v10
  v_add_u32 v19, 0x600, v11
  s_add_u32 m0, s87, 0x18000
  s_nop 0
  buffer_load_dwordx4 v16, s[8:11], 0 offen sc1 lds
  s_add_u32 m0, s87, 0x18400
  s_nop 0
  buffer_load_dwordx4 v17, s[8:11], 0 offen sc1 lds
  s_add_u32 m0, s87, 0x18800
  s_nop 0
  buffer_load_dwordx4 v18, s[8:11], 0 offen sc1 lds
  s_add_u32 m0, s87, 0x18c00
  s_nop 0
  buffer_load_dwordx4 v19, s[8:11], 0 offen sc1 lds
  s_waitcnt vmcnt(12)
  s_barrier
  s_waitcnt vmcnt(8)
  s_barrier
  v_add_u32 v16, 0xfffff900, v8
  v_add_u32 v17, 0xfffff900, v9
  v_add_u32 v18, 0xfffff900, v10
  v_add_u32 v19, 0xfffff900, v11
  s_add_u32 m0, s87, 0x0
  s_nop 0
  buffer_load_dwordx4 v16, s[8:11], 0 offen sc1 lds
  s_add_u32 m0, s87, 0x400
  s_nop 0
  buffer_load_dwordx4 v17, s[8:11], 0 offen sc1 lds
  s_add_u32 m0, s87, 0x800
  s_nop 0
  buffer_load_dwordx4 v18, s[8:11], 0 offen sc1 lds
  s_add_u32 m0, s87, 0xc00
  s_nop 0
  buffer_load_dwordx4 v19, s[8:11], 0 offen sc1 lds
  s_mul_i32 s61, s86, 4
  s_add_u32 m0, s95, 0x6000
  s_nop 0
  buffer_load_dwordx4 v12, s[12:15], s61 offen lds
  s_add_u32 m0, s95, 0x6400
  s_nop 0
  buffer_load_dwordx4 v13, s[12:15], s61 offen lds
  s_waitcnt vmcnt(10)
  s_barrier
  v_add_u32 v16, 0xfffff980, v8
  v_add_u32 v17, 0xfffff980, v9
  v_add_u32 v18, 0xfffff980, v10
  v_add_u32 v19, 0xfffff980, v11
  s_add_u32 m0, s87, 0x8000
  s_nop 0
  buffer_load_dwordx4 v16, s[8:11], 0 offen sc1 lds
  s_add_u32 m0, s87, 0x8400
  s_nop 0
  buffer_load_dwordx4 v17, s[8:11], 0 offen sc1 lds
  s_add_u32 m0, s87, 0x8800
  s_nop 0
  buffer_load_dwordx4 v18, s[8:11], 0 offen sc1 lds
  s_add_u32 m0, s87, 0x8c00
  s_nop 0
  buffer_load_dwordx4 v19, s[8:11], 0 offen sc1 lds
  s_mul_i32 s61, s86, 5
  s_add_u32 m0, s95, 0xe000
  s_nop 0
  buffer_load_dwordx4 v12, s[12:15], s61 offen lds
  s_add_u32 m0, s95, 0xe400
  s_nop 0
  buffer_load_dwordx4 v13, s[12:15], s61 offen lds
  s_waitcnt vmcnt(12)
  s_barrier
  v_add_u32 v16, 0xc00, v8
  v_add_u32 v17, 0xc00, v9
  v_add_u32 v18, 0xc00, v10
  v_add_u32 v19, 0xc00, v11
  s_add_u32 m0, s87, 0x10000
  s_nop 0
  buffer_load_dwordx4 v16, s[8:11], 0 offen sc1 lds
  s_add_u32 m0, s87, 0x10400
  s_nop 0
  buffer_load_dwordx4 v17, s[8:11], 0 offen sc1 lds
  s_add_u32 m0, s87, 0x10800
  s_nop 0
  buffer_load_dwordx4 v18, s[8:11], 0 offen sc1 lds
  s_add_u32 m0, s87, 0x10c00
  s_nop 0
  buffer_load_dwordx4 v19, s[8:11], 0 offen sc1 lds
  s_mul_i32 s61, s86, 6
  s_add_u32 m0, s95, 0x16000
  s_nop 0
  buffer_load_dwordx4 v12, s[12:15], s61 offen lds
  s_add_u32 m0, s95, 0x16400
  s_nop 0
  buffer_load_dwordx4 v13, s[12:15], s61 offen lds
  s_waitcnt vmcnt(12)
  s_barrier
  v_add_u32 v16, 0xc80, v8
  v_add_u32 v17, 0xc80, v9
  v_add_u32 v18, 0xc80, v10
  v_add_u32 v19, 0xc80, v11
  s_add_u32 m0, s87, 0x18000
  s_nop 0
  buffer_load_dwordx4 v16, s[8:11], 0 offen sc1 lds
  s_add_u32 m0, s87, 0x18400
  s_nop 0
  buffer_load_dwordx4 v17, s[8:11], 0 offen sc1 lds
  s_add_u32 m0, s87, 0x18800
  s_nop 0
  buffer_load_dwordx4 v18, s[8:11], 0 offen sc1 lds
  s_add_u32 m0, s87, 0x18c00
  s_nop 0
  buffer_load_dwordx4 v19, s[8:11], 0 offen sc1 lds
  s_mul_i32 s61, s86, 7
  s_add_u32 m0, s95, 0x1e000
  s_nop 0
  buffer_load_dwordx4 v12, s[12:15], s61 offen lds
  s_add_u32 m0, s95, 0x1e400
  s_nop 0
  buffer_load_dwordx4 v13, s[12:15], s61 offen lds
  s_waitcnt vmcnt(12)
  s_barrier
  s_waitcnt vmcnt(6)
  s_barrier
  s_waitcnt vmcnt(0)
  s_barrier
  s_barrier
p3_pre:
  s_and_b32 s4, s2, 7
  s_lshr_b32 s5, s2, 3
  s_lshl_b32 s6, s4, 1
  s_and_b32 s7, s5, 1
  s_add_u32 s32, s6, s7
  s_lshr_b32 s5, s5, 1
  s_and_b32 s33, s5, 7
  s_lshl_b32 s78, s32, 7
  s_mov_b32 s79, 1152
  s_mov_b32 s80, 32
  s_mov_b32 s81, 2752
  s_mov_b32 s85, 128
  s_lshl_b32 s86, s81, 6
  s_mov_b32 s12, s48
  s_mov_b32 s13, s49
  s_mov_b32 s14, 0x158000
  s_mov_b32 s15, 0x00020000
  s_add_u32 s8, s56, 0x740000
  s_addc_u32 s9, s57, 0
  s_mov_b32 s10, 0x240000
  s_mov_b32 s11, 0x00020000
  s_cmp_eq_u32 s94, 0
  s_cbranch_scc1 L_p3mid_11
  s_mov_b32 s83, 64
  s_mov_b32 s84, 32
  s_lshl_b32 s82, s33, 8
  v_lshrrev_b32 v5, 4, v0
  v_bfe_u32 v2, v0, 1, 3
  v_xor_b32 v2, v2, v5
  v_lshrrev_b32 v3, 1, v2
  v_xor_b32 v4, 2, v3
  v_mul_u32_u24 v3, s83, v3
  v_mul_u32_u24 v4, s83, v4
  v_and_b32 v2, 1, v2
  v_mul_u32_u24 v2, s84, v2
  v_and_b32 v12, 1, v0
  v_lshl_add_u32 v2, v12, 4, v2
  v_add3_u32 v3, v3, v2, s82
  v_add3_u32 v4, v4, v2, s82
  s_lshl_b32 s62, s71, 4
  v_add_u32 v2, s62, v5
  v_mul_u32_u24 v2, s81, v2
  s_lshl_b32 s62, s81, 2
  s_lshl_b32 s63, s81, 3
  v_add_u32 v12, v2, v3
  v_add_u32 v13, s62, v12
  v_add3_u32 v14, v2, v4, s63
  v_add_u32 v15, s62, v14
  s_mul_i32 s61, s86, 0
  s_add_u32 m0, s87, 0x4000
  s_nop 0
  buffer_load_dwordx4 v12, s[12:15], s61 offen lds
  s_add_u32 m0, s87, 0x4400
  s_nop 0
  buffer_load_dwordx4 v13, s[12:15], s61 offen lds
  s_add_u32 m0, s87, 0x4800
  s_nop 0
  buffer_load_dwordx4 v14, s[12:15], s61 offen lds
  s_add_u32 m0, s87, 0x4c00
  s_nop 0
  buffer_load_dwordx4 v15, s[12:15], s61 offen lds
  s_mul_i32 s61, s86, 1
  s_add_u32 m0, s87, 0xc000
  s_nop 0
  buffer_load_dwordx4 v12, s[12:15], s61 offen lds
  s_add_u32 m0, s87, 0xc400
  s_nop 0
  buffer_load_dwordx4 v13, s[12:15], s61 offen lds
  s_add_u32 m0, s87, 0xc800
  s_nop 0
  buffer_load_dwordx4 v14, s[12:15], s61 offen lds
  s_add_u32 m0, s87, 0xcc00
  s_nop 0
  buffer_load_dwordx4 v15, s[12:15], s61 offen lds
  s_mul_i32 s61, s86, 2
  s_add_u32 m0, s87, 0x14000
  s_nop 0
  buffer_load_dwordx4 v12, s[12:15], s61 offen lds
  s_add_u32 m0, s87, 0x14400
  s_nop 0
  buffer_load_dwordx4 v13, s[12:15], s61 offen lds
  s_add_u32 m0, s87, 0x14800
  s_nop 0
  buffer_load_dwordx4 v14, s[12:15], s61 offen lds
  s_add_u32 m0, s87, 0x14c00
  s_nop 0
  buffer_load_dwordx4 v15, s[12:15], s61 offen lds
  s_mul_i32 s61, s86, 3
  s_add_u32 m0, s87, 0x1c000
  s_nop 0
  buffer_load_dwordx4 v12, s[12:15], s61 offen lds
  s_add_u32 m0, s87, 0x1c400
  s_nop 0
  buffer_load_dwordx4 v13, s[12:15], s61 offen lds
  s_add_u32 m0, s87, 0x1c800
  s_nop 0
  buffer_load_dwordx4 v14, s[12:15], s61 offen lds
  s_add_u32 m0, s87, 0x1cc00
  s_nop 0
  buffer_load_dwordx4 v15, s[12:15], s61 offen lds
  v_lshrrev_b32 v5, 4, v0
  v_and_b32 v2, 7, v0
  v_xor_b32 v2, v2, v5
  v_lshrrev_b32 v3, 1, v2
  v_xor_b32 v4, 2, v3
  v_mul_u32_u24 v3, s80, v3
  v_mul_u32_u24 v4, s80, v4
  v_and_b32 v2, 1, v2
  v_lshlrev_b32 v2, 4, v2
  v_add_u32 v3, v3, v2
  v_add_u32 v4, v4, v2
  s_lshl_b32 s62, s71, 5
  s_add_u32 s62, s62, s78
  v_lshrrev_b32 v2, 3, v0
  v_add_u32 v2, s62, v2
  v_mul_u32_u24 v2, s79, v2
  s_lshl_b32 s62, s79, 3
  s_lshl_b32 s63, s79, 4
  v_add_u32 v8, v2, v3
  v_add3_u32 v9, v2, v4, s62
  v_add_u32 v10, s63, v8
  v_add_u32 v11, s63, v9
  s_barrier
  s_mul_i32 s60, s85, 0
  s_add_u32 m0, s87, 0x0
  s_nop 0
  buffer_load_dwordx4 v8, s[8:11], s60 offen sc1 lds
  s_add_u32 m0, s87, 0x400
  s_nop 0
  buffer_load_dwordx4 v9, s[8:11], s60 offen sc1 lds
  s_add_u32 m0, s87, 0x800
  s_nop 0
  buffer_load_dwordx4 v10, s[8:11], s60 offen sc1 lds
  s_add_u32 m0, s87, 0xc00
  s_nop 0
  buffer_load_dwordx4 v11, s[8:11], s60 offen sc1 lds
  s_mul_i32 s60, s85, 1
  s_add_u32 m0, s87, 0x8000
  s_nop 0
  buffer_load_dwordx4 v8, s[8:11], s60 offen sc1 lds
  s_add_u32 m0, s87, 0x8400
  s_nop 0
  buffer_load_dwordx4 v9, s[8:11], s60 offen sc1 lds
  s_add_u32 m0, s87, 0x8800
  s_nop 0
  buffer_load_dwordx4 v10, s[8:11], s60 offen sc1 lds
  s_add_u32 m0, s87, 0x8c00
  s_nop 0
  buffer_load_dwordx4 v11, s[8:11], s60 offen sc1 lds
  s_mul_i32 s60, s85, 2
  s_add_u32 m0, s87, 0x10000
  s_nop 0
  buffer_load_dwordx4 v8, s[8:11], s60 offen sc1 lds
  s_add_u32 m0, s87, 0x10400
  s_nop 0
  buffer_load_dwordx4 v9, s[8:11], s60 offen sc1 lds
  s_add_u32 m0, s87, 0x10800
  s_nop 0
  buffer_load_dwordx4 v10, s[8:11], s60 offen sc1 lds
  s_add_u32 m0, s87, 0x10c00
  s_nop 0
  buffer_load_dwordx4 v11, s[8:11], s60 offen sc1 lds
  s_mul_i32 s60, s85, 3
  s_add_u32 m0, s87, 0x18000
  s_nop 0
  buffer_load_dwordx4 v8, s[8:11], s60 offen sc1 lds
  s_add_u32 m0, s87, 0x18400
  s_nop 0
  buffer_load_dwordx4 v9, s[8:11], s60 offen sc1 lds
  s_add_u32 m0, s87, 0x18800
  s_nop 0
  buffer_load_dwordx4 v10, s[8:11], s60 offen sc1 lds
  s_add_u32 m0, s87, 0x18c00
  s_nop 0
  buffer_load_dwordx4 v11, s[8:11], s60 offen sc1 lds
  s_waitcnt vmcnt(12)
  s_barrier
  s_waitcnt vmcnt(8)
  s_barrier
  s_mul_i32 s60, s85, 4
  s_add_u32 m0, s87, 0x0
  s_nop 0
  buffer_load_dwordx4 v8, s[8:11], s60 offen sc1 lds
  s_add_u32 m0, s87, 0x400
  s_nop 0
  buffer_load_dwordx4 v9, s[8:11], s60 offen sc1 lds
  s_add_u32 m0, s87, 0x800
  s_nop 0
  buffer_load_dwordx4 v10, s[8:11], s60 offen sc1 lds
  s_add_u32 m0, s87, 0xc00
  s_nop 0
  buffer_load_dwordx4 v11, s[8:11], s60 offen sc1 lds
  s_mul_i32 s61, s86, 4
  s_add_u32 m0, s87, 0x4000
  s_nop 0
  buffer_load_dwordx4 v12, s[12:15], s61 offen lds
  s_add_u32 m0, s87, 0x4400
  s_nop 0
  buffer_load_dwordx4 v13, s[12:15], s61 offen lds
  s_add_u32 m0, s87, 0x4800
  s_nop 0
  buffer_load_dwordx4 v14, s[12:15], s61 offen lds
  s_add_u32 m0, s87, 0x4c00
  s_nop 0
  buffer_load_dwordx4 v15, s[12:15], s61 offen lds
  s_waitcnt vmcnt(12)
  s_barrier
  s_mul_i32 s60, s85, 5
  s_add_u32 m0, s87, 0x8000
  s_nop 0
  buffer_load_dwordx4 v8, s[8:11], s60 offen sc1 lds
  s_add_u32 m0, s87, 0x8400
  s_nop 0
  buffer_load_dwordx4 v9, s[8:11], s60 offen sc1 lds
  s_add_u32 m0, s87, 0x8800
  s_nop 0
  buffer_load_dwordx4 v10, s[8:11], s60 offen sc1 lds
  s_add_u32 m0, s87, 0x8c00
  s_nop 0
  buffer_load_dwordx4 v11, s[8:11], s60 offen sc1 lds
  s_mul_i32 s61, s86, 5
  s_add_u32 m0, s87, 0xc000
  s_nop 0
  buffer_load_dwordx4 v12, s[12:15], s61 offen lds
  s_add_u32 m0, s87, 0xc400
  s_nop 0
  buffer_load_dwordx4 v13, s[12:15], s61 offen lds
  s_add_u32 m0, s87, 0xc800
  s_nop 0
  buffer_load_dwordx4 v14, s[12:15], s61 offen lds
  s_add_u32 m0, s87, 0xcc00
  s_nop 0
  buffer_load_dwordx4 v15, s[12:15], s61 offen lds
  s_waitcnt vmcnt(16)
  s_barrier
  s_mul_i32 s60, s85, 6
  s_add_u32 m0, s87, 0x10000
  s_nop 0
  buffer_load_dwordx4 v8, s[8:11], s60 offen sc1 lds
  s_add_u32 m0, s87, 0x10400
  s_nop 0
  buffer_load_dwordx4 v9, s[8:11], s60 offen sc1 lds
  s_add_u32 m0, s87, 0x10800
  s_nop 0
  buffer_load_dwordx4 v10, s[8:11], s60 offen sc1 lds
  s_add_u32 m0, s87, 0x10c00
  s_nop 0
  buffer_load_dwordx4 v11, s[8:11], s60 offen sc1 lds
  s_mul_i32 s61, s86, 6
  s_add_u32 m0, s87, 0x14000
  s_nop 0
  buffer_load_dwordx4 v12, s[12:15], s61 offen lds
  s_add_u32 m0, s87, 0x14400
  s_nop 0
  buffer_load_dwordx4 v13, s[12:15], s61 offen lds
  s_add_u32 m0, s87, 0x14800
  s_nop 0
  buffer_load_dwordx4 v14, s[12:15], s61 offen lds
  s_add_u32 m0, s87, 0x14c00
  s_nop 0
  buffer_load_dwordx4 v15, s[12:15], s61 offen lds
  s_waitcnt vmcnt(16)
  s_barrier
  s_mul_i32 s60, s85, 7
  s_add_u32 m0, s87, 0x18000
  s_nop 0
  buffer_load_dwordx4 v8, s[8:11], s60 offen sc1 lds
  s_add_u32 m0, s87, 0x18400
  s_nop 0
  buffer_load_dwordx4 v9, s[8:11], s60 offen sc1 lds
  s_add_u32 m0, s87, 0x18800
  s_nop 0
  buffer_load_dwordx4 v10, s[8:11], s60 offen sc1 lds
  s_add_u32 m0, s87, 0x18c00
  s_nop 0
  buffer_load_dwordx4 v11, s[8:11], s60 offen sc1 lds
  s_mul_i32 s61, s86, 7
  s_add_u32 m0, s87, 0x1c000
  s_nop 0
  buffer_load_dwordx4 v12, s[12:15], s61 offen lds
  s_add_u32 m0, s87, 0x1c400
  s_nop 0
  buffer_load_dwordx4 v13, s[12:15], s61 offen lds
  s_add_u32 m0, s87, 0x1c800
  s_nop 0
  buffer_load_dwordx4 v14, s[12:15], s61 offen lds
  s_add_u32 m0, s87, 0x1cc00
  s_nop 0
  buffer_load_dwordx4 v15, s[12:15], s61 offen lds
  s_waitcnt vmcnt(16)
  s_barrier
  s_waitcnt vmcnt(8)
  s_barrier
  s_waitcnt vmcnt(0)
  s_barrier
  s_barrier
  s_barrier
  s_branch L_p3skip_10
L_p3mid_11:
  s_cmp_ge_u32 s33, 6
  s_cbranch_scc1 L_p3skip_10
  s_lshl_b32 s82, s33, 7
  s_add_u32 s82, s82, 2048
  v_bfe_u32 v3, v0, 4, 1
  v_bfe_u32 v4, v0, 1, 2
  v_xor_b32 v3, v3, v4
  v_lshlrev_b32 v3, 5, v3
  v_and_b32 v4, 1, v0
  v_lshl_add_u32 v3, v4, 4, v3
  v_xor_b32 v4, 64, v3
  s_lshl_b32 s62, s71, 4
  v_lshrrev_b32 v2, 3, v0
  v_add_u32 v2, s62, v2
  v_mul_u32_u24 v2, s81, v2
  v_add_u32 v2, s82, v2
  v_add_u32 v12, v2, v3
  s_lshl_b32 s62, s81, 3
  v_add3_u32 v13, v2, v4, s62
  s_cmp_lg_u32 s33, 5
  s_cbranch_scc1 L_p3m_12
  v_bfe_u32 v2, v0, 4, 1
  v_bfe_u32 v3, v0, 1, 2
  v_xor_b32 v2, v2, v3
  v_xor_b32 v3, 2, v2
  v_mov_b32 v4, 0x40000000
  v_cmp_le_u32 vcc, 2, v2
  s_nop 1
  v_cndmask_b32 v12, v12, v4, vcc
  v_cmp_le_u32 vcc, 2, v3
  s_nop 1
  v_cndmask_b32 v13, v13, v4, vcc
L_p3m_12:
  s_mul_i32 s61, s86, 0
  s_add_u32 m0, s95, 0x4000
  s_nop 0
  buffer_load_dwordx4 v12, s[12:15], s61 offen lds
  s_add_u32 m0, s95, 0x4400
  s_nop 0
  buffer_load_dwordx4 v13, s[12:15], s61 offen lds
  s_mul_i32 s61, s86, 1
  s_add_u32 m0, s95, 0xc000
  s_nop 0
  buffer_load_dwordx4 v12, s[12:15], s61 offen lds
  s_add_u32 m0, s95, 0xc400
  s_nop 0
  buffer_load_dwordx4 v13, s[12:15], s61 offen lds
  s_mul_i32 s61, s86, 2
  s_add_u32 m0, s95, 0x14000
  s_nop 0
  buffer_load_dwordx4 v12, s[12:15], s61 offen lds
  s_add_u32 m0, s95, 0x14400
  s_nop 0
  buffer_load_dwordx4 v13, s[12:15], s61 offen lds
  s_mul_i32 s61, s86, 3
  s_add_u32 m0, s95, 0x1c000
  s_nop 0
  buffer_load_dwordx4 v12, s[12:15], s61 offen lds
  s_add_u32 m0, s95, 0x1c400
  s_nop 0
  buffer_load_dwordx4 v13, s[12:15], s61 offen lds
  v_lshrrev_b32 v5, 4, v0
  v_and_b32 v2, 7, v0
  v_xor_b32 v2, v2, v5
  v_lshrrev_b32 v3, 1, v2
  v_xor_b32 v4, 2, v3
  v_mul_u32_u24 v3, s80, v3
  v_mul_u32_u24 v4, s80, v4
  v_and_b32 v2, 1, v2
  v_lshlrev_b32 v2, 4, v2
  v_add_u32 v3, v3, v2
  v_add_u32 v4, v4, v2
  s_lshl_b32 s62, s71, 5
  s_add_u32 s62, s62, s78
  v_lshrrev_b32 v2, 3, v0
  v_add_u32 v2, s62, v2
  v_mul_u32_u24 v2, s79, v2
  s_lshl_b32 s62, s79, 3
  s_lshl_b32 s63, s79, 4
  v_add_u32 v8, v2, v3
  v_add3_u32 v9, v2, v4, s62
  v_add_u32 v10, s63, v8
  v_add_u32 v11, s63, v9
  s_barrier
  s_mul_i32 s60, s85, 0
  s_add_u32 m0, s87, 0x0
  s_nop 0
  buffer_load_dwordx4 v8, s[8:11], s60 offen sc1 lds
  s_add_u32 m0, s87, 0x400
  s_nop 0
  buffer_load_dwordx4 v9, s[8:11], s60 offen sc1 lds
  s_add_u32 m0, s87, 0x800
  s_nop 0
  buffer_load_dwordx4 v10, s[8:11], s60 offen sc1 lds
  s_add_u32 m0, s87, 0xc00
  s_nop 0
  buffer_load_dwordx4 v11, s[8:11], s60 offen sc1 lds
  s_mul_i32 s60, s85, 1
  s_add_u32 m0, s87, 0x8000
  s_nop 0
  buffer_load_dwordx4 v8, s[8:11], s60 offen sc1 lds
  s_add_u32 m0, s87, 0x8400
  s_nop 0
  buffer_load_dwordx4 v9, s[8:11], s60 offen sc1 lds
  s_add_u32 m0, s87, 0x8800
  s_nop 0
  buffer_load_dwordx4 v10, s[8:11], s60 offen sc1 lds
  s_add_u32 m0, s87, 0x8c00
  s_nop 0
  buffer_load_dwordx4 v11, s[8:11], s60 offen sc1 lds
  s_mul_i32 s60, s85, 2
  s_add_u32 m0, s87, 0x10000
  s_nop 0
  buffer_load_dwordx4 v8, s[8:11], s60 offen sc1 lds
  s_add_u32 m0, s87, 0x10400
  s_nop 0
  buffer_load_dwordx4 v9, s[8:11], s60 offen sc1 lds
  s_add_u32 m0, s87, 0x10800
  s_nop 0
  buffer_load_dwordx4 v10, s[8:11], s60 offen sc1 lds
  s_add_u32 m0, s87, 0x10c00
  s_nop 0
  buffer_load_dwordx4 v11, s[8:11], s60 offen sc1 lds
  s_mul_i32 s60, s85, 3
  s_add_u32 m0, s87, 0x18000
  s_nop 0
  buffer_load_dwordx4 v8, s[8:11], s60 offen sc1 lds
  s_add_u32 m0, s87, 0x18400
  s_nop 0
  buffer_load_dwordx4 v9, s[8:11], s60 offen sc1 lds
  s_add_u32 m0, s87, 0x18800
  s_nop 0
  buffer_load_dwordx4 v10, s[8:11], s60 offen sc1 lds
  s_add_u32 m0, s87, 0x18c00
  s_nop 0
  buffer_load_dwordx4 v11, s[8:11], s60 offen sc1 lds
  s_waitcnt vmcnt(12)
  s_barrier
  s_waitcnt vmcnt(8)
  s_barrier
  s_mul_i32 s60, s85, 4
  s_add_u32 m0, s87, 0x0
  s_nop 0
  buffer_load_dwordx4 v8, s[8:11], s60 offen sc1 lds
  s_add_u32 m0, s87, 0x400
  s_nop 0
  buffer_load_dwordx4 v9, s[8:11], s60 offen sc1 lds
  s_add_u32 m0, s87, 0x800
  s_nop 0
  buffer_load_dwordx4 v10, s[8:11], s60 offen sc1 lds
  s_add_u32 m0, s87, 0xc00
  s_nop 0
  buffer_load_dwordx4 v11, s[8:11], s60 offen sc1 lds
  s_mul_i32 s61, s86, 4
  s_add_u32 m0, s95, 0x6000
  s_nop 0
  buffer_load_dwordx4 v12, s[12:15], s61 offen lds
  s_add_u32 m0, s95, 0x6400
  s_nop 0
  buffer_load_dwordx4 v13, s[12:15], s61 offen lds
  s_waitcnt vmcnt(10)
  s_barrier
  s_mul_i32 s60, s85, 5
  s_add_u32 m0, s87, 0x8000
  s_nop 0
  buffer_load_dwordx4 v8, s[8:11], s60 offen sc1 lds
  s_add_u32 m0, s87, 0x8400
  s_nop 0
  buffer_load_dwordx4 v9, s[8:11], s60 offen sc1 lds
  s_add_u32 m0, s87, 0x8800
  s_nop 0
  buffer_load_dwordx4 v10, s[8:11], s60 offen sc1 lds
  s_add_u32 m0, s87, 0x8c00
  s_nop 0
  buffer_load_dwordx4 v11, s[8:11], s60 offen sc1 lds
  s_mul_i32 s61, s86, 5
  s_add_u32 m0, s95, 0xe000
  s_nop 0
  buffer_load_dwordx4 v12, s[12:15], s61 offen lds
  s_add_u32 m0, s95, 0xe400
  s_nop 0
  buffer_load_dwordx4 v13, s[12:15], s61 offen lds
  s_waitcnt vmcnt(12)
  s_barrier
  s_mul_i32 s60, s85, 6
  s_add_u32 m0, s87, 0x10000
  s_nop 0
  buffer_load_dwordx4 v8, s[8:11], s60 offen sc1 lds
  s_add_u32 m0, s87, 0x10400
  s_nop 0
  buffer_load_dwordx4 v9, s[8:11], s60 offen sc1 lds
  s_add_u32 m0, s87, 0x10800
  s_nop 0
  buffer_load_dwordx4 v10, s[8:11], s60 offen sc1 lds
  s_add_u32 m0, s87, 0x10c00
  s_nop 0
  buffer_load_dwordx4 v11, s[8:11], s60 offen sc1 lds
  s_mul_i32 s61, s86, 6
  s_add_u32 m0, s95, 0x16000
  s_nop 0
  buffer_load_dwordx4 v12, s[12:15], s61 offen lds
  s_add_u32 m0, s95, 0x16400
  s_nop 0
  buffer_load_dwordx4 v13, s[12:15], s61 offen lds
  s_waitcnt vmcnt(12)
  s_barrier
  s_mul_i32 s60, s85, 7
  s_add_u32 m0, s87, 0x18000
  s_nop 0
  buffer_load_dwordx4 v8, s[8:11], s60 offen sc1 lds
  s_add_u32 m0, s87, 0x18400
  s_nop 0
  buffer_load_dwordx4 v9, s[8:11], s60 offen sc1 lds
  s_add_u32 m0, s87, 0x18800
  s_nop 0
  buffer_load_dwordx4 v10, s[8:11], s60 offen sc1 lds
  s_add_u32 m0, s87, 0x18c00
  s_nop 0
  buffer_load_dwordx4 v11, s[8:11], s60 offen sc1 lds
  s_mul_i32 s61, s86, 7
  s_add_u32 m0, s95, 0x1e000
  s_nop 0
  buffer_load_dwordx4 v12, s[12:15], s61 offen lds
  s_add_u32 m0, s95, 0x1e400
  s_nop 0
  buffer_load_dwordx4 v13, s[12:15], s61 offen lds
  s_waitcnt vmcnt(12)
  s_barrier
  s_waitcnt vmcnt(6)
  s_barrier
  s_waitcnt vmcnt(0)
  s_barrier
  s_barrier
L_p3skip_10:
  s_lshr_b32 s4, s2, 3
  s_lshr_b32 s4, s4, 2
  s_lshl_b32 s82, s4, 7
  v_bfe_u32 v3, v0, 4, 1
  v_bfe_u32 v4, v0, 1, 2
  v_xor_b32 v3, v3, v4
  v_lshlrev_b32 v3, 5, v3
  v_and_b32 v4, 1, v0
  v_lshl_add_u32 v3, v4, 4, v3
  v_xor_b32 v4, 64, v3
  s_lshl_b32 s62, s71, 5
  v_lshrrev_b32 v2, 3, v0
  v_add_u32 v2, s62, v2
  s_mov_b32 s62, 1024
  v_mul_u32_u24 v2, s62, v2
  v_add_u32 v2, s82, v2
  s_mov_b32 s62, 0
  v_add3_u32 v12, v2, v3, s62
  s_mov_b32 s62, 8192
  v_add3_u32 v13, v2, v4, s62
  s_mov_b32 s62, 16384
  v_add3_u32 v14, v2, v3, s62
  s_mov_b32 s62, 24576
  v_add3_u32 v15, v2, v4, s62
  s_mov_b32 s12, s40
  s_mov_b32 s13, s41
  s_mov_b32 s14, 0x80000
  s_mov_b32 s15, 0x00020000
  s_mov_b32 s61, 0
  s_add_u32 m0, s87, 0x4000
  s_nop 0
  buffer_load_dwordx4 v12, s[12:15], s61 offen lds
  s_add_u32 m0, s87, 0x4400
  s_nop 0
  buffer_load_dwordx4 v13, s[12:15], s61 offen lds
  s_add_u32 m0, s87, 0x4800
  s_nop 0
  buffer_load_dwordx4 v14, s[12:15], s61 offen lds
  s_add_u32 m0, s87, 0x4c00
  s_nop 0
  buffer_load_dwordx4 v15, s[12:15], s61 offen lds
  s_mov_b32 s61, 131072
  s_add_u32 m0, s87, 0xc000
  s_nop 0
  buffer_load_dwordx4 v12, s[12:15], s61 offen lds
  s_add_u32 m0, s87, 0xc400
  s_nop 0
  buffer_load_dwordx4 v13, s[12:15], s61 offen lds
  s_add_u32 m0, s87, 0xc800
  s_nop 0
  buffer_load_dwordx4 v14, s[12:15], s61 offen lds
  s_add_u32 m0, s87, 0xcc00
  s_nop 0
  buffer_load_dwordx4 v15, s[12:15], s61 offen lds
  s_mov_b32 s61, 262144
  s_add_u32 m0, s87, 0x14000
  s_nop 0
  buffer_load_dwordx4 v12, s[12:15], s61 offen lds
  s_add_u32 m0, s87, 0x14400
  s_nop 0
  buffer_load_dwordx4 v13, s[12:15], s61 offen lds
  s_add_u32 m0, s87, 0x14800
  s_nop 0
  buffer_load_dwordx4 v14, s[12:15], s61 offen lds
  s_add_u32 m0, s87, 0x14c00
  s_nop 0
  buffer_load_dwordx4 v15, s[12:15], s61 offen lds
  s_mov_b32 s61, 393216
  s_add_u32 m0, s87, 0x1c000
  s_nop 0
  buffer_load_dwordx4 v12, s[12:15], s61 offen lds
  s_add_u32 m0, s87, 0x1c400
  s_nop 0
  buffer_load_dwordx4 v13, s[12:15], s61 offen lds
  s_add_u32 m0, s87, 0x1c800
  s_nop 0
  buffer_load_dwordx4 v14, s[12:15], s61 offen lds
  s_add_u32 m0, s87, 0x1cc00
  s_nop 0
  buffer_load_dwordx4 v15, s[12:15], s61 offen lds
  s_and_b32 s4, s2, 7
  s_lshr_b32 s5, s2, 3
  s_lshl_b32 s6, s4, 2
  s_and_b32 s7, s5, 3
  s_add_u32 s32, s6, s7
  s_lshr_b32 s33, s5, 2
  s_mov_b32 s58, 0
  s_lshl_b32 s78, s32, 6
  v_lshrrev_b32 v5, 4, v0
  s_lshl_b32 s62, s71, 4
  s_add_u32 s62, s62, s78
  v_add_u32 v2, s62, v5
  s_mov_b32 s62, 32
  v_mul_u32_u24 v2, s62, v2
  s_mov_b32 s63, 65536
  v_and_b32 v3, 15, v0
  v_xor_b32 v3, v3, v5
  v_lshrrev_b32 v4, 1, v3
  v_mul_u32_u24 v4, s63, v4
  v_and_b32 v3, 1, v3
  v_lshl_add_u32 v4, v3, 4, v4
  s_mov_b32 s62, 0
  v_add3_u32 v8, v2, v4, s62
  v_and_b32 v3, 15, v0
  v_xor_b32 v3, v3, v5
  v_xor_b32 v3, 4, v3
  v_lshrrev_b32 v4, 1, v3
  v_mul_u32_u24 v4, s63, v4
  v_and_b32 v3, 1, v3
  v_lshl_add_u32 v4, v3, 4, v4
  s_mov_b32 s62, 128
  v_add3_u32 v9, v2, v4, s62
  v_and_b32 v3, 15, v0
  v_xor_b32 v3, v3, v5
  v_xor_b32 v3, 8, v3
  v_lshrrev_b32 v4, 1, v3
  v_mul_u32_u24 v4, s63, v4
  v_and_b32 v3, 1, v3
  v_lshl_add_u32 v4, v3, 4, v4
  s_mov_b32 s62, 256
  v_add3_u32 v10, v2, v4, s62
  v_and_b32 v3, 15, v0
  v_xor_b32 v3, v3, v5
  v_xor_b32 v3, 12, v3
  v_lshrrev_b32 v4, 1, v3
  v_mul_u32_u24 v4, s63, v4
  v_and_b32 v3, 1, v3
  v_lshl_add_u32 v4, v3, 4, v4
  s_mov_b32 s62, 384
  v_add3_u32 v11, v2, v4, s62
  v_lshrrev_b32 v5, 4, v0
  v_and_b32 v3, 15, v0
  v_xor_b32 v3, v3, v5
  v_lshlrev_b32 v3, 4, v3
  s_lshl_b32 s62, s71, 4
  s_add_u32 s62, s62, s78
  v_add_u32 v2, s62, v5
  s_mov_b32 s62, 2816
  v_mul_u32_u24 v2, s62, v2
  s_mov_b32 s62, 0
  v_add3_u32 v20, v2, v3, s62
  v_xor_b32 v4, 64, v3
  s_mov_b32 s62, 11264
  v_add3_u32 v21, v2, v4, s62
  v_xor_b32 v4, 128, v3
  s_mov_b32 s62, 22528
  v_add3_u32 v22, v2, v4, s62
  v_xor_b32 v4, 192, v3
  s_mov_b32 s62, 33792
  v_add3_u32 v23, v2, v4, s62
  s_add_u32 s8, s56, 0x300000
  s_addc_u32 s9, s57, 0
  s_mov_b32 s10, 0x200000
  s_mov_b32 s11, 0x00020000
  s_add_u32 s16, s56, 0x980000
  s_addc_u32 s17, s57, 0
  s_mov_b32 s18, 0x580000
  s_mov_b32 s19, 0x00020000
  s_mov_b32 s20, s50
  s_mov_b32 s21, s51
  s_mov_b32 s22, 0x158000
  s_mov_b32 s23, 0x00020000
  v_lshrrev_b32 v2, 3, v0
  v_and_b32 v3, 7, v0
  v_xor_b32 v3, v3, v2
  v_lshlrev_b32 v3, 4, v3
  s_lshl_b32 s4, s71, 4
  s_add_u32 s4, s4, s78
  v_add_u32 v2, s4, v2
  s_lshl_b32 s5, s33, 7
  v_add_u32 v3, s5, v3
  v_lshl_add_u32 v24, v2, 10, v3
  v_add_u32 v25, 8192, v24
  s_mov_b32 s5, 1152
  v_mad_u32_u24 v26, v2, s5, v3
  v_add_u32 v27, 9216, v26
  s_cmp_lg_u32 s71, 0
  s_cbranch_scc1 L_pbw_13
  s_lshr_b32 s5, s32, 1
  s_add_u32 s5, s5, 56
  s_lshl_b32 s89, s5, 8
  s_mov_b32 s28, s56
  s_mov_b32 s29, s57
  s_mov_b32 s30, 0x5800
  s_mov_b32 s31, 0x00020000
  v_mov_b32 v2, s89
  v_mov_b32 v3, 8
  s_mov_b32 s88, 0
L_poll_15:
  buffer_load_dword v4, v2, s[28:31], 0 offen sc1
  s_waitcnt vmcnt(0)
  v_cmp_lt_u32 vcc, v4, v3
  s_add_u32 s88, s88, 1
  s_cmp_ge_u32 s88, 200000
  s_cbranch_scc1 L_polled_16
  s_cbranch_vccz L_polled_16
  s_sleep 4
  s_branch L_poll_15
L_polled_16:
  v_mov_b32 v2, 0x22820
  v_mov_b32 v3, 1
  ds_write_b32 v2, v3
  s_branch L_pbd_14
L_pbw_13:
  v_mov_b32 v2, 0x22820
  s_mov_b32 s88, 0
L_pbs_17:
  ds_read_b32 v4, v2
  s_waitcnt lgkmcnt(0)
  v_readfirstlane_b32 s4, v4
  s_add_u32 s88, s88, 1
  s_cmp_ge_u32 s88, 1600000
  s_cbranch_scc1 L_pbd_14
  s_cmp_eq_u32 s4, 0
  s_cbranch_scc0 L_pbd_14
  s_sleep 1
  s_branch L_pbs_17
L_pbd_14:
  s_mov_b32 s60, 0
  s_add_u32 m0, s87, 0x0
  s_nop 0
  buffer_load_dwordx4 v8, s[8:11], s60 offen sc1 lds
  s_add_u32 m0, s87, 0x400
  s_nop 0
  buffer_load_dwordx4 v9, s[8:11], s60 offen sc1 lds
  s_add_u32 m0, s87, 0x800
  s_nop 0
  buffer_load_dwordx4 v10, s[8:11], s60 offen sc1 lds
  s_add_u32 m0, s87, 0xc00
  s_nop 0
  buffer_load_dwordx4 v11, s[8:11], s60 offen sc1 lds
  s_mov_b32 s60, 524288
  s_add_u32 m0, s87, 0x8000
  s_nop 0
  buffer_load_dwordx4 v8, s[8:11], s60 offen sc1 lds
  s_add_u32 m0, s87, 0x8400
  s_nop 0
  buffer_load_dwordx4 v9, s[8:11], s60 offen sc1 lds
  s_add_u32 m0, s87, 0x8800
  s_nop 0
  buffer_load_dwordx4 v10, s[8:11], s60 offen sc1 lds
  s_add_u32 m0, s87, 0x8c00
  s_nop 0
  buffer_load_dwordx4 v11, s[8:11], s60 offen sc1 lds
  s_mov_b32 s60, 1048576
  s_add_u32 m0, s87, 0x10000
  s_nop 0
  buffer_load_dwordx4 v8, s[8:11], s60 offen sc1 lds
  s_add_u32 m0, s87, 0x10400
  s_nop 0
  buffer_load_dwordx4 v9, s[8:11], s60 offen sc1 lds
  s_add_u32 m0, s87, 0x10800
  s_nop 0
  buffer_load_dwordx4 v10, s[8:11], s60 offen sc1 lds
  s_add_u32 m0, s87, 0x10c00
  s_nop 0
  buffer_load_dwordx4 v11, s[8:11], s60 offen sc1 lds
  s_mov_b32 s60, 1572864
  s_add_u32 m0, s87, 0x18000
  s_nop 0
  buffer_load_dwordx4 v8, s[8:11], s60 offen sc1 lds
  s_add_u32 m0, s87, 0x18400
  s_nop 0
  buffer_load_dwordx4 v9, s[8:11], s60 offen sc1 lds
  s_add_u32 m0, s87, 0x18800
  s_nop 0
  buffer_load_dwordx4 v10, s[8:11], s60 offen sc1 lds
  s_add_u32 m0, s87, 0x18c00
  s_nop 0
  buffer_load_dwordx4 v11, s[8:11], s60 offen sc1 lds
  s_waitcnt vmcnt(12)
  s_barrier
  s_waitcnt vmcnt(8)
  s_barrier
  v_add_u32 v16, 0x0, v12
  v_add_u32 v17, 0x0, v13
  v_add_u32 v18, 0x0, v14
  v_add_u32 v19, 0x0, v15
  s_add_u32 m0, s87, 0x4000
  s_nop 0
  buffer_load_dwordx4 v16, s[20:23], 0 offen lds
  s_add_u32 m0, s87, 0x4400
  s_nop 0
  buffer_load_dwordx4 v17, s[20:23], 0 offen lds
  s_add_u32 m0, s87, 0x4800
  s_nop 0
  buffer_load_dwordx4 v18, s[20:23], 0 offen lds
  s_add_u32 m0, s87, 0x4c00
  s_nop 0
  buffer_load_dwordx4 v19, s[20:23], 0 offen lds
  s_waitcnt vmcnt(8)
  s_barrier
  v_add_u32 v16, 0x20000, v12
  v_add_u32 v17, 0x20000, v13
  v_add_u32 v18, 0x20000, v14
  v_add_u32 v19, 0x20000, v15
  s_add_u32 m0, s87, 0xc000
  s_nop 0
  buffer_load_dwordx4 v16, s[20:23], 0 offen lds
  s_add_u32 m0, s87, 0xc400
  s_nop 0
  buffer_load_dwordx4 v17, s[20:23], 0 offen lds
  s_add_u32 m0, s87, 0xc800
  s_nop 0
  buffer_load_dwordx4 v18, s[20:23], 0 offen lds
  s_add_u32 m0, s87, 0xcc00
  s_nop 0
  buffer_load_dwordx4 v19, s[20:23], 0 offen lds
  s_waitcnt vmcnt(8)
  s_barrier
  v_add_u32 v16, 0x40000, v12
  v_add_u32 v17, 0x40000, v13
  v_add_u32 v18, 0x40000, v14
  v_add_u32 v19, 0x40000, v15
  s_add_u32 m0, s87, 0x14000
  s_nop 0
  buffer_load_dwordx4 v16, s[20:23], 0 offen lds
  s_add_u32 m0, s87, 0x14400
  s_nop 0
  buffer_load_dwordx4 v17, s[20:23], 0 offen lds
  s_add_u32 m0, s87, 0x14800
  s_nop 0
  buffer_load_dwordx4 v18, s[20:23], 0 offen lds
  s_add_u32 m0, s87, 0x14c00
  s_nop 0
  buffer_load_dwordx4 v19, s[20:23], 0 offen lds
  s_barrier
  v_add_u32 v16, 0x60000, v12
  v_add_u32 v17, 0x60000, v13
  v_add_u32 v18, 0x60000, v14
  v_add_u32 v19, 0x60000, v15
  s_add_u32 m0, s87, 0x1c000
  s_nop 0
  buffer_load_dwordx4 v16, s[20:23], 0 offen lds
  s_add_u32 m0, s87, 0x1c400
  s_nop 0
  buffer_load_dwordx4 v17, s[20:23], 0 offen lds
  s_add_u32 m0, s87, 0x1c800
  s_nop 0
  buffer_load_dwordx4 v18, s[20:23], 0 offen lds
  s_add_u32 m0, s87, 0x1cc00
  s_nop 0
  buffer_load_dwordx4 v19, s[20:23], 0 offen lds
  s_cmp_lg_u32 s71, 0
  s_cbranch_scc1 L_pbw_18
  s_lshr_b32 s5, s32, 1
  s_add_u32 s5, s5, 40
  s_lshl_b32 s89, s5, 8
  s_mov_b32 s28, s56
  s_mov_b32 s29, s57
  s_mov_b32 s30, 0x5800
  s_mov_b32 s31, 0x00020000
  v_mov_b32 v2, s89
  v_mov_b32 v3, 8
  s_mov_b32 s88, 0
L_poll_20:
  buffer_load_dword v4, v2, s[28:31], 0 offen sc1
  s_waitcnt vmcnt(0)
  v_cmp_lt_u32 vcc, v4, v3
  s_add_u32 s88, s88, 1
  s_cmp_ge_u32 s88, 200000
  s_cbranch_scc1 L_polled_21
  s_cbranch_vccz L_polled_21
  s_sleep 1
  s_branch L_poll_20
L_polled_21:
  v_mov_b32 v2, 0x22824
  v_mov_b32 v3, 1
  ds_write_b32 v2, v3
  s_branch L_pbd_19
L_pbw_18:
  v_mov_b32 v2, 0x22824
  s_mov_b32 s88, 0
L_pbs_22:
  ds_read_b32 v4, v2
  s_waitcnt lgkmcnt(0)
  v_readfirstlane_b32 s4, v4
  s_add_u32 s88, s88, 1
  s_cmp_ge_u32 s88, 1600000
  s_cbranch_scc1 L_pbd_19
  s_cmp_eq_u32 s4, 0
  s_cbranch_scc0 L_pbd_19
  s_sleep 1
  s_branch L_pbs_22
L_pbd_19:
  s_mov_b32 s60, 0
  s_add_u32 m0, s87, 0x0
  s_nop 0
  buffer_load_dwordx4 v20, s[16:19], s60 offen sc1 lds
  s_add_u32 m0, s87, 0x400
  s_nop 0
  buffer_load_dwordx4 v21, s[16:19], s60 offen sc1 lds
  s_add_u32 m0, s87, 0x800
  s_nop 0
  buffer_load_dwordx4 v22, s[16:19], s60 offen sc1 lds
  s_add_u32 m0, s87, 0xc00
  s_nop 0
  buffer_load_dwordx4 v23, s[16:19], s60 offen sc1 lds
  s_mov_b32 s60, 256
  s_add_u32 m0, s87, 0x8000
  s_nop 0
  buffer_load_dwordx4 v20, s[16:19], s60 offen sc1 lds
  s_add_u32 m0, s87, 0x8400
  s_nop 0
  buffer_load_dwordx4 v21, s[16:19], s60 offen sc1 lds
  s_add_u32 m0, s87, 0x8800
  s_nop 0
  buffer_load_dwordx4 v22, s[16:19], s60 offen sc1 lds
  s_add_u32 m0, s87, 0x8c00
  s_nop 0
  buffer_load_dwordx4 v23, s[16:19], s60 offen sc1 lds
  s_mov_b32 s60, 512
  s_add_u32 m0, s87, 0x10000
  s_nop 0
  buffer_load_dwordx4 v20, s[16:19], s60 offen sc1 lds
  s_add_u32 m0, s87, 0x10400
  s_nop 0
  buffer_load_dwordx4 v21, s[16:19], s60 offen sc1 lds
  s_add_u32 m0, s87, 0x10800
  s_nop 0
  buffer_load_dwordx4 v22, s[16:19], s60 offen sc1 lds
  s_add_u32 m0, s87, 0x10c00
  s_nop 0
  buffer_load_dwordx4 v23, s[16:19], s60 offen sc1 lds
  s_mov_b32 s60, 768
  s_add_u32 m0, s87, 0x18000
  s_nop 0
  buffer_load_dwordx4 v20, s[16:19], s60 offen sc1 lds
  s_add_u32 m0, s87, 0x18400
  s_nop 0
  buffer_load_dwordx4 v21, s[16:19], s60 offen sc1 lds
  s_add_u32 m0, s87, 0x18800
  s_nop 0
  buffer_load_dwordx4 v22, s[16:19], s60 offen sc1 lds
  s_add_u32 m0, s87, 0x18c00
  s_nop 0
  buffer_load_dwordx4 v23, s[16:19], s60 offen sc1 lds
  s_mov_b32 s24, s36
  s_mov_b32 s25, s37
  s_mov_b32 s26, 0x200000
  s_mov_b32 s27, 0x00020000
  s_add_u32 s28, s56, 0x740000
  s_addc_u32 s29, s57, 0
  s_mov_b32 s30, 0x240000
  s_mov_b32 s31, 0x00020000
  s_lshl_b32 s4, s71, 11
  s_add_u32 m0, s4, 0x22900
  s_nop 0
  buffer_load_dwordx4 v24, s[24:27], 0 offen lds
  s_lshl_b32 s4, s71, 11
  s_add_u32 m0, s4, 0x22d00
  s_nop 0
  buffer_load_dwordx4 v25, s[24:27], 0 offen lds
  s_lshl_b32 s4, s71, 11
  s_add_u32 m0, s4, 0x24900
  s_nop 0
  buffer_load_dwordx4 v26, s[28:31], 0 offen sc1 lds
  s_lshl_b32 s4, s71, 11
  s_add_u32 m0, s4, 0x24d00
  s_nop 0
  buffer_load_dwordx4 v27, s[28:31], 0 offen sc1 lds
  s_waitcnt vmcnt(16)
  s_barrier
  s_waitcnt vmcnt(12)
  s_barrier
  s_mov_b32 s28, s56
  s_mov_b32 s29, s57
  s_mov_b32 s30, 0x5800
  s_mov_b32 s31, 0x00020000
  s_lshr_b32 s5, s32, 1
  s_add_u32 s5, s5, 72
  s_lshl_b32 s5, s5, 8
  v_mov_b32 v2, s5
  buffer_load_dword v44, v2, s[28:31], 0 offen sc1
  s_mov_b32 s60, 1024
  s_add_u32 m0, s87, 0x0
  s_nop 0
  buffer_load_dwordx4 v20, s[16:19], s60 offen sc1 lds
  s_add_u32 m0, s87, 0x400
  s_nop 0
  buffer_load_dwordx4 v21, s[16:19], s60 offen sc1 lds
  s_add_u32 m0, s87, 0x800
  s_nop 0
  buffer_load_dwordx4 v22, s[16:19], s60 offen sc1 lds
  s_add_u32 m0, s87, 0xc00
  s_nop 0
  buffer_load_dwordx4 v23, s[16:19], s60 offen sc1 lds
  v_add_u32 v16, 0x80000, v12
  v_add_u32 v17, 0x80000, v13
  v_add_u32 v18, 0x80000, v14
  v_add_u32 v19, 0x80000, v15
  s_add_u32 m0, s87, 0x4000
  s_nop 0
  buffer_load_dwordx4 v16, s[20:23], 0 offen lds
  s_add_u32 m0, s87, 0x4400
  s_nop 0
  buffer_load_dwordx4 v17, s[20:23], 0 offen lds
  s_add_u32 m0, s87, 0x4800
  s_nop 0
  buffer_load_dwordx4 v18, s[20:23], 0 offen lds
  s_add_u32 m0, s87, 0x4c00
  s_nop 0
  buffer_load_dwordx4 v19, s[20:23], 0 offen lds
  s_waitcnt vmcnt(17)
  s_barrier
  s_mov_b32 s60, 1280
  s_add_u32 m0, s87, 0x8000
  s_nop 0
  buffer_load_dwordx4 v20, s[16:19], s60 offen sc1 lds
  s_add_u32 m0, s87, 0x8400
  s_nop 0
  buffer_load_dwordx4 v21, s[16:19], s60 offen sc1 lds
  s_add_u32 m0, s87, 0x8800
  s_nop 0
  buffer_load_dwordx4 v22, s[16:19], s60 offen sc1 lds
  s_add_u32 m0, s87, 0x8c00
  s_nop 0
  buffer_load_dwordx4 v23, s[16:19], s60 offen sc1 lds
  v_add_u32 v16, 0xa0000, v12
  v_add_u32 v17, 0xa0000, v13
  v_add_u32 v18, 0xa0000, v14
  v_add_u32 v19, 0xa0000, v15
  s_add_u32 m0, s87, 0xc000
  s_nop 0
  buffer_load_dwordx4 v16, s[20:23], 0 offen lds
  s_add_u32 m0, s87, 0xc400
  s_nop 0
  buffer_load_dwordx4 v17, s[20:23], 0 offen lds
  s_add_u32 m0, s87, 0xc800
  s_nop 0
  buffer_load_dwordx4 v18, s[20:23], 0 offen lds
  s_add_u32 m0, s87, 0xcc00
  s_nop 0
  buffer_load_dwordx4 v19, s[20:23], 0 offen lds
  s_waitcnt vmcnt(21)
  s_barrier
  s_mov_b32 s60, 1536
  s_add_u32 m0, s87, 0x10000
  s_nop 0
  buffer_load_dwordx4 v20, s[16:19], s60 offen sc1 lds
  s_add_u32 m0, s87, 0x10400
  s_nop 0
  buffer_load_dwordx4 v21, s[16:19], s60 offen sc1 lds
  s_add_u32 m0, s87, 0x10800
  s_nop 0
  buffer_load_dwordx4 v22, s[16:19], s60 offen sc1 lds
  s_add_u32 m0, s87, 0x10c00
  s_nop 0
  buffer_load_dwordx4 v23, s[16:19], s60 offen sc1 lds
  v_add_u32 v16, 0xc0000, v12
  v_add_u32 v17, 0xc0000, v13
  v_add_u32 v18, 0xc0000, v14
  v_add_u32 v19, 0xc0000, v15
  s_add_u32 m0, s87, 0x14000
  s_nop 0
  buffer_load_dwordx4 v16, s[20:23], 0 offen lds
  s_add_u32 m0, s87, 0x14400
  s_nop 0
  buffer_load_dwordx4 v17, s[20:23], 0 offen lds
  s_add_u32 m0, s87, 0x14800
  s_nop 0
  buffer_load_dwordx4 v18, s[20:23], 0 offen lds
  s_add_u32 m0, s87, 0x14c00
  s_nop 0
  buffer_load_dwordx4 v19, s[20:23], 0 offen lds
  s_waitcnt vmcnt(16)
  s_barrier
  s_mov_b32 s60, 1792
  s_add_u32 m0, s87, 0x18000
  s_nop 0
  buffer_load_dwordx4 v20, s[16:19], s60 offen sc1 lds
  s_add_u32 m0, s87, 0x18400
  s_nop 0
  buffer_load_dwordx4 v21, s[16:19], s60 offen sc1 lds
  s_add_u32 m0, s87, 0x18800
  s_nop 0
  buffer_load_dwordx4 v22, s[16:19], s60 offen sc1 lds
  s_add_u32 m0, s87, 0x18c00
  s_nop 0
  buffer_load_dwordx4 v23, s[16:19], s60 offen sc1 lds
  v_add_u32 v16, 0xe0000, v12
  v_add_u32 v17, 0xe0000, v13
  v_add_u32 v18, 0xe0000, v14
  v_add_u32 v19, 0xe0000, v15
  s_add_u32 m0, s87, 0x1c000
  s_nop 0
  buffer_load_dwordx4 v16, s[20:23], 0 offen lds
  s_add_u32 m0, s87, 0x1c400
  s_nop 0
  buffer_load_dwordx4 v17, s[20:23], 0 offen lds
  s_add_u32 m0, s87, 0x1c800
  s_nop 0
  buffer_load_dwordx4 v18, s[20:23], 0 offen lds
  s_add_u32 m0, s87, 0x1cc00
  s_nop 0
  buffer_load_dwordx4 v19, s[20:23], 0 offen lds
  s_waitcnt vmcnt(16)
  s_barrier
  v_cmp_gt_u32 vcc, 6, v44
  s_nop 1
  s_cbranch_vccz L_gaok_23
  s_lshr_b32 s5, s32, 1
  s_add_u32 s5, s5, 72
  s_lshl_b32 s89, s5, 8
  s_mov_b32 s28, s56
  s_mov_b32 s29, s57
  s_mov_b32 s30, 0x5800
  s_mov_b32 s31, 0x00020000
  v_mov_b32 v2, s89
  v_mov_b32 v3, 6
  s_mov_b32 s88, 0
L_poll_24:
  buffer_load_dword v4, v2, s[28:31], 0 offen sc1
  s_waitcnt vmcnt(0)
  v_cmp_lt_u32 vcc, v4, v3
  s_add_u32 s88, s88, 1
  s_cmp_ge_u32 s88, 200000
  s_cbranch_scc1 L_polled_25
  s_cbranch_vccz L_polled_25
  s_sleep 1
  s_branch L_poll_24
L_polled_25:
L_gaok_23:
  s_mov_b32 s60, 2048
  s_add_u32 m0, s87, 0x0
  s_nop 0
  buffer_load_dwordx4 v20, s[16:19], s60 offen sc1 lds
  s_add_u32 m0, s87, 0x400
  s_nop 0
  buffer_load_dwordx4 v21, s[16:19], s60 offen sc1 lds
  s_add_u32 m0, s87, 0x800
  s_nop 0
  buffer_load_dwordx4 v22, s[16:19], s60 offen sc1 lds
  s_add_u32 m0, s87, 0xc00
  s_nop 0
  buffer_load_dwordx4 v23, s[16:19], s60 offen sc1 lds
  v_add_u32 v16, 0x100000, v12
  v_add_u32 v17, 0x100000, v13
  v_add_u32 v18, 0x100000, v14
  v_add_u32 v19, 0x100000, v15
  s_add_u32 m0, s87, 0x4000
  s_nop 0
  buffer_load_dwordx4 v16, s[20:23], 0 offen lds
  s_add_u32 m0, s87, 0x4400
  s_nop 0
  buffer_load_dwordx4 v17, s[20:23], 0 offen lds
  s_add_u32 m0, s87, 0x4800
  s_nop 0
  buffer_load_dwordx4 v18, s[20:23], 0 offen lds
  s_add_u32 m0, s87, 0x4c00
  s_nop 0
  buffer_load_dwordx4 v19, s[20:23], 0 offen lds
  s_waitcnt vmcnt(16)
  s_barrier
  s_mov_b32 s60, 2304
  s_add_u32 m0, s87, 0x8000
  s_nop 0
  buffer_load_dwordx4 v20, s[16:19], s60 offen sc1 lds
  s_add_u32 m0, s87, 0x8400
  s_nop 0
  buffer_load_dwordx4 v21, s[16:19], s60 offen sc1 lds
  s_add_u32 m0, s87, 0x8800
  s_nop 0
  buffer_load_dwordx4 v22, s[16:19], s60 offen sc1 lds
  s_add_u32 m0, s87, 0x8c00
  s_nop 0
  buffer_load_dwordx4 v23, s[16:19], s60 offen sc1 lds
  v_add_u32 v16, 0x120000, v12
  v_add_u32 v17, 0x120000, v13
  v_add_u32 v18, 0x120000, v14
  v_add_u32 v19, 0x120000, v15
  s_add_u32 m0, s87, 0xc000
  s_nop 0
  buffer_load_dwordx4 v16, s[20:23], 0 offen lds
  s_add_u32 m0, s87, 0xc400
  s_nop 0
  buffer_load_dwordx4 v17, s[20:23], 0 offen lds
  s_add_u32 m0, s87, 0xc800
  s_nop 0
  buffer_load_dwordx4 v18, s[20:23], 0 offen lds
  s_add_u32 m0, s87, 0xcc00
  s_nop 0
  buffer_load_dwordx4 v19, s[20:23], 0 offen lds
  s_waitcnt vmcnt(16)
  s_barrier
  s_mov_b32 s60, 2560
  s_add_u32 m0, s87, 0x10000
  s_nop 0
  buffer_load_dwordx4 v20, s[16:19], s60 offen sc1 lds
  s_add_u32 m0, s87, 0x10400
  s_nop 0
  buffer_load_dwordx4 v21, s[16:19], s60 offen sc1 lds
  s_add_u32 m0, s87, 0x10800
  s_nop 0
  buffer_load_dwordx4 v22, s[16:19], s60 offen sc1 lds
  s_add_u32 m0, s87, 0x10c00
  s_nop 0
  buffer_load_dwordx4 v23, s[16:19], s60 offen sc1 lds
  v_add_u32 v16, 0x140000, v12
  v_add_u32 v17, 0x140000, v13
  v_add_u32 v18, 0x140000, v14
  v_add_u32 v19, 0x140000, v15
  s_add_u32 m0, s87, 0x14000
  s_nop 0
  buffer_load_dwordx4 v16, s[20:23], 0 offen lds
  s_add_u32 m0, s87, 0x14400
  s_nop 0
  buffer_load_dwordx4 v17, s[20:23], 0 offen lds
  s_add_u32 m0, s87, 0x14800
  s_nop 0
  buffer_load_dwordx4 v18, s[20:23], 0 offen lds
  s_add_u32 m0, s87, 0x14c00
  s_nop 0
  buffer_load_dwordx4 v19, s[20:23], 0 offen lds
  s_waitcnt vmcnt(16)
  s_barrier
  s_waitcnt vmcnt(8)
  s_barrier
  s_waitcnt vmcnt(0)
  s_barrier
  s_endpgm
cons:
  s_lshr_b32 s34, s3, 1
  s_and_b32 s35, s3, 1
  s_setprio 1
  s_cmp_lg_u32 s3, 0
  s_cbranch_scc1 L_lz_26
  v_lshlrev_b32 v2, 2, v0
  v_add_u32 v2, 0x22800, v2
  v_mov_b32 v3, 0
  s_mov_b32 exec_lo, 0xffff
  s_mov_b32 exec_hi, 0x0
  ds_write_b32 v2, v3
  s_mov_b64 exec, -1
L_lz_26:
  s_waitcnt lgkmcnt(0)
  s_or_b32 s4, s2, s3
  s_cmp_lg_u32 s4, 0
  s_cbranch_scc1 L_gz_27
  s_mov_b32 s28, s56
  s_mov_b32 s29, s57
  s_mov_b32 s30, 0x5800
  s_mov_b32 s31, 0x00020000
  v_lshlrev_b32 v2, 8, v0
  v_mov_b32 v3, 0
  buffer_store_dword v3, v2, s[28:31], 0 offen sc1
  v_add_u32 v2, 0x4000, v2
  buffer_store_dword v3, v2, s[28:31], 0 offen sc1
  s_mov_b32 s24, s54
  s_mov_b32 s25, s55
  s_mov_b32 s26, 0x100
  s_mov_b32 s27, 0x00020000
  s_waitcnt vmcnt(0)
  v_mov_b32 v2, 0
  v_mov_b32 v3, 1
  s_mov_b64 exec, 1
  buffer_store_dword v3, v2, s[24:27], 0 offen sc1
  s_mov_b64 exec, -1
L_gz_27:
  s_cmp_eq_u32 s94, 1
  s_cbranch_scc1 c_mix
  v_and_b32 v2, 15, v0
  v_lshrrev_b32 v3, 4, v0
  v_bfe_u32 v4, v0, 1, 3
  s_lshl_b32 s62, s34, 13
  s_lshl_b32 s63, s35, 12
  s_xor_b32 s64, s63, 0x1000
  s_add_u32 s63, s63, s62
  s_add_u32 s64, s64, s62
  v_xor_b32 v5, v3, v4
  v_lshlrev_b32 v5, 4, v5
  v_lshl_add_u32 v5, v2, 7, v5
  v_add_u32 v8, s63, v5
  v_xor_b32 v12, 64, v8
  v_add_u32 v9, 0x10000, v8
  v_add_u32 v13, 0x10000, v12
  v_add_u32 v10, s64, v5
  v_xor_b32 v14, 64, v10
  v_add_u32 v11, 0x10000, v10
  v_add_u32 v15, 0x10000, v14
  v_bfe_u32 v4, v0, 2, 2
  v_and_b32 v6, 1, v3
  v_lshl_or_b32 v6, v6, 2, v4
  v_lshl_add_u32 v7, v3, 3, v4
  v_lshlrev_b32 v7, 8, v7
  v_and_b32 v5, 3, v0
  v_lshl_add_u32 v7, v5, 3, v7
  v_add_u32 v7, 0x4000, v7
  s_lshl_b32 s62, s35, 2
  s_lshl_b32 s63, s34, 1
  s_add_u32 s62, s62, s63
  v_xor_b32 v5, s62, v6
  v_lshl_add_u32 v16, v5, 5, v7
  v_xor_b32 v18, 32, v16
  v_xor_b32 v20, 64, v16
  v_xor_b32 v22, 96, v16
  v_add_u32 v17, 0x10000, v16
  v_add_u32 v19, 0x10000, v18
  v_add_u32 v21, 0x10000, v20
  v_add_u32 v23, 0x10000, v22
  v_mov_b32 v176, 0x3f803f80
  v_mov_b32 v177, 0x3f803f80
  v_mov_b32 v178, 0x3f803f80
  v_mov_b32 v179, 0x3f803f80
  s_add_u32 s20, s56, 0x40000
  s_addc_u32 s21, s57, 0
  s_mov_b32 s22, 0x88000
  s_mov_b32 s23, 0x00020000
  s_barrier
  ds_read_b128 v[24:27], v8 offset:0
  ds_read_b64_tr_b16 v[40:41], v16 offset:0
  ds_read_b64_tr_b16 v[42:43], v16 offset:1024
  ds_read_b128 v[28:31], v8 offset:2048
  ds_read_b64_tr_b16 v[44:45], v18 offset:0
  ds_read_b64_tr_b16 v[46:47], v18 offset:1024
  ds_read_b128 v[32:35], v10 offset:0
  ds_read_b64_tr_b16 v[48:49], v20 offset:0
  ds_read_b64_tr_b16 v[50:51], v20 offset:1024
  ds_read_b128 v[36:39], v10 offset:2048
  ds_read_b64_tr_b16 v[52:53], v22 offset:0
  ds_read_b64_tr_b16 v[54:55], v22 offset:1024
  s_waitcnt lgkmcnt(0)
  v_mfma_f32_16x16x32_bf16 v[88:91], v[24:27], v[40:43], 0
  ds_read_b128 v[56:59], v12 offset:0
  v_mfma_f32_16x16x32_bf16 v[92:95], v[24:27], v[44:47], 0
  ds_read_b64_tr_b16 v[72:73], v16 offset:8192
  v_mfma_f32_16x16x32_bf16 v[96:99], v[24:27], v[48:51], 0
  ds_read_b64_tr_b16 v[74:75], v16 offset:9216
  v_mfma_f32_16x16x32_bf16 v[100:103], v[24:27], v[52:55], 0
  ds_read_b128 v[60:63], v12 offset:2048
  v_mfma_f32_16x16x32_bf16 v[104:107], v[28:31], v[40:43], 0
  ds_read_b64_tr_b16 v[76:77], v18 offset:8192
  v_mfma_f32_16x16x32_bf16 v[108:111], v[28:31], v[44:47], 0
  ds_read_b64_tr_b16 v[78:79], v18 offset:9216
  v_mfma_f32_16x16x32_bf16 v[112:115], v[28:31], v[48:51], 0
  ds_read_b128 v[64:67], v14 offset:0
  v_mfma_f32_16x16x32_bf16 v[116:119], v[28:31], v[52:55], 0
  ds_read_b64_tr_b16 v[80:81], v20 offset:8192
  v_mfma_f32_16x16x32_bf16 v[120:123], v[32:35], v[40:43], 0
  ds_read_b64_tr_b16 v[82:83], v20 offset:9216
  v_mfma_f32_16x16x32_bf16 v[124:127], v[32:35], v[44:47], 0
  ds_read_b128 v[68:71], v14 offset:2048
  v_mfma_f32_16x16x32_bf16 v[128:131], v[32:35], v[48:51], 0
  ds_read_b64_tr_b16 v[84:85], v22 offset:8192
  v_mfma_f32_16x16x32_bf16 v[132:135], v[32:35], v[52:55], 0
  ds_read_b64_tr_b16 v[86:87], v22 offset:9216
  v_mfma_f32_16x16x32_bf16 v[136:139], v[36:39], v[40:43], 0
  v_mfma_f32_16x16x32_bf16 v[140:143], v[36:39], v[44:47], 0
  v_mfma_f32_16x16x32_bf16 v[144:147], v[36:39], v[48:51], 0
  v_mfma_f32_16x16x32_bf16 v[148:151], v[36:39], v[52:55], 0
  v_mfma_f32_16x16x32_bf16 v[152:155], v[24:27], v[24:27], 0
  v_mfma_f32_16x16x32_bf16 v[160:163], v[176:179], v[24:27], 0
  v_mfma_f32_16x16x32_bf16 v[156:159], v[28:31], v[28:31], 0
  v_mfma_f32_16x16x32_bf16 v[164:167], v[176:179], v[28:31], 0
  v_mfma_f32_16x16x32_bf16 v[168:171], v[176:179], v[40:43], 0
  v_mfma_f32_16x16x32_bf16 v[172:175], v[176:179], v[44:47], 0
  s_waitcnt lgkmcnt(0)
  s_barrier
  v_mfma_f32_16x16x32_bf16 v[88:91], v[56:59], v[72:75], v[88:91]
  ds_read_b128 v[24:27], v8 offset:32768
  v_mfma_f32_16x16x32_bf16 v[92:95], v[56:59], v[76:79], v[92:95]
  ds_read_b64_tr_b16 v[40:41], v16 offset:32768
  v_mfma_f32_16x16x32_bf16 v[96:99], v[56:59], v[80:83], v[96:99]
  ds_read_b64_tr_b16 v[42:43], v16 offset:33792
  v_mfma_f32_16x16x32_bf16 v[100:103], v[56:59], v[84:87], v[100:103]
  ds_read_b128 v[28:31], v8 offset:34816
  v_mfma_f32_16x16x32_bf16 v[104:107], v[60:63], v[72:75], v[104:107]
  ds_read_b64_tr_b16 v[44:45], v18 offset:32768
  v_mfma_f32_16x16x32_bf16 v[108:111], v[60:63], v[76:79], v[108:111]
  ds_read_b64_tr_b16 v[46:47], v18 offset:33792
  v_mfma_f32_16x16x32_bf16 v[112:115], v[60:63], v[80:83], v[112:115]
  ds_read_b128 v[32:35], v10 offset:32768
  v_mfma_f32_16x16x32_bf16 v[116:119], v[60:63], v[84:87], v[116:119]
  ds_read_b64_tr_b16 v[48:49], v20 offset:32768
  v_mfma_f32_16x16x32_bf16 v[120:123], v[64:67], v[72:75], v[120:123]
  ds_read_b64_tr_b16 v[50:51], v20 offset:33792
  v_mfma_f32_16x16x32_bf16 v[124:127], v[64:67], v[76:79], v[124:127]
  ds_read_b128 v[36:39], v10 offset:34816
  v_mfma_f32_16x16x32_bf16 v[128:131], v[64:67], v[80:83], v[128:131]
  ds_read_b64_tr_b16 v[52:53], v22 offset:32768
  v_mfma_f32_16x16x32_bf16 v[132:135], v[64:67], v[84:87], v[132:135]
  ds_read_b64_tr_b16 v[54:55], v22 offset:33792
  v_mfma_f32_16x16x32_bf16 v[136:139], v[68:71], v[72:75], v[136:139]
  v_mfma_f32_16x16x32_bf16 v[140:143], v[68:71], v[76:79], v[140:143]
  v_mfma_f32_16x16x32_bf16 v[144:147], v[68:71], v[80:83], v[144:147]
  v_mfma_f32_16x16x32_bf16 v[148:151], v[68:71], v[84:87], v[148:151]
  v_mfma_f32_16x16x32_bf16 v[152:155], v[56:59], v[56:59], v[152:155]
  v_mfma_f32_16x16x32_bf16 v[160:163], v[176:179], v[56:59], v[160:163]
  v_mfma_f32_16x16x32_bf16 v[156:159], v[60:63], v[60:63], v[156:159]
  v_mfma_f32_16x16x32_bf16 v[164:167], v[176:179], v[60:63], v[164:167]
  v_mfma_f32_16x16x32_bf16 v[168:171], v[176:179], v[72:75], v[168:171]
  v_mfma_f32_16x16x32_bf16 v[172:175], v[176:179], v[76:79], v[172:175]
  s_waitcnt lgkmcnt(0)
  v_mfma_f32_16x16x32_bf16 v[88:91], v[24:27], v[40:43], v[88:91]
  ds_read_b128 v[56:59], v12 offset:32768
  v_mfma_f32_16x16x32_bf16 v[92:95], v[24:27], v[44:47], v[92:95]
  ds_read_b64_tr_b16 v[72:73], v16 offset:40960
  v_mfma_f32_16x16x32_bf16 v[96:99], v[24:27], v[48:51], v[96:99]
  ds_read_b64_tr_b16 v[74:75], v16 offset:41984
  v_mfma_f32_16x16x32_bf16 v[100:103], v[24:27], v[52:55], v[100:103]
  ds_read_b128 v[60:63], v12 offset:34816
  v_mfma_f32_16x16x32_bf16 v[104:107], v[28:31], v[40:43], v[104:107]
  ds_read_b64_tr_b16 v[76:77], v18 offset:40960
  v_mfma_f32_16x16x32_bf16 v[108:111], v[28:31], v[44:47], v[108:111]
  ds_read_b64_tr_b16 v[78:79], v18 offset:41984
  v_mfma_f32_16x16x32_bf16 v[112:115], v[28:31], v[48:51], v[112:115]
  ds_read_b128 v[64:67], v14 offset:32768
  v_mfma_f32_16x16x32_bf16 v[116:119], v[28:31], v[52:55], v[116:119]
  ds_read_b64_tr_b16 v[80:81], v20 offset:40960
  v_mfma_f32_16x16x32_bf16 v[120:123], v[32:35], v[40:43], v[120:123]
  ds_read_b64_tr_b16 v[82:83], v20 offset:41984
  v_mfma_f32_16x16x32_bf16 v[124:127], v[32:35], v[44:47], v[124:127]
  ds_read_b128 v[68:71], v14 offset:34816
  v_mfma_f32_16x16x32_bf16 v[128:131], v[32:35], v[48:51], v[128:131]
  ds_read_b64_tr_b16 v[84:85], v22 offset:40960
  v_mfma_f32_16x16x32_bf16 v[132:135], v[32:35], v[52:55], v[132:135]
  ds_read_b64_tr_b16 v[86:87], v22 offset:41984
  v_mfma_f32_16x16x32_bf16 v[136:139], v[36:39], v[40:43], v[136:139]
  v_mfma_f32_16x16x32_bf16 v[140:143], v[36:39], v[44:47], v[140:143]
  v_mfma_f32_16x16x32_bf16 v[144:147], v[36:39], v[48:51], v[144:147]
  v_mfma_f32_16x16x32_bf16 v[148:151], v[36:39], v[52:55], v[148:151]
  v_mfma_f32_16x16x32_bf16 v[152:155], v[24:27], v[24:27], v[152:155]
  v_mfma_f32_16x16x32_bf16 v[160:163], v[176:179], v[24:27], v[160:163]
  v_mfma_f32_16x16x32_bf16 v[156:159], v[28:31], v[28:31], v[156:159]
  v_mfma_f32_16x16x32_bf16 v[164:167], v[176:179], v[28:31], v[164:167]
  v_mfma_f32_16x16x32_bf16 v[168:171], v[176:179], v[40:43], v[168:171]
  v_mfma_f32_16x16x32_bf16 v[172:175], v[176:179], v[44:47], v[172:175]
  s_waitcnt lgkmcnt(0)
  s_barrier
  v_mfma_f32_16x16x32_bf16 v[88:91], v[56:59], v[72:75], v[88:91]
  ds_read_b128 v[24:27], v9 offset:0
  v_mfma_f32_16x16x32_bf16 v[92:95], v[56:59], v[76:79], v[92:95]
  ds_read_b64_tr_b16 v[40:41], v17 offset:0
  v_mfma_f32_16x16x32_bf16 v[96:99], v[56:59], v[80:83], v[96:99]
  ds_read_b64_tr_b16 v[42:43], v17 offset:1024
  v_mfma_f32_16x16x32_bf16 v[100:103], v[56:59], v[84:87], v[100:103]
  ds_read_b128 v[28:31], v9 offset:2048
  v_mfma_f32_16x16x32_bf16 v[104:107], v[60:63], v[72:75], v[104:107]
  ds_read_b64_tr_b16 v[44:45], v19 offset:0
  v_mfma_f32_16x16x32_bf16 v[108:111], v[60:63], v[76:79], v[108:111]
  ds_read_b64_tr_b16 v[46:47], v19 offset:1024
  v_mfma_f32_16x16x32_bf16 v[112:115], v[60:63], v[80:83], v[112:115]
  ds_read_b128 v[32:35], v11 offset:0
  v_mfma_f32_16x16x32_bf16 v[116:119], v[60:63], v[84:87], v[116:119]
  ds_read_b64_tr_b16 v[48:49], v21 offset:0
  v_mfma_f32_16x16x32_bf16 v[120:123], v[64:67], v[72:75], v[120:123]
  ds_read_b64_tr_b16 v[50:51], v21 offset:1024
  v_mfma_f32_16x16x32_bf16 v[124:127], v[64:67], v[76:79], v[124:127]
  ds_read_b128 v[36:39], v11 offset:2048
  v_mfma_f32_16x16x32_bf16 v[128:131], v[64:67], v[80:83], v[128:131]
  ds_read_b64_tr_b16 v[52:53], v23 offset:0
  v_mfma_f32_16x16x32_bf16 v[132:135], v[64:67], v[84:87], v[132:135]
  ds_read_b64_tr_b16 v[54:55], v23 offset:1024
  v_mfma_f32_16x16x32_bf16 v[136:139], v[68:71], v[72:75], v[136:139]
  v_mfma_f32_16x16x32_bf16 v[140:143], v[68:71], v[76:79], v[140:143]
  v_mfma_f32_16x16x32_bf16 v[144:147], v[68:71], v[80:83], v[144:147]
  v_mfma_f32_16x16x32_bf16 v[148:151], v[68:71], v[84:87], v[148:151]
  v_mfma_f32_16x16x32_bf16 v[152:155], v[56:59], v[56:59], v[152:155]
  v_mfma_f32_16x16x32_bf16 v[160:163], v[176:179], v[56:59], v[160:163]
  v_mfma_f32_16x16x32_bf16 v[156:159], v[60:63], v[60:63], v[156:159]
  v_mfma_f32_16x16x32_bf16 v[164:167], v[176:179], v[60:63], v[164:167]
  v_mfma_f32_16x16x32_bf16 v[168:171], v[176:179], v[72:75], v[168:171]
  v_mfma_f32_16x16x32_bf16 v[172:175], v[176:179], v[76:79], v[172:175]
  s_waitcnt lgkmcnt(0)
  v_mfma_f32_16x16x32_bf16 v[88:91], v[24:27], v[40:43], v[88:91]
  ds_read_b128 v[56:59], v13 offset:0
  v_mfma_f32_16x16x32_bf16 v[92:95], v[24:27], v[44:47], v[92:95]
  ds_read_b64_tr_b16 v[72:73], v17 offset:8192
  v_mfma_f32_16x16x32_bf16 v[96:99], v[24:27], v[48:51], v[96:99]
  ds_read_b64_tr_b16 v[74:75], v17 offset:9216
  v_mfma_f32_16x16x32_bf16 v[100:103], v[24:27], v[52:55], v[100:103]
  ds_read_b128 v[60:63], v13 offset:2048
  v_mfma_f32_16x16x32_bf16 v[104:107], v[28:31], v[40:43], v[104:107]
  ds_read_b64_tr_b16 v[76:77], v19 offset:8192
  v_mfma_f32_16x16x32_bf16 v[108:111], v[28:31], v[44:47], v[108:111]
  ds_read_b64_tr_b16 v[78:79], v19 offset:9216
  v_mfma_f32_16x16x32_bf16 v[112:115], v[28:31], v[48:51], v[112:115]
  ds_read_b128 v[64:67], v15 offset:0
  v_mfma_f32_16x16x32_bf16 v[116:119], v[28:31], v[52:55], v[116:119]
  ds_read_b64_tr_b16 v[80:81], v21 offset:8192
  v_mfma_f32_16x16x32_bf16 v[120:123], v[32:35], v[40:43], v[120:123]
  ds_read_b64_tr_b16 v[82:83], v21 offset:9216
  v_mfma_f32_16x16x32_bf16 v[124:127], v[32:35], v[44:47], v[124:127]
  ds_read_b128 v[68:71], v15 offset:2048
  v_mfma_f32_16x16x32_bf16 v[128:131], v[32:35], v[48:51], v[128:131]
  ds_read_b64_tr_b16 v[84:85], v23 offset:8192
  v_mfma_f32_16x16x32_bf16 v[132:135], v[32:35], v[52:55], v[132:135]
  ds_read_b64_tr_b16 v[86:87], v23 offset:9216
  v_mfma_f32_16x16x32_bf16 v[136:139], v[36:39], v[40:43], v[136:139]
  v_mfma_f32_16x16x32_bf16 v[140:143], v[36:39], v[44:47], v[140:143]
  v_mfma_f32_16x16x32_bf16 v[144:147], v[36:39], v[48:51], v[144:147]
  v_mfma_f32_16x16x32_bf16 v[148:151], v[36:39], v[52:55], v[148:151]
  v_mfma_f32_16x16x32_bf16 v[152:155], v[24:27], v[24:27], v[152:155]
  v_mfma_f32_16x16x32_bf16 v[160:163], v[176:179], v[24:27], v[160:163]
  v_mfma_f32_16x16x32_bf16 v[156:159], v[28:31], v[28:31], v[156:159]
  v_mfma_f32_16x16x32_bf16 v[164:167], v[176:179], v[28:31], v[164:167]
  v_mfma_f32_16x16x32_bf16 v[168:171], v[176:179], v[40:43], v[168:171]
  v_mfma_f32_16x16x32_bf16 v[172:175], v[176:179], v[44:47], v[172:175]
  s_waitcnt lgkmcnt(0)
  s_barrier
  v_mfma_f32_16x16x32_bf16 v[88:91], v[56:59], v[72:75], v[88:91]
  ds_read_b128 v[24:27], v9 offset:32768
  v_mfma_f32_16x16x32_bf16 v[92:95], v[56:59], v[76:79], v[92:95]
  ds_read_b64_tr_b16 v[40:41], v17 offset:32768
  v_mfma_f32_16x16x32_bf16 v[96:99], v[56:59], v[80:83], v[96:99]
  ds_read_b64_tr_b16 v[42:43], v17 offset:33792
  v_mfma_f32_16x16x32_bf16 v[100:103], v[56:59], v[84:87], v[100:103]
  ds_read_b128 v[28:31], v9 offset:34816
  v_mfma_f32_16x16x32_bf16 v[104:107], v[60:63], v[72:75], v[104:107]
  ds_read_b64_tr_b16 v[44:45], v19 offset:32768
  v_mfma_f32_16x16x32_bf16 v[108:111], v[60:63], v[76:79], v[108:111]
  ds_read_b64_tr_b16 v[46:47], v19 offset:33792
  v_mfma_f32_16x16x32_bf16 v[112:115], v[60:63], v[80:83], v[112:115]
  ds_read_b128 v[32:35], v11 offset:32768
  v_mfma_f32_16x16x32_bf16 v[116:119], v[60:63], v[84:87], v[116:119]
  ds_read_b64_tr_b16 v[48:49], v21 offset:32768
  v_mfma_f32_16x16x32_bf16 v[120:123], v[64:67], v[72:75], v[120:123]
  ds_read_b64_tr_b16 v[50:51], v21 offset:33792
  v_mfma_f32_16x16x32_bf16 v[124:127], v[64:67], v[76:79], v[124:127]
  ds_read_b128 v[36:39], v11 offset:34816
  v_mfma_f32_16x16x32_bf16 v[128:131], v[64:67], v[80:83], v[128:131]
  ds_read_b64_tr_b16 v[52:53], v23 offset:32768
  v_mfma_f32_16x16x32_bf16 v[132:135], v[64:67], v[84:87], v[132:135]
  ds_read_b64_tr_b16 v[54:55], v23 offset:33792
  v_mfma_f32_16x16x32_bf16 v[136:139], v[68:71], v[72:75], v[136:139]
  v_mfma_f32_16x16x32_bf16 v[140:143], v[68:71], v[76:79], v[140:143]
  v_mfma_f32_16x16x32_bf16 v[144:147], v[68:71], v[80:83], v[144:147]
  v_mfma_f32_16x16x32_bf16 v[148:151], v[68:71], v[84:87], v[148:151]
  v_mfma_f32_16x16x32_bf16 v[152:155], v[56:59], v[56:59], v[152:155]
  v_mfma_f32_16x16x32_bf16 v[160:163], v[176:179], v[56:59], v[160:163]
  v_mfma_f32_16x16x32_bf16 v[156:159], v[60:63], v[60:63], v[156:159]
  v_mfma_f32_16x16x32_bf16 v[164:167], v[176:179], v[60:63], v[164:167]
  v_mfma_f32_16x16x32_bf16 v[168:171], v[176:179], v[72:75], v[168:171]
  v_mfma_f32_16x16x32_bf16 v[172:175], v[176:179], v[76:79], v[172:175]
  s_waitcnt lgkmcnt(0)
  v_mfma_f32_16x16x32_bf16 v[88:91], v[24:27], v[40:43], v[88:91]
  ds_read_b128 v[56:59], v13 offset:32768
  v_mfma_f32_16x16x32_bf16 v[92:95], v[24:27], v[44:47], v[92:95]
  ds_read_b64_tr_b16 v[72:73], v17 offset:40960
  v_mfma_f32_16x16x32_bf16 v[96:99], v[24:27], v[48:51], v[96:99]
  ds_read_b64_tr_b16 v[74:75], v17 offset:41984
  v_mfma_f32_16x16x32_bf16 v[100:103], v[24:27], v[52:55], v[100:103]
  ds_read_b128 v[60:63], v13 offset:34816
  v_mfma_f32_16x16x32_bf16 v[104:107], v[28:31], v[40:43], v[104:107]
  ds_read_b64_tr_b16 v[76:77], v19 offset:40960
  v_mfma_f32_16x16x32_bf16 v[108:111], v[28:31], v[44:47], v[108:111]
  ds_read_b64_tr_b16 v[78:79], v19 offset:41984
  v_mfma_f32_16x16x32_bf16 v[112:115], v[28:31], v[48:51], v[112:115]
  ds_read_b128 v[64:67], v15 offset:32768
  v_mfma_f32_16x16x32_bf16 v[116:119], v[28:31], v[52:55], v[116:119]
  ds_read_b64_tr_b16 v[80:81], v21 offset:40960
  v_mfma_f32_16x16x32_bf16 v[120:123], v[32:35], v[40:43], v[120:123]
  ds_read_b64_tr_b16 v[82:83], v21 offset:41984
  v_mfma_f32_16x16x32_bf16 v[124:127], v[32:35], v[44:47], v[124:127]
  ds_read_b128 v[68:71], v15 offset:34816
  v_mfma_f32_16x16x32_bf16 v[128:131], v[32:35], v[48:51], v[128:131]
  ds_read_b64_tr_b16 v[84:85], v23 offset:40960
  v_mfma_f32_16x16x32_bf16 v[132:135], v[32:35], v[52:55], v[132:135]
  ds_read_b64_tr_b16 v[86:87], v23 offset:41984
  v_mfma_f32_16x16x32_bf16 v[136:139], v[36:39], v[40:43], v[136:139]
  v_mfma_f32_16x16x32_bf16 v[140:143], v[36:39], v[44:47], v[140:143]
  v_mfma_f32_16x16x32_bf16 v[144:147], v[36:39], v[48:51], v[144:147]
  v_mfma_f32_16x16x32_bf16 v[148:151], v[36:39], v[52:55], v[148:151]
  v_mfma_f32_16x16x32_bf16 v[152:155], v[24:27], v[24:27], v[152:155]
  v_mfma_f32_16x16x32_bf16 v[160:163], v[176:179], v[24:27], v[160:163]
  v_mfma_f32_16x16x32_bf16 v[156:159], v[28:31], v[28:31], v[156:159]
  v_mfma_f32_16x16x32_bf16 v[164:167], v[176:179], v[28:31], v[164:167]
  v_mfma_f32_16x16x32_bf16 v[168:171], v[176:179], v[40:43], v[168:171]
  v_mfma_f32_16x16x32_bf16 v[172:175], v[176:179], v[44:47], v[172:175]
  s_waitcnt lgkmcnt(0)
  s_barrier
  v_mfma_f32_16x16x32_bf16 v[88:91], v[56:59], v[72:75], v[88:91]
  ds_read_b128 v[24:27], v8 offset:0
  v_mfma_f32_16x16x32_bf16 v[92:95], v[56:59], v[76:79], v[92:95]
  ds_read_b64_tr_b16 v[40:41], v16 offset:0
  v_mfma_f32_16x16x32_bf16 v[96:99], v[56:59], v[80:83], v[96:99]
  ds_read_b64_tr_b16 v[42:43], v16 offset:1024
  v_mfma_f32_16x16x32_bf16 v[100:103], v[56:59], v[84:87], v[100:103]
  ds_read_b128 v[28:31], v8 offset:2048
  v_mfma_f32_16x16x32_bf16 v[104:107], v[60:63], v[72:75], v[104:107]
  ds_read_b64_tr_b16 v[44:45], v18 offset:0
  v_mfma_f32_16x16x32_bf16 v[108:111], v[60:63], v[76:79], v[108:111]
  ds_read_b64_tr_b16 v[46:47], v18 offset:1024
  v_mfma_f32_16x16x32_bf16 v[112:115], v[60:63], v[80:83], v[112:115]
  ds_read_b128 v[32:35], v10 offset:0
  v_mfma_f32_16x16x32_bf16 v[116:119], v[60:63], v[84:87], v[116:119]
  ds_read_b64_tr_b16 v[48:49], v20 offset:0
  v_mfma_f32_16x16x32_bf16 v[120:123], v[64:67], v[72:75], v[120:123]
  ds_read_b64_tr_b16 v[50:51], v20 offset:1024
  v_mfma_f32_16x16x32_bf16 v[124:127], v[64:67], v[76:79], v[124:127]
  ds_read_b128 v[36:39], v10 offset:2048
  v_mfma_f32_16x16x32_bf16 v[128:131], v[64:67], v[80:83], v[128:131]
  ds_read_b64_tr_b16 v[52:53], v22 offset:0
  v_mfma_f32_16x16x32_bf16 v[132:135], v[64:67], v[84:87], v[132:135]
  ds_read_b64_tr_b16 v[54:55], v22 offset:1024
  v_mfma_f32_16x16x32_bf16 v[136:139], v[68:71], v[72:75], v[136:139]
  v_mfma_f32_16x16x32_bf16 v[140:143], v[68:71], v[76:79], v[140:143]
  v_mfma_f32_16x16x32_bf16 v[144:147], v[68:71], v[80:83], v[144:147]
  v_mfma_f32_16x16x32_bf16 v[148:151], v[68:71], v[84:87], v[148:151]
  v_mfma_f32_16x16x32_bf16 v[152:155], v[56:59], v[56:59], v[152:155]
  v_mfma_f32_16x16x32_bf16 v[160:163], v[176:179], v[56:59], v[160:163]
  v_mfma_f32_16x16x32_bf16 v[156:159], v[60:63], v[60:63], v[156:159]
  v_mfma_f32_16x16x32_bf16 v[164:167], v[176:179], v[60:63], v[164:167]
  v_mfma_f32_16x16x32_bf16 v[168:171], v[176:179], v[72:75], v[168:171]
  v_mfma_f32_16x16x32_bf16 v[172:175], v[176:179], v[76:79], v[172:175]
  s_waitcnt lgkmcnt(0)
  v_mfma_f32_16x16x32_bf16 v[88:91], v[24:27], v[40:43], v[88:91]
  ds_read_b128 v[56:59], v12 offset:0
  v_mfma_f32_16x16x32_bf16 v[92:95], v[24:27], v[44:47], v[92:95]
  ds_read_b64_tr_b16 v[72:73], v16 offset:8192
  v_mfma_f32_16x16x32_bf16 v[96:99], v[24:27], v[48:51], v[96:99]
  ds_read_b64_tr_b16 v[74:75], v16 offset:9216
  v_mfma_f32_16x16x32_bf16 v[100:103], v[24:27], v[52:55], v[100:103]
  ds_read_b128 v[60:63], v12 offset:2048
  v_mfma_f32_16x16x32_bf16 v[104:107], v[28:31], v[40:43], v[104:107]
  ds_read_b64_tr_b16 v[76:77], v18 offset:8192
  v_mfma_f32_16x16x32_bf16 v[108:111], v[28:31], v[44:47], v[108:111]
  ds_read_b64_tr_b16 v[78:79], v18 offset:9216
  v_mfma_f32_16x16x32_bf16 v[112:115], v[28:31], v[48:51], v[112:115]
  ds_read_b128 v[64:67], v14 offset:0
  v_mfma_f32_16x16x32_bf16 v[116:119], v[28:31], v[52:55], v[116:119]
  ds_read_b64_tr_b16 v[80:81], v20 offset:8192
  v_mfma_f32_16x16x32_bf16 v[120:123], v[32:35], v[40:43], v[120:123]
  ds_read_b64_tr_b16 v[82:83], v20 offset:9216
  v_mfma_f32_16x16x32_bf16 v[124:127], v[32:35], v[44:47], v[124:127]
  ds_read_b128 v[68:71], v14 offset:2048
  v_mfma_f32_16x16x32_bf16 v[128:131], v[32:35], v[48:51], v[128:131]
  ds_read_b64_tr_b16 v[84:85], v22 offset:8192
  v_mfma_f32_16x16x32_bf16 v[132:135], v[32:35], v[52:55], v[132:135]
  ds_read_b64_tr_b16 v[86:87], v22 offset:9216
  v_mfma_f32_16x16x32_bf16 v[136:139], v[36:39], v[40:43], v[136:139]
  v_mfma_f32_16x16x32_bf16 v[140:143], v[36:39], v[44:47], v[140:143]
  v_mfma_f32_16x16x32_bf16 v[144:147], v[36:39], v[48:51], v[144:147]
  v_mfma_f32_16x16x32_bf16 v[148:151], v[36:39], v[52:55], v[148:151]
  v_mfma_f32_16x16x32_bf16 v[152:155], v[24:27], v[24:27], v[152:155]
  v_mfma_f32_16x16x32_bf16 v[160:163], v[176:179], v[24:27], v[160:163]
  v_mfma_f32_16x16x32_bf16 v[156:159], v[28:31], v[28:31], v[156:159]
  v_mfma_f32_16x16x32_bf16 v[164:167], v[176:179], v[28:31], v[164:167]
  v_mfma_f32_16x16x32_bf16 v[168:171], v[176:179], v[40:43], v[168:171]
  v_mfma_f32_16x16x32_bf16 v[172:175], v[176:179], v[44:47], v[172:175]
  s_waitcnt lgkmcnt(0)
  s_barrier
  v_mfma_f32_16x16x32_bf16 v[88:91], v[56:59], v[72:75], v[88:91]
  ds_read_b128 v[24:27], v8 offset:32768
  v_mfma_f32_16x16x32_bf16 v[92:95], v[56:59], v[76:79], v[92:95]
  ds_read_b64_tr_b16 v[40:41], v16 offset:32768
  v_mfma_f32_16x16x32_bf16 v[96:99], v[56:59], v[80:83], v[96:99]
  ds_read_b64_tr_b16 v[42:43], v16 offset:33792
  v_mfma_f32_16x16x32_bf16 v[100:103], v[56:59], v[84:87], v[100:103]
  ds_read_b128 v[28:31], v8 offset:34816
  v_mfma_f32_16x16x32_bf16 v[104:107], v[60:63], v[72:75], v[104:107]
  ds_read_b64_tr_b16 v[44:45], v18 offset:32768
  v_mfma_f32_16x16x32_bf16 v[108:111], v[60:63], v[76:79], v[108:111]
  ds_read_b64_tr_b16 v[46:47], v18 offset:33792
  v_mfma_f32_16x16x32_bf16 v[112:115], v[60:63], v[80:83], v[112:115]
  ds_read_b128 v[32:35], v10 offset:32768
  v_mfma_f32_16x16x32_bf16 v[116:119], v[60:63], v[84:87], v[116:119]
  ds_read_b64_tr_b16 v[48:49], v20 offset:32768
  v_mfma_f32_16x16x32_bf16 v[120:123], v[64:67], v[72:75], v[120:123]
  ds_read_b64_tr_b16 v[50:51], v20 offset:33792
  v_mfma_f32_16x16x32_bf16 v[124:127], v[64:67], v[76:79], v[124:127]
  ds_read_b128 v[36:39], v10 offset:34816
  v_mfma_f32_16x16x32_bf16 v[128:131], v[64:67], v[80:83], v[128:131]
  ds_read_b64_tr_b16 v[52:53], v22 offset:32768
  v_mfma_f32_16x16x32_bf16 v[132:135], v[64:67], v[84:87], v[132:135]
  ds_read_b64_tr_b16 v[54:55], v22 offset:33792
  v_mfma_f32_16x16x32_bf16 v[136:139], v[68:71], v[72:75], v[136:139]
  v_mfma_f32_16x16x32_bf16 v[140:143], v[68:71], v[76:79], v[140:143]
  v_mfma_f32_16x16x32_bf16 v[144:147], v[68:71], v[80:83], v[144:147]
  v_mfma_f32_16x16x32_bf16 v[148:151], v[68:71], v[84:87], v[148:151]
  v_mfma_f32_16x16x32_bf16 v[152:155], v[56:59], v[56:59], v[152:155]
  v_mfma_f32_16x16x32_bf16 v[160:163], v[176:179], v[56:59], v[160:163]
  v_mfma_f32_16x16x32_bf16 v[156:159], v[60:63], v[60:63], v[156:159]
  v_mfma_f32_16x16x32_bf16 v[164:167], v[176:179], v[60:63], v[164:167]
  v_mfma_f32_16x16x32_bf16 v[168:171], v[176:179], v[72:75], v[168:171]
  v_mfma_f32_16x16x32_bf16 v[172:175], v[176:179], v[76:79], v[172:175]
  s_waitcnt lgkmcnt(0)
  v_mfma_f32_16x16x32_bf16 v[88:91], v[24:27], v[40:43], v[88:91]
  ds_read_b128 v[56:59], v12 offset:32768
  v_mfma_f32_16x16x32_bf16 v[92:95], v[24:27], v[44:47], v[92:95]
  ds_read_b64_tr_b16 v[72:73], v16 offset:40960
  v_mfma_f32_16x16x32_bf16 v[96:99], v[24:27], v[48:51], v[96:99]
  ds_read_b64_tr_b16 v[74:75], v16 offset:41984
  v_mfma_f32_16x16x32_bf16 v[100:103], v[24:27], v[52:55], v[100:103]
  ds_read_b128 v[60:63], v12 offset:34816
  v_mfma_f32_16x16x32_bf16 v[104:107], v[28:31], v[40:43], v[104:107]
  ds_read_b64_tr_b16 v[76:77], v18 offset:40960
  v_mfma_f32_16x16x32_bf16 v[108:111], v[28:31], v[44:47], v[108:111]
  ds_read_b64_tr_b16 v[78:79], v18 offset:41984
  v_mfma_f32_16x16x32_bf16 v[112:115], v[28:31], v[48:51], v[112:115]
  ds_read_b128 v[64:67], v14 offset:32768
  v_mfma_f32_16x16x32_bf16 v[116:119], v[28:31], v[52:55], v[116:119]
  ds_read_b64_tr_b16 v[80:81], v20 offset:40960
  v_mfma_f32_16x16x32_bf16 v[120:123], v[32:35], v[40:43], v[120:123]
  ds_read_b64_tr_b16 v[82:83], v20 offset:41984
  v_mfma_f32_16x16x32_bf16 v[124:127], v[32:35], v[44:47], v[124:127]
  ds_read_b128 v[68:71], v14 offset:34816
  v_mfma_f32_16x16x32_bf16 v[128:131], v[32:35], v[48:51], v[128:131]
  ds_read_b64_tr_b16 v[84:85], v22 offset:40960
  v_mfma_f32_16x16x32_bf16 v[132:135], v[32:35], v[52:55], v[132:135]
  ds_read_b64_tr_b16 v[86:87], v22 offset:41984
  v_mfma_f32_16x16x32_bf16 v[136:139], v[36:39], v[40:43], v[136:139]
  v_mfma_f32_16x16x32_bf16 v[140:143], v[36:39], v[44:47], v[140:143]
  v_mfma_f32_16x16x32_bf16 v[144:147], v[36:39], v[48:51], v[144:147]
  v_mfma_f32_16x16x32_bf16 v[148:151], v[36:39], v[52:55], v[148:151]
  v_mfma_f32_16x16x32_bf16 v[152:155], v[24:27], v[24:27], v[152:155]
  v_mfma_f32_16x16x32_bf16 v[160:163], v[176:179], v[24:27], v[160:163]
  v_mfma_f32_16x16x32_bf16 v[156:159], v[28:31], v[28:31], v[156:159]
  v_mfma_f32_16x16x32_bf16 v[164:167], v[176:179], v[28:31], v[164:167]
  v_mfma_f32_16x16x32_bf16 v[168:171], v[176:179], v[40:43], v[168:171]
  v_mfma_f32_16x16x32_bf16 v[172:175], v[176:179], v[44:47], v[172:175]
  s_waitcnt lgkmcnt(0)
  s_barrier
  v_mfma_f32_16x16x32_bf16 v[88:91], v[56:59], v[72:75], v[88:91]
  ds_read_b128 v[24:27], v9 offset:0
  v_mfma_f32_16x16x32_bf16 v[92:95], v[56:59], v[76:79], v[92:95]
  ds_read_b64_tr_b16 v[40:41], v17 offset:0
  v_mfma_f32_16x16x32_bf16 v[96:99], v[56:59], v[80:83], v[96:99]
  ds_read_b64_tr_b16 v[42:43], v17 offset:1024
  v_mfma_f32_16x16x32_bf16 v[100:103], v[56:59], v[84:87], v[100:103]
  ds_read_b128 v[28:31], v9 offset:2048
  v_mfma_f32_16x16x32_bf16 v[104:107], v[60:63], v[72:75], v[104:107]
  ds_read_b64_tr_b16 v[44:45], v19 offset:0
  v_mfma_f32_16x16x32_bf16 v[108:111], v[60:63], v[76:79], v[108:111]
  ds_read_b64_tr_b16 v[46:47], v19 offset:1024
  v_mfma_f32_16x16x32_bf16 v[112:115], v[60:63], v[80:83], v[112:115]
  ds_read_b128 v[32:35], v11 offset:0
  v_mfma_f32_16x16x32_bf16 v[116:119], v[60:63], v[84:87], v[116:119]
  ds_read_b64_tr_b16 v[48:49], v21 offset:0
  v_mfma_f32_16x16x32_bf16 v[120:123], v[64:67], v[72:75], v[120:123]
  ds_read_b64_tr_b16 v[50:51], v21 offset:1024
  v_mfma_f32_16x16x32_bf16 v[124:127], v[64:67], v[76:79], v[124:127]
  ds_read_b128 v[36:39], v11 offset:2048
  v_mfma_f32_16x16x32_bf16 v[128:131], v[64:67], v[80:83], v[128:131]
  ds_read_b64_tr_b16 v[52:53], v23 offset:0
  v_mfma_f32_16x16x32_bf16 v[132:135], v[64:67], v[84:87], v[132:135]
  ds_read_b64_tr_b16 v[54:55], v23 offset:1024
  v_mfma_f32_16x16x32_bf16 v[136:139], v[68:71], v[72:75], v[136:139]
  v_mfma_f32_16x16x32_bf16 v[140:143], v[68:71], v[76:79], v[140:143]
  v_mfma_f32_16x16x32_bf16 v[144:147], v[68:71], v[80:83], v[144:147]
  v_mfma_f32_16x16x32_bf16 v[148:151], v[68:71], v[84:87], v[148:151]
  v_mfma_f32_16x16x32_bf16 v[152:155], v[56:59], v[56:59], v[152:155]
  v_mfma_f32_16x16x32_bf16 v[160:163], v[176:179], v[56:59], v[160:163]
  v_mfma_f32_16x16x32_bf16 v[156:159], v[60:63], v[60:63], v[156:159]
  v_mfma_f32_16x16x32_bf16 v[164:167], v[176:179], v[60:63], v[164:167]
  v_mfma_f32_16x16x32_bf16 v[168:171], v[176:179], v[72:75], v[168:171]
  v_mfma_f32_16x16x32_bf16 v[172:175], v[176:179], v[76:79], v[172:175]
  s_waitcnt lgkmcnt(0)
  v_mfma_f32_16x16x32_bf16 v[88:91], v[24:27], v[40:43], v[88:91]
  ds_read_b128 v[56:59], v13 offset:0
  v_mfma_f32_16x16x32_bf16 v[92:95], v[24:27], v[44:47], v[92:95]
  ds_read_b64_tr_b16 v[72:73], v17 offset:8192
  v_mfma_f32_16x16x32_bf16 v[96:99], v[24:27], v[48:51], v[96:99]
  ds_read_b64_tr_b16 v[74:75], v17 offset:9216
  v_mfma_f32_16x16x32_bf16 v[100:103], v[24:27], v[52:55], v[100:103]
  ds_read_b128 v[60:63], v13 offset:2048
  v_mfma_f32_16x16x32_bf16 v[104:107], v[28:31], v[40:43], v[104:107]
  ds_read_b64_tr_b16 v[76:77], v19 offset:8192
  v_mfma_f32_16x16x32_bf16 v[108:111], v[28:31], v[44:47], v[108:111]
  ds_read_b64_tr_b16 v[78:79], v19 offset:9216
  v_mfma_f32_16x16x32_bf16 v[112:115], v[28:31], v[48:51], v[112:115]
  ds_read_b128 v[64:67], v15 offset:0
  v_mfma_f32_16x16x32_bf16 v[116:119], v[28:31], v[52:55], v[116:119]
  ds_read_b64_tr_b16 v[80:81], v21 offset:8192
  v_mfma_f32_16x16x32_bf16 v[120:123], v[32:35], v[40:43], v[120:123]
  ds_read_b64_tr_b16 v[82:83], v21 offset:9216
  v_mfma_f32_16x16x32_bf16 v[124:127], v[32:35], v[44:47], v[124:127]
  ds_read_b128 v[68:71], v15 offset:2048
  v_mfma_f32_16x16x32_bf16 v[128:131], v[32:35], v[48:51], v[128:131]
  ds_read_b64_tr_b16 v[84:85], v23 offset:8192
  v_mfma_f32_16x16x32_bf16 v[132:135], v[32:35], v[52:55], v[132:135]
  ds_read_b64_tr_b16 v[86:87], v23 offset:9216
  v_mfma_f32_16x16x32_bf16 v[136:139], v[36:39], v[40:43], v[136:139]
  v_mfma_f32_16x16x32_bf16 v[140:143], v[36:39], v[44:47], v[140:143]
  v_mfma_f32_16x16x32_bf16 v[144:147], v[36:39], v[48:51], v[144:147]
  v_mfma_f32_16x16x32_bf16 v[148:151], v[36:39], v[52:55], v[148:151]
  v_mfma_f32_16x16x32_bf16 v[152:155], v[24:27], v[24:27], v[152:155]
  v_mfma_f32_16x16x32_bf16 v[160:163], v[176:179], v[24:27], v[160:163]
  v_mfma_f32_16x16x32_bf16 v[156:159], v[28:31], v[28:31], v[156:159]
  v_mfma_f32_16x16x32_bf16 v[164:167], v[176:179], v[28:31], v[164:167]
  v_mfma_f32_16x16x32_bf16 v[168:171], v[176:179], v[40:43], v[168:171]
  v_mfma_f32_16x16x32_bf16 v[172:175], v[176:179], v[44:47], v[172:175]
  s_waitcnt lgkmcnt(0)
  s_barrier
  v_mfma_f32_16x16x32_bf16 v[88:91], v[56:59], v[72:75], v[88:91]
  ds_read_b128 v[24:27], v9 offset:32768
  v_mfma_f32_16x16x32_bf16 v[92:95], v[56:59], v[76:79], v[92:95]
  ds_read_b64_tr_b16 v[40:41], v17 offset:32768
  v_mfma_f32_16x16x32_bf16 v[96:99], v[56:59], v[80:83], v[96:99]
  ds_read_b64_tr_b16 v[42:43], v17 offset:33792
  v_mfma_f32_16x16x32_bf16 v[100:103], v[56:59], v[84:87], v[100:103]
  ds_read_b128 v[28:31], v9 offset:34816
  v_mfma_f32_16x16x32_bf16 v[104:107], v[60:63], v[72:75], v[104:107]
  ds_read_b64_tr_b16 v[44:45], v19 offset:32768
  v_mfma_f32_16x16x32_bf16 v[108:111], v[60:63], v[76:79], v[108:111]
  ds_read_b64_tr_b16 v[46:47], v19 offset:33792
  v_mfma_f32_16x16x32_bf16 v[112:115], v[60:63], v[80:83], v[112:115]
  ds_read_b128 v[32:35], v11 offset:32768
  v_mfma_f32_16x16x32_bf16 v[116:119], v[60:63], v[84:87], v[116:119]
  ds_read_b64_tr_b16 v[48:49], v21 offset:32768
  v_mfma_f32_16x16x32_bf16 v[120:123], v[64:67], v[72:75], v[120:123]
  ds_read_b64_tr_b16 v[50:51], v21 offset:33792
  v_mfma_f32_16x16x32_bf16 v[124:127], v[64:67], v[76:79], v[124:127]
  ds_read_b128 v[36:39], v11 offset:34816
  v_mfma_f32_16x16x32_bf16 v[128:131], v[64:67], v[80:83], v[128:131]
  ds_read_b64_tr_b16 v[52:53], v23 offset:32768
  v_mfma_f32_16x16x32_bf16 v[132:135], v[64:67], v[84:87], v[132:135]
  ds_read_b64_tr_b16 v[54:55], v23 offset:33792
  v_mfma_f32_16x16x32_bf16 v[136:139], v[68:71], v[72:75], v[136:139]
  v_mfma_f32_16x16x32_bf16 v[140:143], v[68:71], v[76:79], v[140:143]
  v_mfma_f32_16x16x32_bf16 v[144:147], v[68:71], v[80:83], v[144:147]
  v_mfma_f32_16x16x32_bf16 v[148:151], v[68:71], v[84:87], v[148:151]
  v_mfma_f32_16x16x32_bf16 v[152:155], v[56:59], v[56:59], v[152:155]
  v_mfma_f32_16x16x32_bf16 v[160:163], v[176:179], v[56:59], v[160:163]
  v_mfma_f32_16x16x32_bf16 v[156:159], v[60:63], v[60:63], v[156:159]
  v_mfma_f32_16x16x32_bf16 v[164:167], v[176:179], v[60:63], v[164:167]
  v_mfma_f32_16x16x32_bf16 v[168:171], v[176:179], v[72:75], v[168:171]
  v_mfma_f32_16x16x32_bf16 v[172:175], v[176:179], v[76:79], v[172:175]
  s_waitcnt lgkmcnt(0)
  v_mfma_f32_16x16x32_bf16 v[88:91], v[24:27], v[40:43], v[88:91]
  ds_read_b128 v[56:59], v13 offset:32768
  v_mfma_f32_16x16x32_bf16 v[92:95], v[24:27], v[44:47], v[92:95]
  ds_read_b64_tr_b16 v[72:73], v17 offset:40960
  v_mfma_f32_16x16x32_bf16 v[96:99], v[24:27], v[48:51], v[96:99]
  ds_read_b64_tr_b16 v[74:75], v17 offset:41984
  v_mfma_f32_16x16x32_bf16 v[100:103], v[24:27], v[52:55], v[100:103]
  ds_read_b128 v[60:63], v13 offset:34816
  v_mfma_f32_16x16x32_bf16 v[104:107], v[28:31], v[40:43], v[104:107]
  ds_read_b64_tr_b16 v[76:77], v19 offset:40960
  v_mfma_f32_16x16x32_bf16 v[108:111], v[28:31], v[44:47], v[108:111]
  ds_read_b64_tr_b16 v[78:79], v19 offset:41984
  v_mfma_f32_16x16x32_bf16 v[112:115], v[28:31], v[48:51], v[112:115]
  ds_read_b128 v[64:67], v15 offset:32768
  v_mfma_f32_16x16x32_bf16 v[116:119], v[28:31], v[52:55], v[116:119]
  ds_read_b64_tr_b16 v[80:81], v21 offset:40960
  v_mfma_f32_16x16x32_bf16 v[120:123], v[32:35], v[40:43], v[120:123]
  ds_read_b64_tr_b16 v[82:83], v21 offset:41984
  v_mfma_f32_16x16x32_bf16 v[124:127], v[32:35], v[44:47], v[124:127]
  ds_read_b128 v[68:71], v15 offset:34816
  v_mfma_f32_16x16x32_bf16 v[128:131], v[32:35], v[48:51], v[128:131]
  ds_read_b64_tr_b16 v[84:85], v23 offset:40960
  v_mfma_f32_16x16x32_bf16 v[132:135], v[32:35], v[52:55], v[132:135]
  ds_read_b64_tr_b16 v[86:87], v23 offset:41984
  v_mfma_f32_16x16x32_bf16 v[136:139], v[36:39], v[40:43], v[136:139]
  v_mfma_f32_16x16x32_bf16 v[140:143], v[36:39], v[44:47], v[140:143]
  v_mfma_f32_16x16x32_bf16 v[144:147], v[36:39], v[48:51], v[144:147]
  v_mfma_f32_16x16x32_bf16 v[148:151], v[36:39], v[52:55], v[148:151]
  v_mfma_f32_16x16x32_bf16 v[152:155], v[24:27], v[24:27], v[152:155]
  v_mfma_f32_16x16x32_bf16 v[160:163], v[176:179], v[24:27], v[160:163]
  v_mfma_f32_16x16x32_bf16 v[156:159], v[28:31], v[28:31], v[156:159]
  v_mfma_f32_16x16x32_bf16 v[164:167], v[176:179], v[28:31], v[164:167]
  v_mfma_f32_16x16x32_bf16 v[168:171], v[176:179], v[40:43], v[168:171]
  v_mfma_f32_16x16x32_bf16 v[172:175], v[176:179], v[44:47], v[172:175]
  s_waitcnt lgkmcnt(0)
  s_barrier
  v_mfma_f32_16x16x32_bf16 v[88:91], v[56:59], v[72:75], v[88:91]
  v_mfma_f32_16x16x32_bf16 v[92:95], v[56:59], v[76:79], v[92:95]
  v_mfma_f32_16x16x32_bf16 v[96:99], v[56:59], v[80:83], v[96:99]
  v_mfma_f32_16x16x32_bf16 v[100:103], v[56:59], v[84:87], v[100:103]
  v_mfma_f32_16x16x32_bf16 v[104:107], v[60:63], v[72:75], v[104:107]
  v_mfma_f32_16x16x32_bf16 v[108:111], v[60:63], v[76:79], v[108:111]
  v_mfma_f32_16x16x32_bf16 v[112:115], v[60:63], v[80:83], v[112:115]
  v_mfma_f32_16x16x32_bf16 v[116:119], v[60:63], v[84:87], v[116:119]
  v_mfma_f32_16x16x32_bf16 v[120:123], v[64:67], v[72:75], v[120:123]
  v_mfma_f32_16x16x32_bf16 v[124:127], v[64:67], v[76:79], v[124:127]
  v_mfma_f32_16x16x32_bf16 v[128:131], v[64:67], v[80:83], v[128:131]
  v_mfma_f32_16x16x32_bf16 v[132:135], v[64:67], v[84:87], v[132:135]
  v_mfma_f32_16x16x32_bf16 v[136:139], v[68:71], v[72:75], v[136:139]
  v_mfma_f32_16x16x32_bf16 v[140:143], v[68:71], v[76:79], v[140:143]
  v_mfma_f32_16x16x32_bf16 v[144:147], v[68:71], v[80:83], v[144:147]
  v_mfma_f32_16x16x32_bf16 v[148:151], v[68:71], v[84:87], v[148:151]
  v_mfma_f32_16x16x32_bf16 v[152:155], v[56:59], v[56:59], v[152:155]
  v_mfma_f32_16x16x32_bf16 v[160:163], v[176:179], v[56:59], v[160:163]
  v_mfma_f32_16x16x32_bf16 v[156:159], v[60:63], v[60:63], v[156:159]
  v_mfma_f32_16x16x32_bf16 v[164:167], v[176:179], v[60:63], v[164:167]
  v_mfma_f32_16x16x32_bf16 v[168:171], v[176:179], v[72:75], v[168:171]
  v_mfma_f32_16x16x32_bf16 v[172:175], v[176:179], v[76:79], v[172:175]
  s_nop 7
  s_nop 3
  s_mov_b32 s64, 0x22222222
  s_mov_b32 s65, 0x22222222
  s_mov_b32 s66, 0x44444444
  s_mov_b32 s67, 0x44444444
  s_mov_b32 s68, 0x88888888
  s_mov_b32 s69, 0x88888888
  s_lshl_b32 s4, s34, 8
  s_lshl_b32 s5, s35, 7
  s_add_u32 s4, s4, s5
  s_add_u32 s4, s4, 0x20000
  v_and_b32 v24, 15, v0
  v_lshl_add_u32 v25, v24, 2, s4
  v_cndmask_b32 v28, v152, v153, s[64:65]
  v_mul_f32 v26, 0x3b000000, v160
  v_cndmask_b32 v28, v28, v154, s[66:67]
  v_cndmask_b32 v28, v28, v155, s[68:69]
  v_mul_f32 v28, 0x3b000000, v28
  v_fma_f32 v28, -v26, v26, v28
  v_add_f32 v28, 0x3727c5ac, v28
  v_rsq_f32 v27, v28
  v_cndmask_b32 v32, v156, v157, s[64:65]
  v_mul_f32 v30, 0x3b000000, v164
  v_cndmask_b32 v32, v32, v158, s[66:67]
  v_cndmask_b32 v32, v32, v159, s[68:69]
  v_mul_f32 v32, 0x3b000000, v32
  v_fma_f32 v32, -v30, v30, v32
  v_add_f32 v32, 0x3727c5ac, v32
  v_rsq_f32 v31, v32
  s_nop 0
  s_mov_b32 exec_lo, 0xf0000f
  s_mov_b32 exec_hi, 0xf0000f00
  ds_write_b32 v25, v26 offset:0
  ds_write_b32 v25, v27 offset:512
  ds_write_b32 v25, v30 offset:64
  ds_write_b32 v25, v31 offset:576
  s_mov_b64 exec, -1
  s_lshl_b32 s4, s35, 8
  s_lshl_b32 s5, s34, 7
  s_add_u32 s4, s4, s5
  s_add_u32 s4, s4, 0x20400
  v_and_b32 v36, 15, v0
  v_lshl_add_u32 v36, v36, 2, s4
  ds_write_b32 v36, v168 offset:0
  ds_write_b32 v36, v172 offset:64
  s_waitcnt lgkmcnt(0)
  s_barrier
  s_add_u32 s33, s33, 4
  s_lshl_b32 s4, s34, 8
  s_add_u32 s4, s4, 0x20000
  s_lshl_b32 s5, s35, 7
  s_xor_b32 s6, s5, 128
  s_add_u32 s5, s5, s4
  s_add_u32 s6, s6, s4
  v_lshrrev_b32 v184, 4, v0
  v_lshl_add_u32 v180, v184, 4, s5
  v_lshl_add_u32 v181, v184, 4, s6
  s_lshl_b32 s4, s35, 8
  s_add_u32 s4, s4, 0x20400
  s_lshl_b32 s5, s34, 7
  s_xor_b32 s6, s5, 128
  s_add_u32 s5, s5, s4
  s_add_u32 s6, s6, s4
  v_and_b32 v184, 15, v0
  v_lshl_add_u32 v182, v184, 2, s5
  v_lshl_add_u32 v183, v184, 2, s6
  ds_read_b128 v[24:27], v180 offset:0
  ds_read_b128 v[40:43], v180 offset:512
  ds_read_b128 v[28:31], v180 offset:64
  ds_read_b128 v[44:47], v180 offset:576
  ds_read_b128 v[32:35], v181 offset:0
  ds_read_b128 v[48:51], v181 offset:512
  ds_read_b128 v[36:39], v181 offset:64
  ds_read_b128 v[52:55], v181 offset:576
  ds_read_b32 v184, v182 offset:0
  ds_read_b32 v185, v182 offset:64
  ds_read_b32 v186, v183 offset:0
  ds_read_b32 v187, v183 offset:64
  v_mov_b32 v72, 0x358637bd
  v_mov_b32 v73, 0x3fb8aa3b
  s_waitcnt lgkmcnt(0)
  v_sub_f32 v184, 0, v184
  v_sub_f32 v185, 0, v185
  v_sub_f32 v186, 0, v186
  v_sub_f32 v187, 0, v187
  v_pk_fma_f32 v[88:89], v[24:25], v[184:185], v[88:89] op_sel:[0,0,0] op_sel_hi:[1,0,1]
  v_pk_fma_f32 v[90:91], v[26:27], v[184:185], v[90:91] op_sel:[0,0,0] op_sel_hi:[1,0,1]
  v_pk_fma_f32 v[104:105], v[28:29], v[184:185], v[104:105] op_sel:[0,0,0] op_sel_hi:[1,0,1]
  v_pk_fma_f32 v[106:107], v[30:31], v[184:185], v[106:107] op_sel:[0,0,0] op_sel_hi:[1,0,1]
  v_pk_mul_f32 v[88:89], v[88:89], v[40:41]
  v_pk_mul_f32 v[90:91], v[90:91], v[42:43]
  v_pk_mul_f32 v[104:105], v[104:105], v[44:45]
  v_pk_mul_f32 v[106:107], v[106:107], v[46:47]
  v_pk_mul_f32 v[56:57], v[88:89], v[72:73] op_sel:[0,1] op_sel_hi:[1,1]
  v_pk_mul_f32 v[58:59], v[90:91], v[72:73] op_sel:[0,1] op_sel_hi:[1,1]
  v_pk_mul_f32 v[60:61], v[104:105], v[72:73] op_sel:[0,1] op_sel_hi:[1,1]
  v_pk_mul_f32 v[62:63], v[106:107], v[72:73] op_sel:[0,1] op_sel_hi:[1,1]
  v_pk_add_f32 v[88:89], v[88:89], v[72:73] op_sel_hi:[1,0]
  v_pk_add_f32 v[90:91], v[90:91], v[72:73] op_sel_hi:[1,0]
  v_pk_add_f32 v[104:105], v[104:105], v[72:73] op_sel_hi:[1,0]
  v_pk_add_f32 v[106:107], v[106:107], v[72:73] op_sel_hi:[1,0]
  v_exp_f32_e64 v56, v56 clamp
  v_exp_f32_e64 v57, v57 clamp
  v_exp_f32_e64 v58, v58 clamp
  v_exp_f32_e64 v59, v59 clamp
  v_exp_f32_e64 v60, v60 clamp
  v_exp_f32_e64 v61, v61 clamp
  v_exp_f32_e64 v62, v62 clamp
  v_exp_f32_e64 v63, v63 clamp
  v_max_f32 v88, v72, v88
  v_max_f32 v89, v72, v89
  v_max_f32 v90, v72, v90
  v_max_f32 v91, v72, v91
  v_max_f32 v104, v72, v104
  v_max_f32 v105, v72, v105
  v_max_f32 v106, v72, v106
  v_max_f32 v107, v72, v107
  v_pk_add_f32 v[88:89], v[88:89], v[56:57]
  v_pk_add_f32 v[90:91], v[90:91], v[58:59]
  v_pk_add_f32 v[104:105], v[104:105], v[60:61]
  v_pk_add_f32 v[106:107], v[106:107], v[62:63]
  v_cvt_pk_bf16_f32 v64, v88, v89
  v_cvt_pk_bf16_f32 v65, v90, v91
  v_cvt_pk_bf16_f32 v66, v104, v105
  v_cvt_pk_bf16_f32 v67, v106, v107
  v_pk_fma_f32 v[92:93], v[24:25], v[184:185], v[92:93] op_sel:[0,1,0] op_sel_hi:[1,1,1]
  v_pk_fma_f32 v[94:95], v[26:27], v[184:185], v[94:95] op_sel:[0,1,0] op_sel_hi:[1,1,1]
  v_pk_fma_f32 v[108:109], v[28:29], v[184:185], v[108:109] op_sel:[0,1,0] op_sel_hi:[1,1,1]
  v_pk_fma_f32 v[110:111], v[30:31], v[184:185], v[110:111] op_sel:[0,1,0] op_sel_hi:[1,1,1]
  v_pk_mul_f32 v[92:93], v[92:93], v[40:41]
  v_pk_mul_f32 v[94:95], v[94:95], v[42:43]
  v_pk_mul_f32 v[108:109], v[108:109], v[44:45]
  v_pk_mul_f32 v[110:111], v[110:111], v[46:47]
  v_cvt_pk_bf16_f32 v68, v92, v93
  v_cvt_pk_bf16_f32 v69, v94, v95
  v_cvt_pk_bf16_f32 v70, v108, v109
  v_cvt_pk_bf16_f32 v71, v110, v111
  s_nop 1
  v_mfma_f32_16x16x32_bf16 v[188:191], v[64:67], v[68:71], 0
  v_mfma_f32_16x16x32_bf16 v[192:195], v[64:67], v[176:179], 0
  v_pk_fma_f32 v[120:121], v[32:33], v[184:185], v[120:121] op_sel:[0,0,0] op_sel_hi:[1,0,1]
  v_pk_fma_f32 v[122:123], v[34:35], v[184:185], v[122:123] op_sel:[0,0,0] op_sel_hi:[1,0,1]
  v_pk_fma_f32 v[136:137], v[36:37], v[184:185], v[136:137] op_sel:[0,0,0] op_sel_hi:[1,0,1]
  v_pk_fma_f32 v[138:139], v[38:39], v[184:185], v[138:139] op_sel:[0,0,0] op_sel_hi:[1,0,1]
  v_pk_mul_f32 v[120:121], v[120:121], v[48:49]
  v_pk_mul_f32 v[122:123], v[122:123], v[50:51]
  v_pk_mul_f32 v[136:137], v[136:137], v[52:53]
  v_pk_mul_f32 v[138:139], v[138:139], v[54:55]
  v_pk_mul_f32 v[56:57], v[120:121], v[72:73] op_sel:[0,1] op_sel_hi:[1,1]
  v_pk_mul_f32 v[58:59], v[122:123], v[72:73] op_sel:[0,1] op_sel_hi:[1,1]
  v_pk_mul_f32 v[60:61], v[136:137], v[72:73] op_sel:[0,1] op_sel_hi:[1,1]
  v_pk_mul_f32 v[62:63], v[138:139], v[72:73] op_sel:[0,1] op_sel_hi:[1,1]
  v_pk_add_f32 v[120:121], v[120:121], v[72:73] op_sel_hi:[1,0]
  v_pk_add_f32 v[122:123], v[122:123], v[72:73] op_sel_hi:[1,0]
  v_pk_add_f32 v[136:137], v[136:137], v[72:73] op_sel_hi:[1,0]
  v_pk_add_f32 v[138:139], v[138:139], v[72:73] op_sel_hi:[1,0]
  v_exp_f32_e64 v56, v56 clamp
  v_exp_f32_e64 v57, v57 clamp
  v_exp_f32_e64 v58, v58 clamp
  v_exp_f32_e64 v59, v59 clamp
  v_exp_f32_e64 v60, v60 clamp
  v_exp_f32_e64 v61, v61 clamp
  v_exp_f32_e64 v62, v62 clamp
  v_exp_f32_e64 v63, v63 clamp
  v_max_f32 v120, v72, v120
  v_max_f32 v121, v72, v121
  v_max_f32 v122, v72, v122
  v_max_f32 v123, v72, v123
  v_max_f32 v136, v72, v136
  v_max_f32 v137, v72, v137
  v_max_f32 v138, v72, v138
  v_max_f32 v139, v72, v139
  v_pk_add_f32 v[120:121], v[120:121], v[56:57]
  v_pk_add_f32 v[122:123], v[122:123], v[58:59]
  v_pk_add_f32 v[136:137], v[136:137], v[60:61]
  v_pk_add_f32 v[138:139], v[138:139], v[62:63]
  v_cvt_pk_bf16_f32 v64, v120, v121
  v_cvt_pk_bf16_f32 v65, v122, v123
  v_cvt_pk_bf16_f32 v66, v136, v137
  v_cvt_pk_bf16_f32 v67, v138, v139
  v_pk_fma_f32 v[124:125], v[32:33], v[184:185], v[124:125] op_sel:[0,1,0] op_sel_hi:[1,1,1]
  v_pk_fma_f32 v[126:127], v[34:35], v[184:185], v[126:127] op_sel:[0,1,0] op_sel_hi:[1,1,1]
  v_pk_fma_f32 v[140:141], v[36:37], v[184:185], v[140:141] op_sel:[0,1,0] op_sel_hi:[1,1,1]
  v_pk_fma_f32 v[142:143], v[38:39], v[184:185], v[142:143] op_sel:[0,1,0] op_sel_hi:[1,1,1]
  v_pk_mul_f32 v[124:125], v[124:125], v[48:49]
  v_pk_mul_f32 v[126:127], v[126:127], v[50:51]
  v_pk_mul_f32 v[140:141], v[140:141], v[52:53]
  v_pk_mul_f32 v[142:143], v[142:143], v[54:55]
  v_cvt_pk_bf16_f32 v68, v124, v125
  v_cvt_pk_bf16_f32 v69, v126, v127
  v_cvt_pk_bf16_f32 v70, v140, v141
  v_cvt_pk_bf16_f32 v71, v142, v143
  s_nop 1
  v_mfma_f32_16x16x32_bf16 v[188:191], v[64:67], v[68:71], v[188:191]
  v_mfma_f32_16x16x32_bf16 v[192:195], v[64:67], v[176:179], v[192:195]
  v_pk_fma_f32 v[96:97], v[24:25], v[186:187], v[96:97] op_sel:[0,0,0] op_sel_hi:[1,0,1]
  v_pk_fma_f32 v[98:99], v[26:27], v[186:187], v[98:99] op_sel:[0,0,0] op_sel_hi:[1,0,1]
  v_pk_fma_f32 v[112:113], v[28:29], v[186:187], v[112:113] op_sel:[0,0,0] op_sel_hi:[1,0,1]
  v_pk_fma_f32 v[114:115], v[30:31], v[186:187], v[114:115] op_sel:[0,0,0] op_sel_hi:[1,0,1]
  v_pk_mul_f32 v[96:97], v[96:97], v[40:41]
  v_pk_mul_f32 v[98:99], v[98:99], v[42:43]
  v_pk_mul_f32 v[112:113], v[112:113], v[44:45]
  v_pk_mul_f32 v[114:115], v[114:115], v[46:47]
  v_pk_mul_f32 v[56:57], v[96:97], v[72:73] op_sel:[0,1] op_sel_hi:[1,1]
  v_pk_mul_f32 v[58:59], v[98:99], v[72:73] op_sel:[0,1] op_sel_hi:[1,1]
  v_pk_mul_f32 v[60:61], v[112:113], v[72:73] op_sel:[0,1] op_sel_hi:[1,1]
  v_pk_mul_f32 v[62:63], v[114:115], v[72:73] op_sel:[0,1] op_sel_hi:[1,1]
  v_pk_add_f32 v[96:97], v[96:97], v[72:73] op_sel_hi:[1,0]
  v_pk_add_f32 v[98:99], v[98:99], v[72:73] op_sel_hi:[1,0]
  v_pk_add_f32 v[112:113], v[112:113], v[72:73] op_sel_hi:[1,0]
  v_pk_add_f32 v[114:115], v[114:115], v[72:73] op_sel_hi:[1,0]
  v_exp_f32_e64 v56, v56 clamp
  v_exp_f32_e64 v57, v57 clamp
  v_exp_f32_e64 v58, v58 clamp
  v_exp_f32_e64 v59, v59 clamp
  v_exp_f32_e64 v60, v60 clamp
  v_exp_f32_e64 v61, v61 clamp
  v_exp_f32_e64 v62, v62 clamp
  v_exp_f32_e64 v63, v63 clamp
  v_max_f32 v96, v72, v96
  v_max_f32 v97, v72, v97
  v_max_f32 v98, v72, v98
  v_max_f32 v99, v72, v99
  v_max_f32 v112, v72, v112
  v_max_f32 v113, v72, v113
  v_max_f32 v114, v72, v114
  v_max_f32 v115, v72, v115
  v_pk_add_f32 v[96:97], v[96:97], v[56:57]
  v_pk_add_f32 v[98:99], v[98:99], v[58:59]
  v_pk_add_f32 v[112:113], v[112:113], v[60:61]
  v_pk_add_f32 v[114:115], v[114:115], v[62:63]
  v_cvt_pk_bf16_f32 v64, v96, v97
  v_cvt_pk_bf16_f32 v65, v98, v99
  v_cvt_pk_bf16_f32 v66, v112, v113
  v_cvt_pk_bf16_f32 v67, v114, v115
  v_pk_fma_f32 v[100:101], v[24:25], v[186:187], v[100:101] op_sel:[0,1,0] op_sel_hi:[1,1,1]
  v_pk_fma_f32 v[102:103], v[26:27], v[186:187], v[102:103] op_sel:[0,1,0] op_sel_hi:[1,1,1]
  v_pk_fma_f32 v[116:117], v[28:29], v[186:187], v[116:117] op_sel:[0,1,0] op_sel_hi:[1,1,1]
  v_pk_fma_f32 v[118:119], v[30:31], v[186:187], v[118:119] op_sel:[0,1,0] op_sel_hi:[1,1,1]
  v_pk_mul_f32 v[100:101], v[100:101], v[40:41]
  v_pk_mul_f32 v[102:103], v[102:103], v[42:43]
  v_pk_mul_f32 v[116:117], v[116:117], v[44:45]
  v_pk_mul_f32 v[118:119], v[118:119], v[46:47]
  v_cvt_pk_bf16_f32 v68, v100, v101
  v_cvt_pk_bf16_f32 v69, v102, v103
  v_cvt_pk_bf16_f32 v70, v116, v117
  v_cvt_pk_bf16_f32 v71, v118, v119
  s_nop 1
  v_mfma_f32_16x16x32_bf16 v[196:199], v[64:67], v[68:71], 0
  v_mfma_f32_16x16x32_bf16 v[200:203], v[64:67], v[176:179], 0
  v_pk_fma_f32 v[128:129], v[32:33], v[186:187], v[128:129] op_sel:[0,0,0] op_sel_hi:[1,0,1]
  v_pk_fma_f32 v[130:131], v[34:35], v[186:187], v[130:131] op_sel:[0,0,0] op_sel_hi:[1,0,1]
  v_pk_fma_f32 v[144:145], v[36:37], v[186:187], v[144:145] op_sel:[0,0,0] op_sel_hi:[1,0,1]
  v_pk_fma_f32 v[146:147], v[38:39], v[186:187], v[146:147] op_sel:[0,0,0] op_sel_hi:[1,0,1]
  v_pk_mul_f32 v[128:129], v[128:129], v[48:49]
  v_pk_mul_f32 v[130:131], v[130:131], v[50:51]
  v_pk_mul_f32 v[144:145], v[144:145], v[52:53]
  v_pk_mul_f32 v[146:147], v[146:147], v[54:55]
  v_pk_mul_f32 v[56:57], v[128:129], v[72:73] op_sel:[0,1] op_sel_hi:[1,1]
  v_pk_mul_f32 v[58:59], v[130:131], v[72:73] op_sel:[0,1] op_sel_hi:[1,1]
  v_pk_mul_f32 v[60:61], v[144:145], v[72:73] op_sel:[0,1] op_sel_hi:[1,1]
  v_pk_mul_f32 v[62:63], v[146:147], v[72:73] op_sel:[0,1] op_sel_hi:[1,1]
  v_pk_add_f32 v[128:129], v[128:129], v[72:73] op_sel_hi:[1,0]
  v_pk_add_f32 v[130:131], v[130:131], v[72:73] op_sel_hi:[1,0]
  v_pk_add_f32 v[144:145], v[144:145], v[72:73] op_sel_hi:[1,0]
  v_pk_add_f32 v[146:147], v[146:147], v[72:73] op_sel_hi:[1,0]
  v_exp_f32_e64 v56, v56 clamp
  v_exp_f32_e64 v57, v57 clamp
  v_exp_f32_e64 v58, v58 clamp
  v_exp_f32_e64 v59, v59 clamp
  v_exp_f32_e64 v60, v60 clamp
  v_exp_f32_e64 v61, v61 clamp
  v_exp_f32_e64 v62, v62 clamp
  v_exp_f32_e64 v63, v63 clamp
  v_max_f32 v128, v72, v128
  v_max_f32 v129, v72, v129
  v_max_f32 v130, v72, v130
  v_max_f32 v131, v72, v131
  v_max_f32 v144, v72, v144
  v_max_f32 v145, v72, v145
  v_max_f32 v146, v72, v146
  v_max_f32 v147, v72, v147
  v_pk_add_f32 v[128:129], v[128:129], v[56:57]
  v_pk_add_f32 v[130:131], v[130:131], v[58:59]
  v_pk_add_f32 v[144:145], v[144:145], v[60:61]
  v_pk_add_f32 v[146:147], v[146:147], v[62:63]
  v_cvt_pk_bf16_f32 v64, v128, v129
  v_cvt_pk_bf16_f32 v65, v130, v131
  v_cvt_pk_bf16_f32 v66, v144, v145
  v_cvt_pk_bf16_f32 v67, v146, v147
  v_pk_fma_f32 v[132:133], v[32:33], v[186:187], v[132:133] op_sel:[0,1,0] op_sel_hi:[1,1,1]
  v_pk_fma_f32 v[134:135], v[34:35], v[186:187], v[134:135] op_sel:[0,1,0] op_sel_hi:[1,1,1]
  v_pk_fma_f32 v[148:149], v[36:37], v[186:187], v[148:149] op_sel:[0,1,0] op_sel_hi:[1,1,1]
  v_pk_fma_f32 v[150:151], v[38:39], v[186:187], v[150:151] op_sel:[0,1,0] op_sel_hi:[1,1,1]
  v_pk_mul_f32 v[132:133], v[132:133], v[48:49]
  v_pk_mul_f32 v[134:135], v[134:135], v[50:51]
  v_pk_mul_f32 v[148:149], v[148:149], v[52:53]
  v_pk_mul_f32 v[150:151], v[150:151], v[54:55]
  v_cvt_pk_bf16_f32 v68, v132, v133
  v_cvt_pk_bf16_f32 v69, v134, v135
  v_cvt_pk_bf16_f32 v70, v148, v149
  v_cvt_pk_bf16_f32 v71, v150, v151
  s_nop 1
  v_mfma_f32_16x16x32_bf16 v[196:199], v[64:67], v[68:71], v[196:199]
  v_mfma_f32_16x16x32_bf16 v[200:203], v[64:67], v[176:179], v[200:203]
  s_nop 7
  s_nop 3
  s_lshl_b32 s4, s35, 12
  s_add_u32 s4, s4, 0x20800
  v_lshl_add_u32 v56, v0, 4, s4
  s_cmp_eq_u32 s34, 0
  s_cbranch_scc1 L_kvw_28
  ds_write_b128 v56, v[188:191] offset:0
  ds_write_b128 v56, v[192:195] offset:1024
  ds_write_b128 v56, v[196:199] offset:2048
  ds_write_b128 v56, v[200:203] offset:3072
  s_waitcnt lgkmcnt(0)
  s_barrier
  s_branch L_kvd_29
L_kvw_28:
  s_barrier
  ds_read_b128 v[24:27], v56 offset:0
  ds_read_b128 v[28:31], v56 offset:1024
  ds_read_b128 v[32:35], v56 offset:2048
  ds_read_b128 v[36:39], v56 offset:3072
  s_sub_u32 s4, s33, 4
  s_lshl_b32 s4, s4, 2
  s_lshl_b32 s5, s35, 1
  s_add_u32 s4, s4, s5
  s_lshl_b32 s5, s32, 5
  s_add_u32 s4, s4, s5
  s_mul_i32 s4, s4, 1088
  v_and_b32 v56, 15, v0
  v_lshlrev_b32 v56, 6, v56
  v_lshrrev_b32 v57, 4, v0
  v_lshl_add_u32 v56, v57, 4, v56
  v_lshlrev_b32 v57, 4, v57
  s_waitcnt lgkmcnt(0)
  v_pk_add_f32 v[188:189], v[188:189], v[32:33]
  v_pk_add_f32 v[190:191], v[190:191], v[34:35]
  v_pk_add_f32 v[192:193], v[192:193], v[36:37]
  v_pk_add_f32 v[194:195], v[194:195], v[38:39]
  v_pk_add_f32 v[196:197], v[196:197], v[24:25]
  v_pk_add_f32 v[198:199], v[198:199], v[26:27]
  v_pk_add_f32 v[200:201], v[200:201], v[28:29]
  v_pk_add_f32 v[202:203], v[202:203], v[30:31]
  s_add_u32 s5, s4, 0
  buffer_store_dwordx4 v[188:191], v56, s[20:23], s5 offen sc1
  s_add_u32 s5, s4, 1088
  buffer_store_dwordx4 v[196:199], v56, s[20:23], s5 offen sc1
  s_mov_b32 exec_lo, 0x10001
  s_mov_b32 exec_hi, 0x10001
  s_add_u32 s5, s4, 1024
  buffer_store_dwordx4 v[192:195], v57, s[20:23], s5 offen sc1
  s_add_u32 s5, s4, 2112
  buffer_store_dwordx4 v[200:203], v57, s[20:23], s5 offen sc1
  s_mov_b64 exec, -1
L_kvd_29:
  s_sub_u32 s33, s33, 4
  v_and_b32 v2, 15, v0
  v_lshrrev_b32 v3, 4, v0
  v_bfe_u32 v4, v0, 1, 3
  v_xor_b32 v5, v3, v4
  v_lshlrev_b32 v5, 4, v5
  v_lshl_add_u32 v5, v2, 7, v5
  s_lshl_b32 s62, s3, 12
  v_add_u32 v8, s62, v5
  v_xor_b32 v10, 64, v8
  v_add_u32 v9, 0x10000, v8
  v_add_u32 v11, 0x10000, v10
  v_bfe_u32 v4, v0, 2, 2
  v_lshl_add_u32 v7, v3, 3, v4
  v_lshlrev_b32 v7, 7, v7
  v_and_b32 v5, 3, v0
  v_lshl_add_u32 v7, v5, 3, v7
  v_add_u32 v7, 0x4000, v7
  v_lshrrev_b32 v4, 1, v4
  v_and_b32 v6, 1, v3
  v_lshl_or_b32 v6, v6, 1, v4
  v_lshl_add_u32 v12, v6, 5, v7
  v_xor_b32 v14, 32, v12
  v_xor_b32 v16, 64, v12
  v_xor_b32 v18, 96, v12
  v_add_u32 v13, 0x10000, v12
  v_add_u32 v15, 0x10000, v14
  v_add_u32 v17, 0x10000, v16
  v_add_u32 v19, 0x10000, v18
  v_mov_b32 v132, 0x3f803f80
  v_mov_b32 v133, 0x3f803f80
  v_mov_b32 v134, 0x3f803f80
  v_mov_b32 v135, 0x3f803f80
  s_add_u32 s16, s56, 0x300000
  s_addc_u32 s17, s57, 0
  s_mov_b32 s18, 0x200000
  s_mov_b32 s19, 0x00020000
  s_lshl_b32 s72, s33, 18
  s_add_u32 s73, s72, 256
  s_lshl_b32 s4, s3, 12
  s_add_u32 s4, s4, 0x22900
  v_lshrrev_b32 v150, 5, v0
  v_and_b32 v151, 7, v0
  v_xor_b32 v150, v150, v151
  v_lshlrev_b32 v150, 4, v150
  v_and_b32 v151, 15, v0
  v_lshl_add_u32 v150, v151, 7, v150
  v_bfe_u32 v151, v0, 4, 1
  v_lshl_add_u32 v150, v151, 3, v150
  v_add_u32 v150, s4, v150
  v_xor_b32 v151, 32, v150
  v_xor_b32 v152, 64, v150
  v_xor_b32 v153, 96, v150
  v_lshrrev_b32 v156, 3, v0
  v_and_b32 v157, 7, v0
  v_xor_b32 v154, v156, v157
  v_lshlrev_b32 v154, 4, v154
  v_lshl_add_u32 v154, v156, 7, v154
  v_add_u32 v154, s4, v154
  s_lshl_b32 s4, s32, 7
  s_lshl_b32 s5, s3, 5
  s_add_u32 s4, s4, s5
  v_add_u32 v156, s4, v156
  v_lshrrev_b32 v160, 1, v157
  v_lshlrev_b32 v160, 16, v160
  v_and_b32 v157, 1, v157
  v_lshl_add_u32 v157, v157, 4, v160
  v_lshl_add_u32 v156, v156, 5, v157
  v_add_u32 v157, 512, v156
  s_lshl_b32 s4, s3, 7
  s_add_u32 s4, s4, 0x20000
  v_and_b32 v2, 15, v0
  v_lshl_add_u32 v2, v2, 2, s4
  ds_read_b32 v136, v2 offset:0
  ds_read_b32 v137, v2 offset:512
  ds_read_b32 v138, v2 offset:64
  ds_read_b32 v139, v2 offset:576
  s_barrier
  ds_read_b128 v[20:23], v8 offset:0
  ds_read_b64_tr_b16 v[28:29], v12 offset:0
  ds_read_b64_tr_b16 v[30:31], v12 offset:512
  ds_read_b64_tr_b16 v[32:33], v14 offset:0
  ds_read_b64_tr_b16 v[34:35], v14 offset:512
  ds_read_b128 v[24:27], v8 offset:2048
  ds_read_b64_tr_b16 v[36:37], v16 offset:0
  ds_read_b64_tr_b16 v[38:39], v16 offset:512
  ds_read_b64_tr_b16 v[40:41], v18 offset:0
  ds_read_b64_tr_b16 v[42:43], v18 offset:512
  s_waitcnt lgkmcnt(0)
  v_mfma_f32_16x16x32_bf16 v[68:71], v[28:31], v[20:23], 0
  ds_read_b128 v[44:47], v10 offset:0
  v_mfma_f32_16x16x32_bf16 v[72:75], v[32:35], v[20:23], 0
  ds_read_b64_tr_b16 v[52:53], v12 offset:4096
  v_mfma_f32_16x16x32_bf16 v[76:79], v[36:39], v[20:23], 0
  ds_read_b64_tr_b16 v[54:55], v12 offset:4608
  v_mfma_f32_16x16x32_bf16 v[80:83], v[40:43], v[20:23], 0
  ds_read_b64_tr_b16 v[56:57], v14 offset:4096
  v_mfma_f32_16x16x32_bf16 v[84:87], v[28:31], v[24:27], 0
  ds_read_b64_tr_b16 v[58:59], v14 offset:4608
  v_mfma_f32_16x16x32_bf16 v[88:91], v[32:35], v[24:27], 0
  ds_read_b128 v[48:51], v10 offset:2048
  v_mfma_f32_16x16x32_bf16 v[92:95], v[36:39], v[24:27], 0
  ds_read_b64_tr_b16 v[60:61], v16 offset:4096
  v_mfma_f32_16x16x32_bf16 v[96:99], v[40:43], v[24:27], 0
  ds_read_b64_tr_b16 v[62:63], v16 offset:4608
  v_mfma_f32_16x16x32_bf16 v[116:119], v[28:31], v[132:135], 0
  ds_read_b64_tr_b16 v[64:65], v18 offset:4096
  v_mfma_f32_16x16x32_bf16 v[120:123], v[32:35], v[132:135], 0
  ds_read_b64_tr_b16 v[66:67], v18 offset:4608
  v_mfma_f32_16x16x32_bf16 v[124:127], v[36:39], v[132:135], 0
  v_mfma_f32_16x16x32_bf16 v[128:131], v[40:43], v[132:135], 0
  s_waitcnt lgkmcnt(0)
  s_barrier
  v_mfma_f32_16x16x32_bf16 v[68:71], v[52:55], v[44:47], v[68:71]
  ds_read_b128 v[20:23], v8 offset:32768
  v_mfma_f32_16x16x32_bf16 v[72:75], v[56:59], v[44:47], v[72:75]
  ds_read_b64_tr_b16 v[28:29], v12 offset:32768
  v_mfma_f32_16x16x32_bf16 v[76:79], v[60:63], v[44:47], v[76:79]
  ds_read_b64_tr_b16 v[30:31], v12 offset:33280
  v_mfma_f32_16x16x32_bf16 v[80:83], v[64:67], v[44:47], v[80:83]
  ds_read_b64_tr_b16 v[32:33], v14 offset:32768
  v_mfma_f32_16x16x32_bf16 v[84:87], v[52:55], v[48:51], v[84:87]
  ds_read_b64_tr_b16 v[34:35], v14 offset:33280
  v_mfma_f32_16x16x32_bf16 v[88:91], v[56:59], v[48:51], v[88:91]
  ds_read_b128 v[24:27], v8 offset:34816
  v_mfma_f32_16x16x32_bf16 v[92:95], v[60:63], v[48:51], v[92:95]
  ds_read_b64_tr_b16 v[36:37], v16 offset:32768
  v_mfma_f32_16x16x32_bf16 v[96:99], v[64:67], v[48:51], v[96:99]
  ds_read_b64_tr_b16 v[38:39], v16 offset:33280
  v_mfma_f32_16x16x32_bf16 v[116:119], v[52:55], v[132:135], v[116:119]
  ds_read_b64_tr_b16 v[40:41], v18 offset:32768
  v_mfma_f32_16x16x32_bf16 v[120:123], v[56:59], v[132:135], v[120:123]
  ds_read_b64_tr_b16 v[42:43], v18 offset:33280
  v_mfma_f32_16x16x32_bf16 v[124:127], v[60:63], v[132:135], v[124:127]
  v_mfma_f32_16x16x32_bf16 v[128:131], v[64:67], v[132:135], v[128:131]
  s_waitcnt lgkmcnt(0)
  v_mfma_f32_16x16x32_bf16 v[68:71], v[28:31], v[20:23], v[68:71]
  ds_read_b128 v[44:47], v10 offset:32768
  v_mfma_f32_16x16x32_bf16 v[72:75], v[32:35], v[20:23], v[72:75]
  ds_read_b64_tr_b16 v[52:53], v12 offset:36864
  v_mfma_f32_16x16x32_bf16 v[76:79], v[36:39], v[20:23], v[76:79]
  ds_read_b64_tr_b16 v[54:55], v12 offset:37376
  v_mfma_f32_16x16x32_bf16 v[80:83], v[40:43], v[20:23], v[80:83]
  ds_read_b64_tr_b16 v[56:57], v14 offset:36864
  v_mfma_f32_16x16x32_bf16 v[84:87], v[28:31], v[24:27], v[84:87]
  ds_read_b64_tr_b16 v[58:59], v14 offset:37376
  v_mfma_f32_16x16x32_bf16 v[88:91], v[32:35], v[24:27], v[88:91]
  ds_read_b128 v[48:51], v10 offset:34816
  v_mfma_f32_16x16x32_bf16 v[92:95], v[36:39], v[24:27], v[92:95]
  ds_read_b64_tr_b16 v[60:61], v16 offset:36864
  v_mfma_f32_16x16x32_bf16 v[96:99], v[40:43], v[24:27], v[96:99]
  ds_read_b64_tr_b16 v[62:63], v16 offset:37376
  v_mfma_f32_16x16x32_bf16 v[116:119], v[28:31], v[132:135], v[116:119]
  ds_read_b64_tr_b16 v[64:65], v18 offset:36864
  v_mfma_f32_16x16x32_bf16 v[120:123], v[32:35], v[132:135], v[120:123]
  ds_read_b64_tr_b16 v[66:67], v18 offset:37376
  v_mfma_f32_16x16x32_bf16 v[124:127], v[36:39], v[132:135], v[124:127]
  s_waitcnt vmcnt(0)
  s_mov_b64 exec, 1
  v_mov_b32 v2, 0x22814
  v_mov_b32 v3, 1
  ds_add_rtn_u32 v4, v2, v3
  s_waitcnt lgkmcnt(0)
  v_readfirstlane_b32 s4, v4
  s_mov_b64 exec, -1
  s_cmp_eq_u32 s4, 3
  s_cbranch_scc0 L_cd_1030
  s_mov_b32 s28, s56
  s_mov_b32 s29, s57
  s_mov_b32 s30, 0x5800
  s_mov_b32 s31, 0x00020000
  s_add_u32 s4, s33, 32
  s_lshl_b32 s4, s4, 8
  v_mov_b32 v2, s4
  v_mov_b32 v3, 1
  s_mov_b64 exec, 1
  buffer_atomic_add v3, v2, s[28:31], 0 offen
  s_mov_b64 exec, -1
  L_cd_1030:
  v_mfma_f32_16x16x32_bf16 v[128:131], v[40:43], v[132:135], v[128:131]
  s_waitcnt lgkmcnt(0)
  s_barrier
  v_mfma_f32_16x16x32_bf16 v[68:71], v[52:55], v[44:47], v[68:71]
  ds_read_b128 v[20:23], v9 offset:0
  v_mfma_f32_16x16x32_bf16 v[72:75], v[56:59], v[44:47], v[72:75]
  ds_read_b64_tr_b16 v[28:29], v13 offset:0
  v_mfma_f32_16x16x32_bf16 v[76:79], v[60:63], v[44:47], v[76:79]
  ds_read_b64_tr_b16 v[30:31], v13 offset:512
  v_mfma_f32_16x16x32_bf16 v[80:83], v[64:67], v[44:47], v[80:83]
  ds_read_b64_tr_b16 v[32:33], v15 offset:0
  v_mfma_f32_16x16x32_bf16 v[84:87], v[52:55], v[48:51], v[84:87]
  ds_read_b64_tr_b16 v[34:35], v15 offset:512
  v_mfma_f32_16x16x32_bf16 v[88:91], v[56:59], v[48:51], v[88:91]
  ds_read_b128 v[24:27], v9 offset:2048
  v_mfma_f32_16x16x32_bf16 v[92:95], v[60:63], v[48:51], v[92:95]
  ds_read_b64_tr_b16 v[36:37], v17 offset:0
  v_mfma_f32_16x16x32_bf16 v[96:99], v[64:67], v[48:51], v[96:99]
  ds_read_b64_tr_b16 v[38:39], v17 offset:512
  v_mfma_f32_16x16x32_bf16 v[116:119], v[52:55], v[132:135], v[116:119]
  ds_read_b64_tr_b16 v[40:41], v19 offset:0
  v_mfma_f32_16x16x32_bf16 v[120:123], v[56:59], v[132:135], v[120:123]
  ds_read_b64_tr_b16 v[42:43], v19 offset:512
  v_mfma_f32_16x16x32_bf16 v[124:127], v[60:63], v[132:135], v[124:127]
  v_mfma_f32_16x16x32_bf16 v[128:131], v[64:67], v[132:135], v[128:131]
  s_waitcnt lgkmcnt(0)
  v_mfma_f32_16x16x32_bf16 v[68:71], v[28:31], v[20:23], v[68:71]
  ds_read_b128 v[44:47], v11 offset:0
  v_mfma_f32_16x16x32_bf16 v[72:75], v[32:35], v[20:23], v[72:75]
  ds_read_b64_tr_b16 v[52:53], v13 offset:4096
  v_mfma_f32_16x16x32_bf16 v[76:79], v[36:39], v[20:23], v[76:79]
  ds_read_b64_tr_b16 v[54:55], v13 offset:4608
  v_mfma_f32_16x16x32_bf16 v[80:83], v[40:43], v[20:23], v[80:83]
  ds_read_b64_tr_b16 v[56:57], v15 offset:4096
  v_mfma_f32_16x16x32_bf16 v[84:87], v[28:31], v[24:27], v[84:87]
  ds_read_b64_tr_b16 v[58:59], v15 offset:4608
  v_mfma_f32_16x16x32_bf16 v[88:91], v[32:35], v[24:27], v[88:91]
  ds_read_b128 v[48:51], v11 offset:2048
  v_mfma_f32_16x16x32_bf16 v[92:95], v[36:39], v[24:27], v[92:95]
  ds_read_b64_tr_b16 v[60:61], v17 offset:4096
  v_mfma_f32_16x16x32_bf16 v[96:99], v[40:43], v[24:27], v[96:99]
  ds_read_b64_tr_b16 v[62:63], v17 offset:4608
  v_mfma_f32_16x16x32_bf16 v[116:119], v[28:31], v[132:135], v[116:119]
  ds_read_b64_tr_b16 v[64:65], v19 offset:4096
  v_mfma_f32_16x16x32_bf16 v[120:123], v[32:35], v[132:135], v[120:123]
  ds_read_b64_tr_b16 v[66:67], v19 offset:4608
  v_mfma_f32_16x16x32_bf16 v[124:127], v[36:39], v[132:135], v[124:127]
  v_mfma_f32_16x16x32_bf16 v[128:131], v[40:43], v[132:135], v[128:131]
  s_waitcnt lgkmcnt(0)
  s_barrier
  v_mfma_f32_16x16x32_bf16 v[68:71], v[52:55], v[44:47], v[68:71]
  ds_read_b128 v[20:23], v9 offset:32768
  v_mfma_f32_16x16x32_bf16 v[72:75], v[56:59], v[44:47], v[72:75]
  ds_read_b64_tr_b16 v[28:29], v13 offset:32768
  v_mfma_f32_16x16x32_bf16 v[76:79], v[60:63], v[44:47], v[76:79]
  ds_read_b64_tr_b16 v[30:31], v13 offset:33280
  v_mfma_f32_16x16x32_bf16 v[80:83], v[64:67], v[44:47], v[80:83]
  ds_read_b64_tr_b16 v[32:33], v15 offset:32768
  v_mfma_f32_16x16x32_bf16 v[84:87], v[52:55], v[48:51], v[84:87]
  ds_read_b64_tr_b16 v[34:35], v15 offset:33280
  v_mfma_f32_16x16x32_bf16 v[88:91], v[56:59], v[48:51], v[88:91]
  ds_read_b128 v[24:27], v9 offset:34816
  v_mfma_f32_16x16x32_bf16 v[92:95], v[60:63], v[48:51], v[92:95]
  ds_read_b64_tr_b16 v[36:37], v17 offset:32768
  v_mfma_f32_16x16x32_bf16 v[96:99], v[64:67], v[48:51], v[96:99]
  ds_read_b64_tr_b16 v[38:39], v17 offset:33280
  v_mfma_f32_16x16x32_bf16 v[116:119], v[52:55], v[132:135], v[116:119]
  ds_read_b64_tr_b16 v[40:41], v19 offset:32768
  v_mfma_f32_16x16x32_bf16 v[120:123], v[56:59], v[132:135], v[120:123]
  ds_read_b64_tr_b16 v[42:43], v19 offset:33280
  v_mfma_f32_16x16x32_bf16 v[124:127], v[60:63], v[132:135], v[124:127]
  v_mfma_f32_16x16x32_bf16 v[128:131], v[64:67], v[132:135], v[128:131]
  s_waitcnt lgkmcnt(0)
  v_mfma_f32_16x16x32_bf16 v[68:71], v[28:31], v[20:23], v[68:71]
  ds_read_b128 v[44:47], v11 offset:32768
  v_mfma_f32_16x16x32_bf16 v[72:75], v[32:35], v[20:23], v[72:75]
  ds_read_b64_tr_b16 v[52:53], v13 offset:36864
  v_mfma_f32_16x16x32_bf16 v[76:79], v[36:39], v[20:23], v[76:79]
  ds_read_b64_tr_b16 v[54:55], v13 offset:37376
  v_mfma_f32_16x16x32_bf16 v[80:83], v[40:43], v[20:23], v[80:83]
  ds_read_b64_tr_b16 v[56:57], v15 offset:36864
  v_mfma_f32_16x16x32_bf16 v[84:87], v[28:31], v[24:27], v[84:87]
  ds_read_b64_tr_b16 v[58:59], v15 offset:37376
  v_mfma_f32_16x16x32_bf16 v[88:91], v[32:35], v[24:27], v[88:91]
  ds_read_b128 v[48:51], v11 offset:34816
  v_mfma_f32_16x16x32_bf16 v[92:95], v[36:39], v[24:27], v[92:95]
  ds_read_b64_tr_b16 v[60:61], v17 offset:36864
  v_mfma_f32_16x16x32_bf16 v[96:99], v[40:43], v[24:27], v[96:99]
  ds_read_b64_tr_b16 v[62:63], v17 offset:37376
  v_mfma_f32_16x16x32_bf16 v[116:119], v[28:31], v[132:135], v[116:119]
  ds_read_b64_tr_b16 v[64:65], v19 offset:36864
  v_mfma_f32_16x16x32_bf16 v[120:123], v[32:35], v[132:135], v[120:123]
  ds_read_b64_tr_b16 v[66:67], v19 offset:37376
  v_mfma_f32_16x16x32_bf16 v[124:127], v[36:39], v[132:135], v[124:127]
  v_mfma_f32_16x16x32_bf16 v[128:131], v[40:43], v[132:135], v[128:131]
  s_waitcnt lgkmcnt(0)
  s_barrier
  v_mfma_f32_16x16x32_bf16 v[68:71], v[52:55], v[44:47], v[68:71]
  ds_read_b128 v[20:23], v8 offset:0
  v_mfma_f32_16x16x32_bf16 v[72:75], v[56:59], v[44:47], v[72:75]
  ds_read_b64_tr_b16 v[28:29], v12 offset:8192
  v_mfma_f32_16x16x32_bf16 v[76:79], v[60:63], v[44:47], v[76:79]
  ds_read_b64_tr_b16 v[30:31], v12 offset:8704
  v_mfma_f32_16x16x32_bf16 v[80:83], v[64:67], v[44:47], v[80:83]
  ds_read_b64_tr_b16 v[32:33], v14 offset:8192
  v_mfma_f32_16x16x32_bf16 v[84:87], v[52:55], v[48:51], v[84:87]
  ds_read_b64_tr_b16 v[34:35], v14 offset:8704
  v_mfma_f32_16x16x32_bf16 v[88:91], v[56:59], v[48:51], v[88:91]
  ds_read_b128 v[24:27], v8 offset:2048
  v_mfma_f32_16x16x32_bf16 v[92:95], v[60:63], v[48:51], v[92:95]
  ds_read_b64_tr_b16 v[36:37], v16 offset:8192
  v_mfma_f32_16x16x32_bf16 v[96:99], v[64:67], v[48:51], v[96:99]
  ds_read_b64_tr_b16 v[38:39], v16 offset:8704
  v_mfma_f32_16x16x32_bf16 v[116:119], v[52:55], v[132:135], v[116:119]
  ds_read_b64_tr_b16 v[40:41], v18 offset:8192
  v_mfma_f32_16x16x32_bf16 v[120:123], v[56:59], v[132:135], v[120:123]
  ds_read_b64_tr_b16 v[42:43], v18 offset:8704
  v_mfma_f32_16x16x32_bf16 v[124:127], v[60:63], v[132:135], v[124:127]
  v_mfma_f32_16x16x32_bf16 v[128:131], v[64:67], v[132:135], v[128:131]
  s_waitcnt lgkmcnt(0)
  v_mfma_f32_16x16x32_bf16 v[68:71], v[28:31], v[20:23], v[68:71]
  ds_read_b128 v[44:47], v10 offset:0
  v_mfma_f32_16x16x32_bf16 v[72:75], v[32:35], v[20:23], v[72:75]
  ds_read_b64_tr_b16 v[52:53], v12 offset:12288
  v_mfma_f32_16x16x32_bf16 v[76:79], v[36:39], v[20:23], v[76:79]
  ds_read_b64_tr_b16 v[54:55], v12 offset:12800
  v_mfma_f32_16x16x32_bf16 v[80:83], v[40:43], v[20:23], v[80:83]
  ds_read_b64_tr_b16 v[56:57], v14 offset:12288
  v_mfma_f32_16x16x32_bf16 v[84:87], v[28:31], v[24:27], v[84:87]
  ds_read_b64_tr_b16 v[58:59], v14 offset:12800
  v_mfma_f32_16x16x32_bf16 v[88:91], v[32:35], v[24:27], v[88:91]
  ds_read_b128 v[48:51], v10 offset:2048
  v_mfma_f32_16x16x32_bf16 v[92:95], v[36:39], v[24:27], v[92:95]
  ds_read_b64_tr_b16 v[60:61], v16 offset:12288
  v_mfma_f32_16x16x32_bf16 v[96:99], v[40:43], v[24:27], v[96:99]
  ds_read_b64_tr_b16 v[62:63], v16 offset:12800
  v_mfma_f32_16x16x32_bf16 v[116:119], v[28:31], v[132:135], v[116:119]
  ds_read_b64_tr_b16 v[64:65], v18 offset:12288
  v_mfma_f32_16x16x32_bf16 v[120:123], v[32:35], v[132:135], v[120:123]
  ds_read_b64_tr_b16 v[66:67], v18 offset:12800
  v_mfma_f32_16x16x32_bf16 v[124:127], v[36:39], v[132:135], v[124:127]
  v_mfma_f32_16x16x32_bf16 v[128:131], v[40:43], v[132:135], v[128:131]
  s_waitcnt lgkmcnt(0)
  s_barrier
  v_mfma_f32_16x16x32_bf16 v[68:71], v[52:55], v[44:47], v[68:71]
  ds_read_b128 v[20:23], v8 offset:32768
  v_mfma_f32_16x16x32_bf16 v[72:75], v[56:59], v[44:47], v[72:75]
  ds_read_b64_tr_b16 v[28:29], v12 offset:40960
  v_mfma_f32_16x16x32_bf16 v[76:79], v[60:63], v[44:47], v[76:79]
  ds_read_b64_tr_b16 v[30:31], v12 offset:41472
  v_mfma_f32_16x16x32_bf16 v[80:83], v[64:67], v[44:47], v[80:83]
  ds_read_b64_tr_b16 v[32:33], v14 offset:40960
  v_mfma_f32_16x16x32_bf16 v[84:87], v[52:55], v[48:51], v[84:87]
  ds_read_b64_tr_b16 v[34:35], v14 offset:41472
  v_mfma_f32_16x16x32_bf16 v[88:91], v[56:59], v[48:51], v[88:91]
  ds_read_b128 v[24:27], v8 offset:34816
  v_mfma_f32_16x16x32_bf16 v[92:95], v[60:63], v[48:51], v[92:95]
  ds_read_b64_tr_b16 v[36:37], v16 offset:40960
  v_mfma_f32_16x16x32_bf16 v[96:99], v[64:67], v[48:51], v[96:99]
  ds_read_b64_tr_b16 v[38:39], v16 offset:41472
  v_mfma_f32_16x16x32_bf16 v[116:119], v[52:55], v[132:135], v[116:119]
  ds_read_b64_tr_b16 v[40:41], v18 offset:40960
  v_mfma_f32_16x16x32_bf16 v[120:123], v[56:59], v[132:135], v[120:123]
  ds_read_b64_tr_b16 v[42:43], v18 offset:41472
  v_mfma_f32_16x16x32_bf16 v[124:127], v[60:63], v[132:135], v[124:127]
  v_mfma_f32_16x16x32_bf16 v[128:131], v[64:67], v[132:135], v[128:131]
  s_waitcnt lgkmcnt(0)
  v_mfma_f32_16x16x32_bf16 v[68:71], v[28:31], v[20:23], v[68:71]
  ds_read_b128 v[44:47], v10 offset:32768
  v_mfma_f32_16x16x32_bf16 v[72:75], v[32:35], v[20:23], v[72:75]
  ds_read_b64_tr_b16 v[52:53], v12 offset:45056
  v_mfma_f32_16x16x32_bf16 v[76:79], v[36:39], v[20:23], v[76:79]
  ds_read_b64_tr_b16 v[54:55], v12 offset:45568
  v_mfma_f32_16x16x32_bf16 v[80:83], v[40:43], v[20:23], v[80:83]
  ds_read_b64_tr_b16 v[56:57], v14 offset:45056
  v_mfma_f32_16x16x32_bf16 v[84:87], v[28:31], v[24:27], v[84:87]
  ds_read_b64_tr_b16 v[58:59], v14 offset:45568
  v_mfma_f32_16x16x32_bf16 v[88:91], v[32:35], v[24:27], v[88:91]
  ds_read_b128 v[48:51], v10 offset:34816
  v_mfma_f32_16x16x32_bf16 v[92:95], v[36:39], v[24:27], v[92:95]
  ds_read_b64_tr_b16 v[60:61], v16 offset:45056
  v_mfma_f32_16x16x32_bf16 v[96:99], v[40:43], v[24:27], v[96:99]
  ds_read_b64_tr_b16 v[62:63], v16 offset:45568
  v_mfma_f32_16x16x32_bf16 v[116:119], v[28:31], v[132:135], v[116:119]
  ds_read_b64_tr_b16 v[64:65], v18 offset:45056
  v_mfma_f32_16x16x32_bf16 v[120:123], v[32:35], v[132:135], v[120:123]
  ds_read_b64_tr_b16 v[66:67], v18 offset:45568
  v_mfma_f32_16x16x32_bf16 v[124:127], v[36:39], v[132:135], v[124:127]
  v_mfma_f32_16x16x32_bf16 v[128:131], v[40:43], v[132:135], v[128:131]
  s_waitcnt lgkmcnt(0)
  s_barrier
  v_mfma_f32_16x16x32_bf16 v[68:71], v[52:55], v[44:47], v[68:71]
  ds_read_b128 v[20:23], v9 offset:0
  v_mfma_f32_16x16x32_bf16 v[72:75], v[56:59], v[44:47], v[72:75]
  ds_read_b64_tr_b16 v[28:29], v13 offset:8192
  v_mfma_f32_16x16x32_bf16 v[76:79], v[60:63], v[44:47], v[76:79]
  ds_read_b64_tr_b16 v[30:31], v13 offset:8704
  v_mfma_f32_16x16x32_bf16 v[80:83], v[64:67], v[44:47], v[80:83]
  ds_read_b64_tr_b16 v[32:33], v15 offset:8192
  v_mfma_f32_16x16x32_bf16 v[84:87], v[52:55], v[48:51], v[84:87]
  ds_read_b64_tr_b16 v[34:35], v15 offset:8704
  v_mfma_f32_16x16x32_bf16 v[88:91], v[56:59], v[48:51], v[88:91]
  ds_read_b128 v[24:27], v9 offset:2048
  v_mfma_f32_16x16x32_bf16 v[92:95], v[60:63], v[48:51], v[92:95]
  ds_read_b64_tr_b16 v[36:37], v17 offset:8192
  v_mfma_f32_16x16x32_bf16 v[96:99], v[64:67], v[48:51], v[96:99]
  ds_read_b64_tr_b16 v[38:39], v17 offset:8704
  v_mfma_f32_16x16x32_bf16 v[116:119], v[52:55], v[132:135], v[116:119]
  ds_read_b64_tr_b16 v[40:41], v19 offset:8192
  v_mfma_f32_16x16x32_bf16 v[120:123], v[56:59], v[132:135], v[120:123]
  ds_read_b64_tr_b16 v[42:43], v19 offset:8704
  v_mfma_f32_16x16x32_bf16 v[124:127], v[60:63], v[132:135], v[124:127]
  v_mfma_f32_16x16x32_bf16 v[128:131], v[64:67], v[132:135], v[128:131]
  s_waitcnt lgkmcnt(0)
  v_mfma_f32_16x16x32_bf16 v[68:71], v[28:31], v[20:23], v[68:71]
  ds_read_b128 v[44:47], v11 offset:0
  v_mfma_f32_16x16x32_bf16 v[72:75], v[32:35], v[20:23], v[72:75]
  ds_read_b64_tr_b16 v[52:53], v13 offset:12288
  v_mfma_f32_16x16x32_bf16 v[76:79], v[36:39], v[20:23], v[76:79]
  ds_read_b64_tr_b16 v[54:55], v13 offset:12800
  v_mfma_f32_16x16x32_bf16 v[80:83], v[40:43], v[20:23], v[80:83]
  ds_read_b64_tr_b16 v[56:57], v15 offset:12288
  v_mfma_f32_16x16x32_bf16 v[84:87], v[28:31], v[24:27], v[84:87]
  ds_read_b64_tr_b16 v[58:59], v15 offset:12800
  v_mfma_f32_16x16x32_bf16 v[88:91], v[32:35], v[24:27], v[88:91]
  ds_read_b128 v[48:51], v11 offset:2048
  v_mfma_f32_16x16x32_bf16 v[92:95], v[36:39], v[24:27], v[92:95]
  ds_read_b64_tr_b16 v[60:61], v17 offset:12288
  v_mfma_f32_16x16x32_bf16 v[96:99], v[40:43], v[24:27], v[96:99]
  ds_read_b64_tr_b16 v[62:63], v17 offset:12800
  v_mfma_f32_16x16x32_bf16 v[116:119], v[28:31], v[132:135], v[116:119]
  ds_read_b64_tr_b16 v[64:65], v19 offset:12288
  v_mfma_f32_16x16x32_bf16 v[120:123], v[32:35], v[132:135], v[120:123]
  ds_read_b64_tr_b16 v[66:67], v19 offset:12800
  v_mfma_f32_16x16x32_bf16 v[124:127], v[36:39], v[132:135], v[124:127]
  v_mfma_f32_16x16x32_bf16 v[128:131], v[40:43], v[132:135], v[128:131]
  s_waitcnt lgkmcnt(0)
  s_barrier
  v_mfma_f32_16x16x32_bf16 v[68:71], v[52:55], v[44:47], v[68:71]
  ds_read_b128 v[20:23], v9 offset:32768
  v_mfma_f32_16x16x32_bf16 v[72:75], v[56:59], v[44:47], v[72:75]
  ds_read_b64_tr_b16 v[28:29], v13 offset:40960
  v_mfma_f32_16x16x32_bf16 v[76:79], v[60:63], v[44:47], v[76:79]
  ds_read_b64_tr_b16 v[30:31], v13 offset:41472
  v_mfma_f32_16x16x32_bf16 v[80:83], v[64:67], v[44:47], v[80:83]
  ds_read_b64_tr_b16 v[32:33], v15 offset:40960
  v_mfma_f32_16x16x32_bf16 v[84:87], v[52:55], v[48:51], v[84:87]
  ds_read_b64_tr_b16 v[34:35], v15 offset:41472
  v_mfma_f32_16x16x32_bf16 v[88:91], v[56:59], v[48:51], v[88:91]
  ds_read_b128 v[24:27], v9 offset:34816
  v_mfma_f32_16x16x32_bf16 v[92:95], v[60:63], v[48:51], v[92:95]
  ds_read_b64_tr_b16 v[36:37], v17 offset:40960
  v_mfma_f32_16x16x32_bf16 v[96:99], v[64:67], v[48:51], v[96:99]
  ds_read_b64_tr_b16 v[38:39], v17 offset:41472
  v_mfma_f32_16x16x32_bf16 v[116:119], v[52:55], v[132:135], v[116:119]
  ds_read_b64_tr_b16 v[40:41], v19 offset:40960
  v_mfma_f32_16x16x32_bf16 v[120:123], v[56:59], v[132:135], v[120:123]
  ds_read_b64_tr_b16 v[42:43], v19 offset:41472
  v_mfma_f32_16x16x32_bf16 v[124:127], v[60:63], v[132:135], v[124:127]
  v_mfma_f32_16x16x32_bf16 v[128:131], v[64:67], v[132:135], v[128:131]
  s_waitcnt lgkmcnt(0)
  v_mfma_f32_16x16x32_bf16 v[68:71], v[28:31], v[20:23], v[68:71]
  ds_read_b128 v[44:47], v11 offset:32768
  v_mfma_f32_16x16x32_bf16 v[72:75], v[32:35], v[20:23], v[72:75]
  ds_read_b64_tr_b16 v[52:53], v13 offset:45056
  v_mfma_f32_16x16x32_bf16 v[76:79], v[36:39], v[20:23], v[76:79]
  ds_read_b64_tr_b16 v[54:55], v13 offset:45568
  v_mfma_f32_16x16x32_bf16 v[80:83], v[40:43], v[20:23], v[80:83]
  ds_read_b64_tr_b16 v[56:57], v15 offset:45056
  v_mfma_f32_16x16x32_bf16 v[84:87], v[28:31], v[24:27], v[84:87]
  ds_read_b64_tr_b16 v[58:59], v15 offset:45568
  v_mfma_f32_16x16x32_bf16 v[88:91], v[32:35], v[24:27], v[88:91]
  ds_read_b128 v[48:51], v11 offset:34816
  v_mfma_f32_16x16x32_bf16 v[92:95], v[36:39], v[24:27], v[92:95]
  ds_read_b64_tr_b16 v[60:61], v17 offset:45056
  v_mfma_f32_16x16x32_bf16 v[96:99], v[40:43], v[24:27], v[96:99]
  ds_read_b64_tr_b16 v[62:63], v17 offset:45568
  v_mfma_f32_16x16x32_bf16 v[116:119], v[28:31], v[132:135], v[116:119]
  ds_read_b64_tr_b16 v[64:65], v19 offset:45056
  v_mfma_f32_16x16x32_bf16 v[120:123], v[32:35], v[132:135], v[120:123]
  ds_read_b64_tr_b16 v[66:67], v19 offset:45568
  v_mfma_f32_16x16x32_bf16 v[124:127], v[36:39], v[132:135], v[124:127]
  v_mfma_f32_16x16x32_bf16 v[128:131], v[40:43], v[132:135], v[128:131]
  s_waitcnt lgkmcnt(0)
  s_barrier
  v_mfma_f32_16x16x32_bf16 v[68:71], v[52:55], v[44:47], v[68:71]
  v_mfma_f32_16x16x32_bf16 v[72:75], v[56:59], v[44:47], v[72:75]
  v_mfma_f32_16x16x32_bf16 v[76:79], v[60:63], v[44:47], v[76:79]
  v_mfma_f32_16x16x32_bf16 v[80:83], v[64:67], v[44:47], v[80:83]
  v_mfma_f32_16x16x32_bf16 v[84:87], v[52:55], v[48:51], v[84:87]
  v_mfma_f32_16x16x32_bf16 v[88:91], v[56:59], v[48:51], v[88:91]
  v_mfma_f32_16x16x32_bf16 v[92:95], v[60:63], v[48:51], v[92:95]
  v_mfma_f32_16x16x32_bf16 v[96:99], v[64:67], v[48:51], v[96:99]
  v_mfma_f32_16x16x32_bf16 v[116:119], v[52:55], v[132:135], v[116:119]
  v_mfma_f32_16x16x32_bf16 v[120:123], v[56:59], v[132:135], v[120:123]
  v_mfma_f32_16x16x32_bf16 v[124:127], v[60:63], v[132:135], v[124:127]
  v_mfma_f32_16x16x32_bf16 v[128:131], v[64:67], v[132:135], v[128:131]
  s_nop 7
  s_nop 3
  v_mov_b32 v148, 0x358637bd
  v_sub_f32 v140, 0, v136
  v_mov_b32 v142, v137
  v_mul_f32 v143, 0x3fb8aa3b, v137
  v_sub_f32 v144, 0, v138
  v_mov_b32 v146, v139
  v_mul_f32 v147, 0x3fb8aa3b, v139
  v_pk_fma_f32 v[68:69], v[116:117], v[140:141], v[68:69] op_sel_hi:[1,0,1]
  v_pk_fma_f32 v[70:71], v[118:119], v[140:141], v[70:71] op_sel_hi:[1,0,1]
  v_pk_fma_f32 v[72:73], v[120:121], v[140:141], v[72:73] op_sel_hi:[1,0,1]
  v_pk_fma_f32 v[74:75], v[122:123], v[140:141], v[74:75] op_sel_hi:[1,0,1]
  v_pk_mul_f32 v[20:21], v[68:69], v[142:143] op_sel:[0,1] op_sel_hi:[1,1]
  v_pk_mul_f32 v[22:23], v[70:71], v[142:143] op_sel:[0,1] op_sel_hi:[1,1]
  v_pk_mul_f32 v[24:25], v[72:73], v[142:143] op_sel:[0,1] op_sel_hi:[1,1]
  v_pk_mul_f32 v[26:27], v[74:75], v[142:143] op_sel:[0,1] op_sel_hi:[1,1]
  v_pk_fma_f32 v[68:69], v[68:69], v[142:143], v[148:149] op_sel_hi:[1,0,0]
  v_pk_fma_f32 v[70:71], v[70:71], v[142:143], v[148:149] op_sel_hi:[1,0,0]
  v_pk_fma_f32 v[72:73], v[72:73], v[142:143], v[148:149] op_sel_hi:[1,0,0]
  v_pk_fma_f32 v[74:75], v[74:75], v[142:143], v[148:149] op_sel_hi:[1,0,0]
  v_exp_f32_e64 v20, v20 clamp
  v_exp_f32_e64 v21, v21 clamp
  v_exp_f32_e64 v22, v22 clamp
  v_exp_f32_e64 v23, v23 clamp
  v_exp_f32_e64 v24, v24 clamp
  v_exp_f32_e64 v25, v25 clamp
  v_exp_f32_e64 v26, v26 clamp
  v_exp_f32_e64 v27, v27 clamp
  v_max_f32 v68, v148, v68
  v_max_f32 v69, v148, v69
  v_max_f32 v70, v148, v70
  v_max_f32 v71, v148, v71
  v_max_f32 v72, v148, v72
  v_max_f32 v73, v148, v73
  v_max_f32 v74, v148, v74
  v_max_f32 v75, v148, v75
  v_pk_add_f32 v[68:69], v[68:69], v[20:21]
  v_pk_add_f32 v[70:71], v[70:71], v[22:23]
  v_pk_add_f32 v[72:73], v[72:73], v[24:25]
  v_pk_add_f32 v[74:75], v[74:75], v[26:27]
  v_cvt_pk_bf16_f32 v176, v68, v69
  v_cvt_pk_bf16_f32 v177, v70, v71
  v_cvt_pk_bf16_f32 v178, v72, v73
  v_cvt_pk_bf16_f32 v179, v74, v75
  v_pk_fma_f32 v[76:77], v[124:125], v[140:141], v[76:77] op_sel_hi:[1,0,1]
  v_pk_fma_f32 v[78:79], v[126:127], v[140:141], v[78:79] op_sel_hi:[1,0,1]
  v_pk_fma_f32 v[80:81], v[128:129], v[140:141], v[80:81] op_sel_hi:[1,0,1]
  v_pk_fma_f32 v[82:83], v[130:131], v[140:141], v[82:83] op_sel_hi:[1,0,1]
  v_pk_mul_f32 v[20:21], v[76:77], v[142:143] op_sel:[0,1] op_sel_hi:[1,1]
  v_pk_mul_f32 v[22:23], v[78:79], v[142:143] op_sel:[0,1] op_sel_hi:[1,1]
  v_pk_mul_f32 v[24:25], v[80:81], v[142:143] op_sel:[0,1] op_sel_hi:[1,1]
  v_pk_mul_f32 v[26:27], v[82:83], v[142:143] op_sel:[0,1] op_sel_hi:[1,1]
  v_pk_fma_f32 v[76:77], v[76:77], v[142:143], v[148:149] op_sel_hi:[1,0,0]
  v_pk_fma_f32 v[78:79], v[78:79], v[142:143], v[148:149] op_sel_hi:[1,0,0]
  v_pk_fma_f32 v[80:81], v[80:81], v[142:143], v[148:149] op_sel_hi:[1,0,0]
  v_pk_fma_f32 v[82:83], v[82:83], v[142:143], v[148:149] op_sel_hi:[1,0,0]
  v_exp_f32_e64 v20, v20 clamp
  v_exp_f32_e64 v21, v21 clamp
  v_exp_f32_e64 v22, v22 clamp
  v_exp_f32_e64 v23, v23 clamp
  v_exp_f32_e64 v24, v24 clamp
  v_exp_f32_e64 v25, v25 clamp
  v_exp_f32_e64 v26, v26 clamp
  v_exp_f32_e64 v27, v27 clamp
  v_max_f32 v76, v148, v76
  v_max_f32 v77, v148, v77
  v_max_f32 v78, v148, v78
  v_max_f32 v79, v148, v79
  v_max_f32 v80, v148, v80
  v_max_f32 v81, v148, v81
  v_max_f32 v82, v148, v82
  v_max_f32 v83, v148, v83
  v_pk_add_f32 v[76:77], v[76:77], v[20:21]
  v_pk_add_f32 v[78:79], v[78:79], v[22:23]
  v_pk_add_f32 v[80:81], v[80:81], v[24:25]
  v_pk_add_f32 v[82:83], v[82:83], v[26:27]
  v_cvt_pk_bf16_f32 v180, v76, v77
  v_cvt_pk_bf16_f32 v181, v78, v79
  v_cvt_pk_bf16_f32 v182, v80, v81
  v_cvt_pk_bf16_f32 v183, v82, v83
  v_pk_fma_f32 v[84:85], v[116:117], v[144:145], v[84:85] op_sel_hi:[1,0,1]
  v_pk_fma_f32 v[86:87], v[118:119], v[144:145], v[86:87] op_sel_hi:[1,0,1]
  v_pk_fma_f32 v[88:89], v[120:121], v[144:145], v[88:89] op_sel_hi:[1,0,1]
  v_pk_fma_f32 v[90:91], v[122:123], v[144:145], v[90:91] op_sel_hi:[1,0,1]
  v_pk_mul_f32 v[20:21], v[84:85], v[146:147] op_sel:[0,1] op_sel_hi:[1,1]
  v_pk_mul_f32 v[22:23], v[86:87], v[146:147] op_sel:[0,1] op_sel_hi:[1,1]
  v_pk_mul_f32 v[24:25], v[88:89], v[146:147] op_sel:[0,1] op_sel_hi:[1,1]
  v_pk_mul_f32 v[26:27], v[90:91], v[146:147] op_sel:[0,1] op_sel_hi:[1,1]
  v_pk_fma_f32 v[84:85], v[84:85], v[146:147], v[148:149] op_sel_hi:[1,0,0]
  v_pk_fma_f32 v[86:87], v[86:87], v[146:147], v[148:149] op_sel_hi:[1,0,0]
  v_pk_fma_f32 v[88:89], v[88:89], v[146:147], v[148:149] op_sel_hi:[1,0,0]
  v_pk_fma_f32 v[90:91], v[90:91], v[146:147], v[148:149] op_sel_hi:[1,0,0]
  v_exp_f32_e64 v20, v20 clamp
  v_exp_f32_e64 v21, v21 clamp
  v_exp_f32_e64 v22, v22 clamp
  v_exp_f32_e64 v23, v23 clamp
  v_exp_f32_e64 v24, v24 clamp
  v_exp_f32_e64 v25, v25 clamp
  v_exp_f32_e64 v26, v26 clamp
  v_exp_f32_e64 v27, v27 clamp
  v_max_f32 v84, v148, v84
  v_max_f32 v85, v148, v85
  v_max_f32 v86, v148, v86
  v_max_f32 v87, v148, v87
  v_max_f32 v88, v148, v88
  v_max_f32 v89, v148, v89
  v_max_f32 v90, v148, v90
  v_max_f32 v91, v148, v91
  v_pk_add_f32 v[84:85], v[84:85], v[20:21]
  v_pk_add_f32 v[86:87], v[86:87], v[22:23]
  v_pk_add_f32 v[88:89], v[88:89], v[24:25]
  v_pk_add_f32 v[90:91], v[90:91], v[26:27]
  v_cvt_pk_bf16_f32 v184, v84, v85
  v_cvt_pk_bf16_f32 v185, v86, v87
  v_cvt_pk_bf16_f32 v186, v88, v89
  v_cvt_pk_bf16_f32 v187, v90, v91
  v_pk_fma_f32 v[92:93], v[124:125], v[144:145], v[92:93] op_sel_hi:[1,0,1]
  v_pk_fma_f32 v[94:95], v[126:127], v[144:145], v[94:95] op_sel_hi:[1,0,1]
  v_pk_fma_f32 v[96:97], v[128:129], v[144:145], v[96:97] op_sel_hi:[1,0,1]
  v_pk_fma_f32 v[98:99], v[130:131], v[144:145], v[98:99] op_sel_hi:[1,0,1]
  v_pk_mul_f32 v[20:21], v[92:93], v[146:147] op_sel:[0,1] op_sel_hi:[1,1]
  v_pk_mul_f32 v[22:23], v[94:95], v[146:147] op_sel:[0,1] op_sel_hi:[1,1]
  v_pk_mul_f32 v[24:25], v[96:97], v[146:147] op_sel:[0,1] op_sel_hi:[1,1]
  v_pk_mul_f32 v[26:27], v[98:99], v[146:147] op_sel:[0,1] op_sel_hi:[1,1]
  v_pk_fma_f32 v[92:93], v[92:93], v[146:147], v[148:149] op_sel_hi:[1,0,0]
  v_pk_fma_f32 v[94:95], v[94:95], v[146:147], v[148:149] op_sel_hi:[1,0,0]
  v_pk_fma_f32 v[96:97], v[96:97], v[146:147], v[148:149] op_sel_hi:[1,0,0]
  v_pk_fma_f32 v[98:99], v[98:99], v[146:147], v[148:149] op_sel_hi:[1,0,0]
  v_exp_f32_e64 v20, v20 clamp
  v_exp_f32_e64 v21, v21 clamp
  v_exp_f32_e64 v22, v22 clamp
  v_exp_f32_e64 v23, v23 clamp
  v_exp_f32_e64 v24, v24 clamp
  v_exp_f32_e64 v25, v25 clamp
  v_exp_f32_e64 v26, v26 clamp
  v_exp_f32_e64 v27, v27 clamp
  v_max_f32 v92, v148, v92
  v_max_f32 v93, v148, v93
  v_max_f32 v94, v148, v94
  v_max_f32 v95, v148, v95
  v_max_f32 v96, v148, v96
  v_max_f32 v97, v148, v97
  v_max_f32 v98, v148, v98
  v_max_f32 v99, v148, v99
  v_pk_add_f32 v[92:93], v[92:93], v[20:21]
  v_pk_add_f32 v[94:95], v[94:95], v[22:23]
  v_pk_add_f32 v[96:97], v[96:97], v[24:25]
  v_pk_add_f32 v[98:99], v[98:99], v[26:27]
  v_cvt_pk_bf16_f32 v188, v92, v93
  v_cvt_pk_bf16_f32 v189, v94, v95
  v_cvt_pk_bf16_f32 v190, v96, v97
  v_cvt_pk_bf16_f32 v191, v98, v99
  v_lshlrev_b32 v20, 3, v0
  v_add_u32 v20, 0x20800, v20
  v_lshrrev_b32 v21, 4, v0
  v_lshlrev_b32 v21, 3, v21
  v_add_u32 v21, 0x21000, v21
  s_barrier
  ds_read_b64 v[192:193], v20 offset:0
  ds_read_b64 v[194:195], v21 offset:0
  ds_read_b64 v[196:197], v20 offset:512
  ds_read_b64 v[198:199], v21 offset:32
  ds_read_b64 v[200:201], v20 offset:1024
  ds_read_b64 v[202:203], v21 offset:64
  ds_read_b64 v[204:205], v20 offset:1536
  ds_read_b64 v[206:207], v21 offset:96
  s_waitcnt lgkmcnt(0)
  v_mfma_f32_16x16x16_bf16 v[68:71], v[192:193], v[176:177], 0
  v_mfma_f32_16x16x16_bf16 v[100:103], v[194:195], v[176:177], 0
  v_mfma_f32_16x16x16_bf16 v[72:75], v[196:197], v[178:179], 0
  v_mfma_f32_16x16x16_bf16 v[104:107], v[198:199], v[178:179], 0
  v_mfma_f32_16x16x16_bf16 v[76:79], v[200:201], v[180:181], 0
  v_mfma_f32_16x16x16_bf16 v[108:111], v[202:203], v[180:181], 0
  v_mfma_f32_16x16x16_bf16 v[80:83], v[204:205], v[182:183], 0
  v_mfma_f32_16x16x16_bf16 v[112:115], v[206:207], v[182:183], 0
  v_mfma_f32_16x16x16_bf16 v[84:87], v[192:193], v[184:185], 0
  v_mfma_f32_16x16x16_bf16 v[116:119], v[194:195], v[184:185], 0
  v_mfma_f32_16x16x16_bf16 v[88:91], v[196:197], v[186:187], 0
  v_mfma_f32_16x16x16_bf16 v[120:123], v[198:199], v[186:187], 0
  v_mfma_f32_16x16x16_bf16 v[92:95], v[200:201], v[188:189], 0
  v_mfma_f32_16x16x16_bf16 v[124:127], v[202:203], v[188:189], 0
  v_mfma_f32_16x16x16_bf16 v[96:99], v[204:205], v[190:191], 0
  v_mfma_f32_16x16x16_bf16 v[128:131], v[206:207], v[190:191], 0
  s_nop 7
  s_nop 3
  v_add_f32 v100, 0x358637bd, v100
  v_add_f32 v104, 0x358637bd, v104
  v_add_f32 v108, 0x358637bd, v108
  v_add_f32 v112, 0x358637bd, v112
  v_add_f32 v116, 0x358637bd, v116
  v_add_f32 v120, 0x358637bd, v120
  v_add_f32 v124, 0x358637bd, v124
  v_add_f32 v128, 0x358637bd, v128
  v_rcp_f32 v100, v100
  v_rcp_f32 v104, v104
  v_rcp_f32 v108, v108
  v_rcp_f32 v112, v112
  v_rcp_f32 v116, v116
  v_rcp_f32 v120, v120
  v_rcp_f32 v124, v124
  v_rcp_f32 v128, v128
  s_nop 0
  v_pk_mul_f32 v[68:69], v[68:69], v[100:101] op_sel_hi:[1,0]
  v_pk_mul_f32 v[70:71], v[70:71], v[100:101] op_sel_hi:[1,0]
  v_pk_mul_f32 v[72:73], v[72:73], v[104:105] op_sel_hi:[1,0]
  v_pk_mul_f32 v[74:75], v[74:75], v[104:105] op_sel_hi:[1,0]
  v_cvt_pk_bf16_f32 v28, v68, v69
  v_cvt_pk_bf16_f32 v29, v70, v71
  v_cvt_pk_bf16_f32 v30, v72, v73
  v_cvt_pk_bf16_f32 v31, v74, v75
  ds_write_b64 v150, v[28:29] offset:0
  ds_write_b64 v151, v[30:31] offset:0
  v_pk_mul_f32 v[76:77], v[76:77], v[108:109] op_sel_hi:[1,0]
  v_pk_mul_f32 v[78:79], v[78:79], v[108:109] op_sel_hi:[1,0]
  v_pk_mul_f32 v[80:81], v[80:81], v[112:113] op_sel_hi:[1,0]
  v_pk_mul_f32 v[82:83], v[82:83], v[112:113] op_sel_hi:[1,0]
  v_cvt_pk_bf16_f32 v32, v76, v77
  v_cvt_pk_bf16_f32 v33, v78, v79
  v_cvt_pk_bf16_f32 v34, v80, v81
  v_cvt_pk_bf16_f32 v35, v82, v83
  ds_write_b64 v152, v[32:33] offset:0
  ds_write_b64 v153, v[34:35] offset:0
  ds_read_b128 v[160:163], v154 offset:0
  ds_read_b128 v[164:167], v154 offset:1024
  v_pk_mul_f32 v[84:85], v[84:85], v[116:117] op_sel_hi:[1,0]
  v_pk_mul_f32 v[86:87], v[86:87], v[116:117] op_sel_hi:[1,0]
  v_pk_mul_f32 v[88:89], v[88:89], v[120:121] op_sel_hi:[1,0]
  v_pk_mul_f32 v[90:91], v[90:91], v[120:121] op_sel_hi:[1,0]
  s_waitcnt lgkmcnt(0)
  buffer_store_dwordx4 v[160:163], v156, s[16:19], s72 offen sc1
  buffer_store_dwordx4 v[164:167], v156, s[16:19], s73 offen sc1
  v_cvt_pk_bf16_f32 v28, v84, v85
  v_cvt_pk_bf16_f32 v29, v86, v87
  v_cvt_pk_bf16_f32 v30, v88, v89
  v_cvt_pk_bf16_f32 v31, v90, v91
  ds_write_b64 v150, v[28:29] offset:2048
  ds_write_b64 v151, v[30:31] offset:2048
  v_pk_mul_f32 v[92:93], v[92:93], v[124:125] op_sel_hi:[1,0]
  v_pk_mul_f32 v[94:95], v[94:95], v[124:125] op_sel_hi:[1,0]
  v_pk_mul_f32 v[96:97], v[96:97], v[128:129] op_sel_hi:[1,0]
  v_pk_mul_f32 v[98:99], v[98:99], v[128:129] op_sel_hi:[1,0]
  v_cvt_pk_bf16_f32 v32, v92, v93
  v_cvt_pk_bf16_f32 v33, v94, v95
  v_cvt_pk_bf16_f32 v34, v96, v97
  v_cvt_pk_bf16_f32 v35, v98, v99
  ds_write_b64 v152, v[32:33] offset:2048
  ds_write_b64 v153, v[34:35] offset:2048
  ds_read_b128 v[168:171], v154 offset:2048
  ds_read_b128 v[172:175], v154 offset:3072
  s_waitcnt lgkmcnt(0)
  buffer_store_dwordx4 v[168:171], v157, s[16:19], s72 offen sc1
  buffer_store_dwordx4 v[172:175], v157, s[16:19], s73 offen sc1
  s_add_u32 s99, s32, 56
  s_branch c3_entry
c_mix:
  v_and_b32 v2, 15, v0
  v_lshrrev_b32 v3, 4, v0
  v_bfe_u32 v4, v0, 1, 3
  v_xor_b32 v5, v3, v4
  v_lshlrev_b32 v5, 4, v5
  v_lshl_add_u32 v5, v2, 7, v5
  s_lshl_b32 s62, s3, 12
  v_add_u32 v8, s62, v5
  v_xor_b32 v10, 64, v8
  v_add_u32 v9, 0x10000, v8
  v_add_u32 v11, 0x10000, v10
  v_bfe_u32 v4, v0, 2, 2
  v_lshl_add_u32 v7, v3, 3, v4
  v_lshlrev_b32 v7, 7, v7
  v_and_b32 v5, 3, v0
  v_lshl_add_u32 v7, v5, 3, v7
  v_add_u32 v7, 0x4000, v7
  v_lshrrev_b32 v4, 1, v4
  v_and_b32 v6, 1, v3
  v_lshl_or_b32 v6, v6, 1, v4
  v_lshl_add_u32 v12, v6, 5, v7
  v_xor_b32 v14, 32, v12
  v_xor_b32 v16, 64, v12
  v_xor_b32 v18, 96, v12
  v_add_u32 v13, 0x10000, v12
  v_add_u32 v15, 0x10000, v14
  v_add_u32 v17, 0x10000, v16
  v_add_u32 v19, 0x10000, v18
  v_mov_b32 v132, 0x3f803f80
  v_mov_b32 v133, 0x3f803f80
  v_mov_b32 v134, 0x3f803f80
  v_mov_b32 v135, 0x3f803f80
  s_add_u32 s28, s56, 0x500000
  s_addc_u32 s29, s57, 0
  s_mov_b32 s30, 0x240000
  s_mov_b32 s31, 0x00020000
  s_mov_b32 s75, 1152
  s_lshl_b32 s72, s33, 7
  s_add_u32 s73, s72, 9216
  s_lshl_b32 s4, s3, 12
  s_add_u32 s4, s4, 0x22900
  v_lshrrev_b32 v150, 5, v0
  v_and_b32 v151, 7, v0
  v_xor_b32 v150, v150, v151
  v_lshlrev_b32 v150, 4, v150
  v_and_b32 v151, 15, v0
  v_lshl_add_u32 v150, v151, 7, v150
  v_bfe_u32 v151, v0, 4, 1
  v_lshl_add_u32 v150, v151, 3, v150
  v_add_u32 v150, s4, v150
  v_xor_b32 v151, 32, v150
  v_xor_b32 v152, 64, v150
  v_xor_b32 v153, 96, v150
  v_lshrrev_b32 v156, 3, v0
  v_and_b32 v157, 7, v0
  v_xor_b32 v154, v156, v157
  v_lshlrev_b32 v154, 4, v154
  v_lshl_add_u32 v154, v156, 7, v154
  v_add_u32 v154, s4, v154
  s_lshl_b32 s4, s32, 7
  s_lshl_b32 s5, s3, 5
  s_add_u32 s4, s4, s5
  v_add_u32 v156, s4, v156
  v_lshlrev_b32 v157, 4, v157
  v_mad_u32_u24 v156, v156, s75, v157
  s_lshl_b32 s4, s75, 4
  v_add_u32 v157, s4, v156
  s_barrier
  ds_read_b128 v[20:23], v8 offset:0
  ds_read_b64_tr_b16 v[28:29], v12 offset:0
  ds_read_b64_tr_b16 v[30:31], v12 offset:512
  ds_read_b64_tr_b16 v[32:33], v14 offset:0
  ds_read_b64_tr_b16 v[34:35], v14 offset:512
  ds_read_b128 v[24:27], v8 offset:2048
  ds_read_b64_tr_b16 v[36:37], v16 offset:0
  ds_read_b64_tr_b16 v[38:39], v16 offset:512
  ds_read_b64_tr_b16 v[40:41], v18 offset:0
  ds_read_b64_tr_b16 v[42:43], v18 offset:512
  s_waitcnt lgkmcnt(0)
  v_mfma_f32_16x16x32_bf16 v[68:71], v[28:31], v[20:23], 0
  ds_read_b128 v[44:47], v10 offset:0
  v_mfma_f32_16x16x32_bf16 v[72:75], v[32:35], v[20:23], 0
  ds_read_b64_tr_b16 v[52:53], v12 offset:4096
  v_mfma_f32_16x16x32_bf16 v[76:79], v[36:39], v[20:23], 0
  ds_read_b64_tr_b16 v[54:55], v12 offset:4608
  v_mfma_f32_16x16x32_bf16 v[80:83], v[40:43], v[20:23], 0
  ds_read_b64_tr_b16 v[56:57], v14 offset:4096
  v_mfma_f32_16x16x32_bf16 v[84:87], v[28:31], v[24:27], 0
  ds_read_b64_tr_b16 v[58:59], v14 offset:4608
  v_mfma_f32_16x16x32_bf16 v[88:91], v[32:35], v[24:27], 0
  ds_read_b128 v[48:51], v10 offset:2048
  v_mfma_f32_16x16x32_bf16 v[92:95], v[36:39], v[24:27], 0
  ds_read_b64_tr_b16 v[60:61], v16 offset:4096
  v_mfma_f32_16x16x32_bf16 v[96:99], v[40:43], v[24:27], 0
  ds_read_b64_tr_b16 v[62:63], v16 offset:4608
  v_mfma_f32_16x16x32_bf16 v[100:103], v[20:23], v[20:23], 0
  ds_read_b64_tr_b16 v[64:65], v18 offset:4096
  v_mfma_f32_16x16x32_bf16 v[108:111], v[132:135], v[20:23], 0
  ds_read_b64_tr_b16 v[66:67], v18 offset:4608
  v_mfma_f32_16x16x32_bf16 v[104:107], v[24:27], v[24:27], 0
  v_mfma_f32_16x16x32_bf16 v[112:115], v[132:135], v[24:27], 0
  v_mfma_f32_16x16x32_bf16 v[116:119], v[28:31], v[132:135], 0
  v_mfma_f32_16x16x32_bf16 v[120:123], v[32:35], v[132:135], 0
  v_mfma_f32_16x16x32_bf16 v[124:127], v[36:39], v[132:135], 0
  v_mfma_f32_16x16x32_bf16 v[128:131], v[40:43], v[132:135], 0
  s_waitcnt lgkmcnt(0)
  s_barrier
  v_mfma_f32_16x16x32_bf16 v[68:71], v[52:55], v[44:47], v[68:71]
  ds_read_b128 v[20:23], v8 offset:32768
  v_mfma_f32_16x16x32_bf16 v[72:75], v[56:59], v[44:47], v[72:75]
  ds_read_b64_tr_b16 v[28:29], v12 offset:32768
  v_mfma_f32_16x16x32_bf16 v[76:79], v[60:63], v[44:47], v[76:79]
  ds_read_b64_tr_b16 v[30:31], v12 offset:33280
  v_mfma_f32_16x16x32_bf16 v[80:83], v[64:67], v[44:47], v[80:83]
  ds_read_b64_tr_b16 v[32:33], v14 offset:32768
  v_mfma_f32_16x16x32_bf16 v[84:87], v[52:55], v[48:51], v[84:87]
  ds_read_b64_tr_b16 v[34:35], v14 offset:33280
  v_mfma_f32_16x16x32_bf16 v[88:91], v[56:59], v[48:51], v[88:91]
  ds_read_b128 v[24:27], v8 offset:34816
  v_mfma_f32_16x16x32_bf16 v[92:95], v[60:63], v[48:51], v[92:95]
  ds_read_b64_tr_b16 v[36:37], v16 offset:32768
  v_mfma_f32_16x16x32_bf16 v[96:99], v[64:67], v[48:51], v[96:99]
  ds_read_b64_tr_b16 v[38:39], v16 offset:33280
  v_mfma_f32_16x16x32_bf16 v[100:103], v[44:47], v[44:47], v[100:103]
  ds_read_b64_tr_b16 v[40:41], v18 offset:32768
  v_mfma_f32_16x16x32_bf16 v[108:111], v[132:135], v[44:47], v[108:111]
  ds_read_b64_tr_b16 v[42:43], v18 offset:33280
  v_mfma_f32_16x16x32_bf16 v[104:107], v[48:51], v[48:51], v[104:107]
  v_mfma_f32_16x16x32_bf16 v[112:115], v[132:135], v[48:51], v[112:115]
  v_mfma_f32_16x16x32_bf16 v[116:119], v[52:55], v[132:135], v[116:119]
  v_mfma_f32_16x16x32_bf16 v[120:123], v[56:59], v[132:135], v[120:123]
  v_mfma_f32_16x16x32_bf16 v[124:127], v[60:63], v[132:135], v[124:127]
  v_mfma_f32_16x16x32_bf16 v[128:131], v[64:67], v[132:135], v[128:131]
  s_waitcnt lgkmcnt(0)
  v_mfma_f32_16x16x32_bf16 v[68:71], v[28:31], v[20:23], v[68:71]
  ds_read_b128 v[44:47], v10 offset:32768
  v_mfma_f32_16x16x32_bf16 v[72:75], v[32:35], v[20:23], v[72:75]
  ds_read_b64_tr_b16 v[52:53], v12 offset:36864
  v_mfma_f32_16x16x32_bf16 v[76:79], v[36:39], v[20:23], v[76:79]
  ds_read_b64_tr_b16 v[54:55], v12 offset:37376
  v_mfma_f32_16x16x32_bf16 v[80:83], v[40:43], v[20:23], v[80:83]
  ds_read_b64_tr_b16 v[56:57], v14 offset:36864
  v_mfma_f32_16x16x32_bf16 v[84:87], v[28:31], v[24:27], v[84:87]
  ds_read_b64_tr_b16 v[58:59], v14 offset:37376
  v_mfma_f32_16x16x32_bf16 v[88:91], v[32:35], v[24:27], v[88:91]
  ds_read_b128 v[48:51], v10 offset:34816
  v_mfma_f32_16x16x32_bf16 v[92:95], v[36:39], v[24:27], v[92:95]
  ds_read_b64_tr_b16 v[60:61], v16 offset:36864
  v_mfma_f32_16x16x32_bf16 v[96:99], v[40:43], v[24:27], v[96:99]
  ds_read_b64_tr_b16 v[62:63], v16 offset:37376
  v_mfma_f32_16x16x32_bf16 v[100:103], v[20:23], v[20:23], v[100:103]
  ds_read_b64_tr_b16 v[64:65], v18 offset:36864
  v_mfma_f32_16x16x32_bf16 v[108:111], v[132:135], v[20:23], v[108:111]
  ds_read_b64_tr_b16 v[66:67], v18 offset:37376
  v_mfma_f32_16x16x32_bf16 v[104:107], v[24:27], v[24:27], v[104:107]
  v_mfma_f32_16x16x32_bf16 v[112:115], v[132:135], v[24:27], v[112:115]
  v_mfma_f32_16x16x32_bf16 v[116:119], v[28:31], v[132:135], v[116:119]
  v_mfma_f32_16x16x32_bf16 v[120:123], v[32:35], v[132:135], v[120:123]
  v_mfma_f32_16x16x32_bf16 v[124:127], v[36:39], v[132:135], v[124:127]
  v_mfma_f32_16x16x32_bf16 v[128:131], v[40:43], v[132:135], v[128:131]
  s_waitcnt lgkmcnt(0)
  s_barrier
  v_mfma_f32_16x16x32_bf16 v[68:71], v[52:55], v[44:47], v[68:71]
  ds_read_b128 v[20:23], v9 offset:0
  v_mfma_f32_16x16x32_bf16 v[72:75], v[56:59], v[44:47], v[72:75]
  ds_read_b64_tr_b16 v[28:29], v13 offset:0
  v_mfma_f32_16x16x32_bf16 v[76:79], v[60:63], v[44:47], v[76:79]
  ds_read_b64_tr_b16 v[30:31], v13 offset:512
  v_mfma_f32_16x16x32_bf16 v[80:83], v[64:67], v[44:47], v[80:83]
  ds_read_b64_tr_b16 v[32:33], v15 offset:0
  v_mfma_f32_16x16x32_bf16 v[84:87], v[52:55], v[48:51], v[84:87]
  ds_read_b64_tr_b16 v[34:35], v15 offset:512
  v_mfma_f32_16x16x32_bf16 v[88:91], v[56:59], v[48:51], v[88:91]
  ds_read_b128 v[24:27], v9 offset:2048
  v_mfma_f32_16x16x32_bf16 v[92:95], v[60:63], v[48:51], v[92:95]
  ds_read_b64_tr_b16 v[36:37], v17 offset:0
  v_mfma_f32_16x16x32_bf16 v[96:99], v[64:67], v[48:51], v[96:99]
  ds_read_b64_tr_b16 v[38:39], v17 offset:512
  v_mfma_f32_16x16x32_bf16 v[100:103], v[44:47], v[44:47], v[100:103]
  ds_read_b64_tr_b16 v[40:41], v19 offset:0
  v_mfma_f32_16x16x32_bf16 v[108:111], v[132:135], v[44:47], v[108:111]
  ds_read_b64_tr_b16 v[42:43], v19 offset:512
  v_mfma_f32_16x16x32_bf16 v[104:107], v[48:51], v[48:51], v[104:107]
  v_mfma_f32_16x16x32_bf16 v[112:115], v[132:135], v[48:51], v[112:115]
  v_mfma_f32_16x16x32_bf16 v[116:119], v[52:55], v[132:135], v[116:119]
  v_mfma_f32_16x16x32_bf16 v[120:123], v[56:59], v[132:135], v[120:123]
  v_mfma_f32_16x16x32_bf16 v[124:127], v[60:63], v[132:135], v[124:127]
  v_mfma_f32_16x16x32_bf16 v[128:131], v[64:67], v[132:135], v[128:131]
  s_waitcnt lgkmcnt(0)
  v_mfma_f32_16x16x32_bf16 v[68:71], v[28:31], v[20:23], v[68:71]
  ds_read_b128 v[44:47], v11 offset:0
  v_mfma_f32_16x16x32_bf16 v[72:75], v[32:35], v[20:23], v[72:75]
  ds_read_b64_tr_b16 v[52:53], v13 offset:4096
  v_mfma_f32_16x16x32_bf16 v[76:79], v[36:39], v[20:23], v[76:79]
  ds_read_b64_tr_b16 v[54:55], v13 offset:4608
  v_mfma_f32_16x16x32_bf16 v[80:83], v[40:43], v[20:23], v[80:83]
  ds_read_b64_tr_b16 v[56:57], v15 offset:4096
  v_mfma_f32_16x16x32_bf16 v[84:87], v[28:31], v[24:27], v[84:87]
  ds_read_b64_tr_b16 v[58:59], v15 offset:4608
  v_mfma_f32_16x16x32_bf16 v[88:91], v[32:35], v[24:27], v[88:91]
  ds_read_b128 v[48:51], v11 offset:2048
  v_mfma_f32_16x16x32_bf16 v[92:95], v[36:39], v[24:27], v[92:95]
  ds_read_b64_tr_b16 v[60:61], v17 offset:4096
  v_mfma_f32_16x16x32_bf16 v[96:99], v[40:43], v[24:27], v[96:99]
  ds_read_b64_tr_b16 v[62:63], v17 offset:4608
  v_mfma_f32_16x16x32_bf16 v[100:103], v[20:23], v[20:23], v[100:103]
  ds_read_b64_tr_b16 v[64:65], v19 offset:4096
  v_mfma_f32_16x16x32_bf16 v[108:111], v[132:135], v[20:23], v[108:111]
  ds_read_b64_tr_b16 v[66:67], v19 offset:4608
  v_mfma_f32_16x16x32_bf16 v[104:107], v[24:27], v[24:27], v[104:107]
  v_mfma_f32_16x16x32_bf16 v[112:115], v[132:135], v[24:27], v[112:115]
  v_mfma_f32_16x16x32_bf16 v[116:119], v[28:31], v[132:135], v[116:119]
  v_mfma_f32_16x16x32_bf16 v[120:123], v[32:35], v[132:135], v[120:123]
  v_mfma_f32_16x16x32_bf16 v[124:127], v[36:39], v[132:135], v[124:127]
  v_mfma_f32_16x16x32_bf16 v[128:131], v[40:43], v[132:135], v[128:131]
  s_waitcnt lgkmcnt(0)
  s_barrier
  v_mfma_f32_16x16x32_bf16 v[68:71], v[52:55], v[44:47], v[68:71]
  ds_read_b128 v[20:23], v9 offset:32768
  v_mfma_f32_16x16x32_bf16 v[72:75], v[56:59], v[44:47], v[72:75]
  ds_read_b64_tr_b16 v[28:29], v13 offset:32768
  v_mfma_f32_16x16x32_bf16 v[76:79], v[60:63], v[44:47], v[76:79]
  ds_read_b64_tr_b16 v[30:31], v13 offset:33280
  v_mfma_f32_16x16x32_bf16 v[80:83], v[64:67], v[44:47], v[80:83]
  ds_read_b64_tr_b16 v[32:33], v15 offset:32768
  v_mfma_f32_16x16x32_bf16 v[84:87], v[52:55], v[48:51], v[84:87]
  ds_read_b64_tr_b16 v[34:35], v15 offset:33280
  v_mfma_f32_16x16x32_bf16 v[88:91], v[56:59], v[48:51], v[88:91]
  ds_read_b128 v[24:27], v9 offset:34816
  v_mfma_f32_16x16x32_bf16 v[92:95], v[60:63], v[48:51], v[92:95]
  ds_read_b64_tr_b16 v[36:37], v17 offset:32768
  v_mfma_f32_16x16x32_bf16 v[96:99], v[64:67], v[48:51], v[96:99]
  ds_read_b64_tr_b16 v[38:39], v17 offset:33280
  v_mfma_f32_16x16x32_bf16 v[100:103], v[44:47], v[44:47], v[100:103]
  ds_read_b64_tr_b16 v[40:41], v19 offset:32768
  v_mfma_f32_16x16x32_bf16 v[108:111], v[132:135], v[44:47], v[108:111]
  ds_read_b64_tr_b16 v[42:43], v19 offset:33280
  v_mfma_f32_16x16x32_bf16 v[104:107], v[48:51], v[48:51], v[104:107]
  v_mfma_f32_16x16x32_bf16 v[112:115], v[132:135], v[48:51], v[112:115]
  v_mfma_f32_16x16x32_bf16 v[116:119], v[52:55], v[132:135], v[116:119]
  v_mfma_f32_16x16x32_bf16 v[120:123], v[56:59], v[132:135], v[120:123]
  v_mfma_f32_16x16x32_bf16 v[124:127], v[60:63], v[132:135], v[124:127]
  v_mfma_f32_16x16x32_bf16 v[128:131], v[64:67], v[132:135], v[128:131]
  s_waitcnt lgkmcnt(0)
  v_mfma_f32_16x16x32_bf16 v[68:71], v[28:31], v[20:23], v[68:71]
  ds_read_b128 v[44:47], v11 offset:32768
  v_mfma_f32_16x16x32_bf16 v[72:75], v[32:35], v[20:23], v[72:75]
  ds_read_b64_tr_b16 v[52:53], v13 offset:36864
  v_mfma_f32_16x16x32_bf16 v[76:79], v[36:39], v[20:23], v[76:79]
  ds_read_b64_tr_b16 v[54:55], v13 offset:37376
  v_mfma_f32_16x16x32_bf16 v[80:83], v[40:43], v[20:23], v[80:83]
  ds_read_b64_tr_b16 v[56:57], v15 offset:36864
  v_mfma_f32_16x16x32_bf16 v[84:87], v[28:31], v[24:27], v[84:87]
  ds_read_b64_tr_b16 v[58:59], v15 offset:37376
  v_mfma_f32_16x16x32_bf16 v[88:91], v[32:35], v[24:27], v[88:91]
  ds_read_b128 v[48:51], v11 offset:34816
  v_mfma_f32_16x16x32_bf16 v[92:95], v[36:39], v[24:27], v[92:95]
  ds_read_b64_tr_b16 v[60:61], v17 offset:36864
  v_mfma_f32_16x16x32_bf16 v[96:99], v[40:43], v[24:27], v[96:99]
  ds_read_b64_tr_b16 v[62:63], v17 offset:37376
  v_mfma_f32_16x16x32_bf16 v[100:103], v[20:23], v[20:23], v[100:103]
  ds_read_b64_tr_b16 v[64:65], v19 offset:36864
  v_mfma_f32_16x16x32_bf16 v[108:111], v[132:135], v[20:23], v[108:111]
  ds_read_b64_tr_b16 v[66:67], v19 offset:37376
  v_mfma_f32_16x16x32_bf16 v[104:107], v[24:27], v[24:27], v[104:107]
  v_mfma_f32_16x16x32_bf16 v[112:115], v[132:135], v[24:27], v[112:115]
  v_mfma_f32_16x16x32_bf16 v[116:119], v[28:31], v[132:135], v[116:119]
  v_mfma_f32_16x16x32_bf16 v[120:123], v[32:35], v[132:135], v[120:123]
  v_mfma_f32_16x16x32_bf16 v[124:127], v[36:39], v[132:135], v[124:127]
  v_mfma_f32_16x16x32_bf16 v[128:131], v[40:43], v[132:135], v[128:131]
  s_waitcnt lgkmcnt(0)
  s_barrier
  v_mfma_f32_16x16x32_bf16 v[68:71], v[52:55], v[44:47], v[68:71]
  ds_read_b128 v[20:23], v8 offset:0
  v_mfma_f32_16x16x32_bf16 v[72:75], v[56:59], v[44:47], v[72:75]
  ds_read_b64_tr_b16 v[28:29], v12 offset:8192
  v_mfma_f32_16x16x32_bf16 v[76:79], v[60:63], v[44:47], v[76:79]
  ds_read_b64_tr_b16 v[30:31], v12 offset:8704
  v_mfma_f32_16x16x32_bf16 v[80:83], v[64:67], v[44:47], v[80:83]
  ds_read_b64_tr_b16 v[32:33], v14 offset:8192
  v_mfma_f32_16x16x32_bf16 v[84:87], v[52:55], v[48:51], v[84:87]
  ds_read_b64_tr_b16 v[34:35], v14 offset:8704
  v_mfma_f32_16x16x32_bf16 v[88:91], v[56:59], v[48:51], v[88:91]
  ds_read_b128 v[24:27], v8 offset:2048
  v_mfma_f32_16x16x32_bf16 v[92:95], v[60:63], v[48:51], v[92:95]
  ds_read_b64_tr_b16 v[36:37], v16 offset:8192
  v_mfma_f32_16x16x32_bf16 v[96:99], v[64:67], v[48:51], v[96:99]
  ds_read_b64_tr_b16 v[38:39], v16 offset:8704
  v_mfma_f32_16x16x32_bf16 v[100:103], v[44:47], v[44:47], v[100:103]
  ds_read_b64_tr_b16 v[40:41], v18 offset:8192
  v_mfma_f32_16x16x32_bf16 v[108:111], v[132:135], v[44:47], v[108:111]
  ds_read_b64_tr_b16 v[42:43], v18 offset:8704
  v_mfma_f32_16x16x32_bf16 v[104:107], v[48:51], v[48:51], v[104:107]
  v_mfma_f32_16x16x32_bf16 v[112:115], v[132:135], v[48:51], v[112:115]
  v_mfma_f32_16x16x32_bf16 v[116:119], v[52:55], v[132:135], v[116:119]
  v_mfma_f32_16x16x32_bf16 v[120:123], v[56:59], v[132:135], v[120:123]
  v_mfma_f32_16x16x32_bf16 v[124:127], v[60:63], v[132:135], v[124:127]
  v_mfma_f32_16x16x32_bf16 v[128:131], v[64:67], v[132:135], v[128:131]
  s_waitcnt lgkmcnt(0)
  v_mfma_f32_16x16x32_bf16 v[68:71], v[28:31], v[20:23], v[68:71]
  ds_read_b128 v[44:47], v10 offset:0
  v_mfma_f32_16x16x32_bf16 v[72:75], v[32:35], v[20:23], v[72:75]
  ds_read_b64_tr_b16 v[52:53], v12 offset:12288
  v_mfma_f32_16x16x32_bf16 v[76:79], v[36:39], v[20:23], v[76:79]
  ds_read_b64_tr_b16 v[54:55], v12 offset:12800
  v_mfma_f32_16x16x32_bf16 v[80:83], v[40:43], v[20:23], v[80:83]
  ds_read_b64_tr_b16 v[56:57], v14 offset:12288
  v_mfma_f32_16x16x32_bf16 v[84:87], v[28:31], v[24:27], v[84:87]
  ds_read_b64_tr_b16 v[58:59], v14 offset:12800
  v_mfma_f32_16x16x32_bf16 v[88:91], v[32:35], v[24:27], v[88:91]
  ds_read_b128 v[48:51], v10 offset:2048
  v_mfma_f32_16x16x32_bf16 v[92:95], v[36:39], v[24:27], v[92:95]
  ds_read_b64_tr_b16 v[60:61], v16 offset:12288
  v_mfma_f32_16x16x32_bf16 v[96:99], v[40:43], v[24:27], v[96:99]
  ds_read_b64_tr_b16 v[62:63], v16 offset:12800
  v_mfma_f32_16x16x32_bf16 v[100:103], v[20:23], v[20:23], v[100:103]
  ds_read_b64_tr_b16 v[64:65], v18 offset:12288
  v_mfma_f32_16x16x32_bf16 v[108:111], v[132:135], v[20:23], v[108:111]
  ds_read_b64_tr_b16 v[66:67], v18 offset:12800
  v_mfma_f32_16x16x32_bf16 v[104:107], v[24:27], v[24:27], v[104:107]
  v_mfma_f32_16x16x32_bf16 v[112:115], v[132:135], v[24:27], v[112:115]
  v_mfma_f32_16x16x32_bf16 v[116:119], v[28:31], v[132:135], v[116:119]
  v_mfma_f32_16x16x32_bf16 v[120:123], v[32:35], v[132:135], v[120:123]
  v_mfma_f32_16x16x32_bf16 v[124:127], v[36:39], v[132:135], v[124:127]
  v_mfma_f32_16x16x32_bf16 v[128:131], v[40:43], v[132:135], v[128:131]
  s_waitcnt lgkmcnt(0)
  s_barrier
  v_mfma_f32_16x16x32_bf16 v[68:71], v[52:55], v[44:47], v[68:71]
  ds_read_b128 v[20:23], v8 offset:32768
  v_mfma_f32_16x16x32_bf16 v[72:75], v[56:59], v[44:47], v[72:75]
  ds_read_b64_tr_b16 v[28:29], v12 offset:40960
  v_mfma_f32_16x16x32_bf16 v[76:79], v[60:63], v[44:47], v[76:79]
  ds_read_b64_tr_b16 v[30:31], v12 offset:41472
  v_mfma_f32_16x16x32_bf16 v[80:83], v[64:67], v[44:47], v[80:83]
  ds_read_b64_tr_b16 v[32:33], v14 offset:40960
  v_mfma_f32_16x16x32_bf16 v[84:87], v[52:55], v[48:51], v[84:87]
  ds_read_b64_tr_b16 v[34:35], v14 offset:41472
  v_mfma_f32_16x16x32_bf16 v[88:91], v[56:59], v[48:51], v[88:91]
  ds_read_b128 v[24:27], v8 offset:34816
  v_mfma_f32_16x16x32_bf16 v[92:95], v[60:63], v[48:51], v[92:95]
  ds_read_b64_tr_b16 v[36:37], v16 offset:40960
  v_mfma_f32_16x16x32_bf16 v[96:99], v[64:67], v[48:51], v[96:99]
  ds_read_b64_tr_b16 v[38:39], v16 offset:41472
  v_mfma_f32_16x16x32_bf16 v[100:103], v[44:47], v[44:47], v[100:103]
  ds_read_b64_tr_b16 v[40:41], v18 offset:40960
  v_mfma_f32_16x16x32_bf16 v[108:111], v[132:135], v[44:47], v[108:111]
  ds_read_b64_tr_b16 v[42:43], v18 offset:41472
  v_mfma_f32_16x16x32_bf16 v[104:107], v[48:51], v[48:51], v[104:107]
  v_mfma_f32_16x16x32_bf16 v[112:115], v[132:135], v[48:51], v[112:115]
  v_mfma_f32_16x16x32_bf16 v[116:119], v[52:55], v[132:135], v[116:119]
  v_mfma_f32_16x16x32_bf16 v[120:123], v[56:59], v[132:135], v[120:123]
  v_mfma_f32_16x16x32_bf16 v[124:127], v[60:63], v[132:135], v[124:127]
  v_mfma_f32_16x16x32_bf16 v[128:131], v[64:67], v[132:135], v[128:131]
  s_waitcnt lgkmcnt(0)
  v_mfma_f32_16x16x32_bf16 v[68:71], v[28:31], v[20:23], v[68:71]
  ds_read_b128 v[44:47], v10 offset:32768
  v_mfma_f32_16x16x32_bf16 v[72:75], v[32:35], v[20:23], v[72:75]
  ds_read_b64_tr_b16 v[52:53], v12 offset:45056
  v_mfma_f32_16x16x32_bf16 v[76:79], v[36:39], v[20:23], v[76:79]
  ds_read_b64_tr_b16 v[54:55], v12 offset:45568
  v_mfma_f32_16x16x32_bf16 v[80:83], v[40:43], v[20:23], v[80:83]
  ds_read_b64_tr_b16 v[56:57], v14 offset:45056
  v_mfma_f32_16x16x32_bf16 v[84:87], v[28:31], v[24:27], v[84:87]
  ds_read_b64_tr_b16 v[58:59], v14 offset:45568
  v_mfma_f32_16x16x32_bf16 v[88:91], v[32:35], v[24:27], v[88:91]
  ds_read_b128 v[48:51], v10 offset:34816
  v_mfma_f32_16x16x32_bf16 v[92:95], v[36:39], v[24:27], v[92:95]
  ds_read_b64_tr_b16 v[60:61], v16 offset:45056
  v_mfma_f32_16x16x32_bf16 v[96:99], v[40:43], v[24:27], v[96:99]
  ds_read_b64_tr_b16 v[62:63], v16 offset:45568
  v_mfma_f32_16x16x32_bf16 v[100:103], v[20:23], v[20:23], v[100:103]
  ds_read_b64_tr_b16 v[64:65], v18 offset:45056
  v_mfma_f32_16x16x32_bf16 v[108:111], v[132:135], v[20:23], v[108:111]
  ds_read_b64_tr_b16 v[66:67], v18 offset:45568
  v_mfma_f32_16x16x32_bf16 v[104:107], v[24:27], v[24:27], v[104:107]
  v_mfma_f32_16x16x32_bf16 v[112:115], v[132:135], v[24:27], v[112:115]
  v_mfma_f32_16x16x32_bf16 v[116:119], v[28:31], v[132:135], v[116:119]
  v_mfma_f32_16x16x32_bf16 v[120:123], v[32:35], v[132:135], v[120:123]
  v_mfma_f32_16x16x32_bf16 v[124:127], v[36:39], v[132:135], v[124:127]
  v_mfma_f32_16x16x32_bf16 v[128:131], v[40:43], v[132:135], v[128:131]
  s_waitcnt lgkmcnt(0)
  s_barrier
  v_mfma_f32_16x16x32_bf16 v[68:71], v[52:55], v[44:47], v[68:71]
  ds_read_b128 v[20:23], v9 offset:0
  v_mfma_f32_16x16x32_bf16 v[72:75], v[56:59], v[44:47], v[72:75]
  ds_read_b64_tr_b16 v[28:29], v13 offset:8192
  v_mfma_f32_16x16x32_bf16 v[76:79], v[60:63], v[44:47], v[76:79]
  ds_read_b64_tr_b16 v[30:31], v13 offset:8704
  v_mfma_f32_16x16x32_bf16 v[80:83], v[64:67], v[44:47], v[80:83]
  ds_read_b64_tr_b16 v[32:33], v15 offset:8192
  v_mfma_f32_16x16x32_bf16 v[84:87], v[52:55], v[48:51], v[84:87]
  ds_read_b64_tr_b16 v[34:35], v15 offset:8704
  v_mfma_f32_16x16x32_bf16 v[88:91], v[56:59], v[48:51], v[88:91]
  ds_read_b128 v[24:27], v9 offset:2048
  v_mfma_f32_16x16x32_bf16 v[92:95], v[60:63], v[48:51], v[92:95]
  ds_read_b64_tr_b16 v[36:37], v17 offset:8192
  v_mfma_f32_16x16x32_bf16 v[96:99], v[64:67], v[48:51], v[96:99]
  ds_read_b64_tr_b16 v[38:39], v17 offset:8704
  v_mfma_f32_16x16x32_bf16 v[100:103], v[44:47], v[44:47], v[100:103]
  ds_read_b64_tr_b16 v[40:41], v19 offset:8192
  v_mfma_f32_16x16x32_bf16 v[108:111], v[132:135], v[44:47], v[108:111]
  ds_read_b64_tr_b16 v[42:43], v19 offset:8704
  v_mfma_f32_16x16x32_bf16 v[104:107], v[48:51], v[48:51], v[104:107]
  v_mfma_f32_16x16x32_bf16 v[112:115], v[132:135], v[48:51], v[112:115]
  v_mfma_f32_16x16x32_bf16 v[116:119], v[52:55], v[132:135], v[116:119]
  v_mfma_f32_16x16x32_bf16 v[120:123], v[56:59], v[132:135], v[120:123]
  v_mfma_f32_16x16x32_bf16 v[124:127], v[60:63], v[132:135], v[124:127]
  v_mfma_f32_16x16x32_bf16 v[128:131], v[64:67], v[132:135], v[128:131]
  s_waitcnt lgkmcnt(0)
  v_mfma_f32_16x16x32_bf16 v[68:71], v[28:31], v[20:23], v[68:71]
  ds_read_b128 v[44:47], v11 offset:0
  v_mfma_f32_16x16x32_bf16 v[72:75], v[32:35], v[20:23], v[72:75]
  ds_read_b64_tr_b16 v[52:53], v13 offset:12288
  v_mfma_f32_16x16x32_bf16 v[76:79], v[36:39], v[20:23], v[76:79]
  ds_read_b64_tr_b16 v[54:55], v13 offset:12800
  v_mfma_f32_16x16x32_bf16 v[80:83], v[40:43], v[20:23], v[80:83]
  ds_read_b64_tr_b16 v[56:57], v15 offset:12288
  v_mfma_f32_16x16x32_bf16 v[84:87], v[28:31], v[24:27], v[84:87]
  ds_read_b64_tr_b16 v[58:59], v15 offset:12800
  v_mfma_f32_16x16x32_bf16 v[88:91], v[32:35], v[24:27], v[88:91]
  ds_read_b128 v[48:51], v11 offset:2048
  v_mfma_f32_16x16x32_bf16 v[92:95], v[36:39], v[24:27], v[92:95]
  ds_read_b64_tr_b16 v[60:61], v17 offset:12288
  v_mfma_f32_16x16x32_bf16 v[96:99], v[40:43], v[24:27], v[96:99]
  ds_read_b64_tr_b16 v[62:63], v17 offset:12800
  v_mfma_f32_16x16x32_bf16 v[100:103], v[20:23], v[20:23], v[100:103]
  ds_read_b64_tr_b16 v[64:65], v19 offset:12288
  v_mfma_f32_16x16x32_bf16 v[108:111], v[132:135], v[20:23], v[108:111]
  ds_read_b64_tr_b16 v[66:67], v19 offset:12800
  v_mfma_f32_16x16x32_bf16 v[104:107], v[24:27], v[24:27], v[104:107]
  v_mfma_f32_16x16x32_bf16 v[112:115], v[132:135], v[24:27], v[112:115]
  v_mfma_f32_16x16x32_bf16 v[116:119], v[28:31], v[132:135], v[116:119]
  v_mfma_f32_16x16x32_bf16 v[120:123], v[32:35], v[132:135], v[120:123]
  v_mfma_f32_16x16x32_bf16 v[124:127], v[36:39], v[132:135], v[124:127]
  v_mfma_f32_16x16x32_bf16 v[128:131], v[40:43], v[132:135], v[128:131]
  s_waitcnt lgkmcnt(0)
  s_barrier
  v_mfma_f32_16x16x32_bf16 v[68:71], v[52:55], v[44:47], v[68:71]
  ds_read_b128 v[20:23], v9 offset:32768
  v_mfma_f32_16x16x32_bf16 v[72:75], v[56:59], v[44:47], v[72:75]
  ds_read_b64_tr_b16 v[28:29], v13 offset:40960
  v_mfma_f32_16x16x32_bf16 v[76:79], v[60:63], v[44:47], v[76:79]
  ds_read_b64_tr_b16 v[30:31], v13 offset:41472
  v_mfma_f32_16x16x32_bf16 v[80:83], v[64:67], v[44:47], v[80:83]
  ds_read_b64_tr_b16 v[32:33], v15 offset:40960
  v_mfma_f32_16x16x32_bf16 v[84:87], v[52:55], v[48:51], v[84:87]
  ds_read_b64_tr_b16 v[34:35], v15 offset:41472
  v_mfma_f32_16x16x32_bf16 v[88:91], v[56:59], v[48:51], v[88:91]
  ds_read_b128 v[24:27], v9 offset:34816
  v_mfma_f32_16x16x32_bf16 v[92:95], v[60:63], v[48:51], v[92:95]
  ds_read_b64_tr_b16 v[36:37], v17 offset:40960
  v_mfma_f32_16x16x32_bf16 v[96:99], v[64:67], v[48:51], v[96:99]
  ds_read_b64_tr_b16 v[38:39], v17 offset:41472
  v_mfma_f32_16x16x32_bf16 v[100:103], v[44:47], v[44:47], v[100:103]
  ds_read_b64_tr_b16 v[40:41], v19 offset:40960
  v_mfma_f32_16x16x32_bf16 v[108:111], v[132:135], v[44:47], v[108:111]
  ds_read_b64_tr_b16 v[42:43], v19 offset:41472
  v_mfma_f32_16x16x32_bf16 v[104:107], v[48:51], v[48:51], v[104:107]
  v_mfma_f32_16x16x32_bf16 v[112:115], v[132:135], v[48:51], v[112:115]
  v_mfma_f32_16x16x32_bf16 v[116:119], v[52:55], v[132:135], v[116:119]
  v_mfma_f32_16x16x32_bf16 v[120:123], v[56:59], v[132:135], v[120:123]
  v_mfma_f32_16x16x32_bf16 v[124:127], v[60:63], v[132:135], v[124:127]
  v_mfma_f32_16x16x32_bf16 v[128:131], v[64:67], v[132:135], v[128:131]
  s_waitcnt lgkmcnt(0)
  v_mfma_f32_16x16x32_bf16 v[68:71], v[28:31], v[20:23], v[68:71]
  ds_read_b128 v[44:47], v11 offset:32768
  v_mfma_f32_16x16x32_bf16 v[72:75], v[32:35], v[20:23], v[72:75]
  ds_read_b64_tr_b16 v[52:53], v13 offset:45056
  v_mfma_f32_16x16x32_bf16 v[76:79], v[36:39], v[20:23], v[76:79]
  ds_read_b64_tr_b16 v[54:55], v13 offset:45568
  v_mfma_f32_16x16x32_bf16 v[80:83], v[40:43], v[20:23], v[80:83]
  ds_read_b64_tr_b16 v[56:57], v15 offset:45056
  v_mfma_f32_16x16x32_bf16 v[84:87], v[28:31], v[24:27], v[84:87]
  ds_read_b64_tr_b16 v[58:59], v15 offset:45568
  v_mfma_f32_16x16x32_bf16 v[88:91], v[32:35], v[24:27], v[88:91]
  ds_read_b128 v[48:51], v11 offset:34816
  v_mfma_f32_16x16x32_bf16 v[92:95], v[36:39], v[24:27], v[92:95]
  ds_read_b64_tr_b16 v[60:61], v17 offset:45056
  v_mfma_f32_16x16x32_bf16 v[96:99], v[40:43], v[24:27], v[96:99]
  ds_read_b64_tr_b16 v[62:63], v17 offset:45568
  v_mfma_f32_16x16x32_bf16 v[100:103], v[20:23], v[20:23], v[100:103]
  ds_read_b64_tr_b16 v[64:65], v19 offset:45056
  v_mfma_f32_16x16x32_bf16 v[108:111], v[132:135], v[20:23], v[108:111]
  ds_read_b64_tr_b16 v[66:67], v19 offset:45568
  v_mfma_f32_16x16x32_bf16 v[104:107], v[24:27], v[24:27], v[104:107]
  v_mfma_f32_16x16x32_bf16 v[112:115], v[132:135], v[24:27], v[112:115]
  v_mfma_f32_16x16x32_bf16 v[116:119], v[28:31], v[132:135], v[116:119]
  v_mfma_f32_16x16x32_bf16 v[120:123], v[32:35], v[132:135], v[120:123]
  v_mfma_f32_16x16x32_bf16 v[124:127], v[36:39], v[132:135], v[124:127]
  v_mfma_f32_16x16x32_bf16 v[128:131], v[40:43], v[132:135], v[128:131]
  s_waitcnt lgkmcnt(0)
  s_barrier
  v_mfma_f32_16x16x32_bf16 v[68:71], v[52:55], v[44:47], v[68:71]
  v_mfma_f32_16x16x32_bf16 v[72:75], v[56:59], v[44:47], v[72:75]
  v_mfma_f32_16x16x32_bf16 v[76:79], v[60:63], v[44:47], v[76:79]
  v_mfma_f32_16x16x32_bf16 v[80:83], v[64:67], v[44:47], v[80:83]
  v_mfma_f32_16x16x32_bf16 v[84:87], v[52:55], v[48:51], v[84:87]
  v_mfma_f32_16x16x32_bf16 v[88:91], v[56:59], v[48:51], v[88:91]
  v_mfma_f32_16x16x32_bf16 v[92:95], v[60:63], v[48:51], v[92:95]
  v_mfma_f32_16x16x32_bf16 v[96:99], v[64:67], v[48:51], v[96:99]
  v_mfma_f32_16x16x32_bf16 v[100:103], v[44:47], v[44:47], v[100:103]
  v_mfma_f32_16x16x32_bf16 v[108:111], v[132:135], v[44:47], v[108:111]
  v_mfma_f32_16x16x32_bf16 v[104:107], v[48:51], v[48:51], v[104:107]
  v_mfma_f32_16x16x32_bf16 v[112:115], v[132:135], v[48:51], v[112:115]
  v_mfma_f32_16x16x32_bf16 v[116:119], v[52:55], v[132:135], v[116:119]
  v_mfma_f32_16x16x32_bf16 v[120:123], v[56:59], v[132:135], v[120:123]
  v_mfma_f32_16x16x32_bf16 v[124:127], v[60:63], v[132:135], v[124:127]
  v_mfma_f32_16x16x32_bf16 v[128:131], v[64:67], v[132:135], v[128:131]
  s_nop 7
  s_nop 3
  s_mov_b32 s64, 0x22222222
  s_mov_b32 s65, 0x22222222
  s_mov_b32 s66, 0x44444444
  s_mov_b32 s67, 0x44444444
  s_mov_b32 s68, 0x88888888
  s_mov_b32 s69, 0x88888888
  s_mov_b32 s4, 0xf0000f
  s_mov_b32 s5, 0xf0000f00
  v_cndmask_b32 v36, v100, v101, s[64:65]
  v_mul_f32 v136, 0x3b000000, v108
  v_cndmask_b32 v36, v36, v102, s[66:67]
  v_cndmask_b32 v36, v36, v103, s[68:69]
  v_cndmask_b32 v36, 0, v36, s[4:5]
  v_cndmask_b32 v37, v104, v105, s[64:65]
  v_mul_f32 v138, 0x3b000000, v112
  v_cndmask_b32 v37, v37, v106, s[66:67]
  v_cndmask_b32 v37, v37, v107, s[68:69]
  v_cndmask_b32 v37, 0, v37, s[4:5]
  v_mov_b32 v38, v36
  v_mov_b32 v39, v37
  s_nop 1
  v_permlane32_swap_b32 v38, v36
  v_permlane32_swap_b32 v39, v37
  s_nop 1
  v_add_f32 v36, v36, v38
  v_add_f32 v37, v37, v39
  v_mov_b32 v38, v36
  v_mov_b32 v39, v37
  s_nop 1
  v_permlane16_swap_b32 v38, v36
  v_permlane16_swap_b32 v39, v37
  s_nop 1
  v_add_f32 v36, v36, v38
  v_add_f32 v37, v37, v39
  v_mul_f32 v36, 0x3b000000, v36
  v_fma_f32 v36, -v136, v136, v36
  v_add_f32 v36, 0x3727c5ac, v36
  v_rsq_f32 v137, v36
  v_mul_f32 v37, 0x3b000000, v37
  v_fma_f32 v37, -v138, v138, v37
  v_add_f32 v37, 0x3727c5ac, v37
  v_rsq_f32 v139, v37
  s_nop 0
  v_mul_f32 v20, v137, v137
  v_mul_f32 v20, 0xb727c5ac, v20
  v_add_f32 v20, 0x3f800054, v20
  v_rsq_f32 v20, v20
  v_mul_f32 v21, v139, v139
  v_mul_f32 v21, 0xb727c5ac, v21
  v_add_f32 v21, 0x3f800054, v21
  v_rsq_f32 v21, v21
  s_nop 0
  v_mul_f32 v28, v137, v20
  v_sub_f32 v140, 0, v136
  v_mul_f32 v141, 0xc0135761, v28
  v_mul_f32 v20, v28, v28
  v_rcp_f32 v143, v28
  v_mul_f32 v20, v20, v141
  v_mul_f32 v142, 0x3d372713, v20
  v_mul_f32 v29, v139, v21
  v_sub_f32 v144, 0, v138
  v_mul_f32 v145, 0xc0135761, v29
  v_mul_f32 v21, v29, v29
  v_rcp_f32 v147, v29
  v_mul_f32 v21, v21, v145
  v_mul_f32 v146, 0x3d372713, v21
  v_pk_fma_f32 v[68:69], v[116:117], v[140:141], v[68:69] op_sel_hi:[1,0,1]
  v_pk_fma_f32 v[70:71], v[118:119], v[140:141], v[70:71] op_sel_hi:[1,0,1]
  v_pk_fma_f32 v[72:73], v[120:121], v[140:141], v[72:73] op_sel_hi:[1,0,1]
  v_pk_fma_f32 v[74:75], v[122:123], v[140:141], v[74:75] op_sel_hi:[1,0,1]
  v_pk_mul_f32 v[20:21], v[68:69], v[68:69]
  v_pk_mul_f32 v[22:23], v[70:71], v[70:71]
  v_pk_mul_f32 v[24:25], v[72:73], v[72:73]
  v_pk_mul_f32 v[26:27], v[74:75], v[74:75]
  v_pk_fma_f32 v[20:21], v[20:21], v[142:143], v[140:141] op_sel:[0,0,1] op_sel_hi:[1,0,1]
  v_pk_fma_f32 v[22:23], v[22:23], v[142:143], v[140:141] op_sel:[0,0,1] op_sel_hi:[1,0,1]
  v_pk_fma_f32 v[24:25], v[24:25], v[142:143], v[140:141] op_sel:[0,0,1] op_sel_hi:[1,0,1]
  v_pk_fma_f32 v[26:27], v[26:27], v[142:143], v[140:141] op_sel:[0,0,1] op_sel_hi:[1,0,1]
  v_pk_mul_f32 v[20:21], v[68:69], v[20:21]
  v_pk_mul_f32 v[22:23], v[70:71], v[22:23]
  v_pk_mul_f32 v[24:25], v[72:73], v[24:25]
  v_pk_mul_f32 v[26:27], v[74:75], v[26:27]
  v_exp_f32 v20, v20
  v_exp_f32 v21, v21
  v_exp_f32 v22, v22
  v_exp_f32 v23, v23
  v_exp_f32 v24, v24
  v_exp_f32 v25, v25
  v_exp_f32 v26, v26
  v_exp_f32 v27, v27
  v_pk_fma_f32 v[20:21], v[20:21], v[142:143], v[142:143] op_sel:[0,1,1] op_sel_hi:[1,1,1]
  v_pk_fma_f32 v[22:23], v[22:23], v[142:143], v[142:143] op_sel:[0,1,1] op_sel_hi:[1,1,1]
  v_pk_fma_f32 v[24:25], v[24:25], v[142:143], v[142:143] op_sel:[0,1,1] op_sel_hi:[1,1,1]
  v_pk_fma_f32 v[26:27], v[26:27], v[142:143], v[142:143] op_sel:[0,1,1] op_sel_hi:[1,1,1]
  v_rcp_f32 v20, v20
  v_rcp_f32 v21, v21
  v_rcp_f32 v22, v22
  v_rcp_f32 v23, v23
  v_rcp_f32 v24, v24
  v_rcp_f32 v25, v25
  v_rcp_f32 v26, v26
  v_rcp_f32 v27, v27
  v_pk_mul_f32 v[20:21], v[68:69], v[20:21]
  v_pk_mul_f32 v[22:23], v[70:71], v[22:23]
  v_pk_mul_f32 v[24:25], v[72:73], v[24:25]
  v_pk_mul_f32 v[26:27], v[74:75], v[26:27]
  v_cvt_pk_bf16_f32 v28, v20, v21
  v_cvt_pk_bf16_f32 v29, v22, v23
  v_cvt_pk_bf16_f32 v30, v24, v25
  v_cvt_pk_bf16_f32 v31, v26, v27
  ds_write_b64 v150, v[28:29] offset:0
  ds_write_b64 v151, v[30:31] offset:0
  v_pk_fma_f32 v[76:77], v[124:125], v[140:141], v[76:77] op_sel_hi:[1,0,1]
  v_pk_fma_f32 v[78:79], v[126:127], v[140:141], v[78:79] op_sel_hi:[1,0,1]
  v_pk_fma_f32 v[80:81], v[128:129], v[140:141], v[80:81] op_sel_hi:[1,0,1]
  v_pk_fma_f32 v[82:83], v[130:131], v[140:141], v[82:83] op_sel_hi:[1,0,1]
  v_pk_mul_f32 v[20:21], v[76:77], v[76:77]
  v_pk_mul_f32 v[22:23], v[78:79], v[78:79]
  v_pk_mul_f32 v[24:25], v[80:81], v[80:81]
  v_pk_mul_f32 v[26:27], v[82:83], v[82:83]
  v_pk_fma_f32 v[20:21], v[20:21], v[142:143], v[140:141] op_sel:[0,0,1] op_sel_hi:[1,0,1]
  v_pk_fma_f32 v[22:23], v[22:23], v[142:143], v[140:141] op_sel:[0,0,1] op_sel_hi:[1,0,1]
  v_pk_fma_f32 v[24:25], v[24:25], v[142:143], v[140:141] op_sel:[0,0,1] op_sel_hi:[1,0,1]
  v_pk_fma_f32 v[26:27], v[26:27], v[142:143], v[140:141] op_sel:[0,0,1] op_sel_hi:[1,0,1]
  v_pk_mul_f32 v[20:21], v[76:77], v[20:21]
  v_pk_mul_f32 v[22:23], v[78:79], v[22:23]
  v_pk_mul_f32 v[24:25], v[80:81], v[24:25]
  v_pk_mul_f32 v[26:27], v[82:83], v[26:27]
  v_exp_f32 v20, v20
  v_exp_f32 v21, v21
  v_exp_f32 v22, v22
  v_exp_f32 v23, v23
  v_exp_f32 v24, v24
  v_exp_f32 v25, v25
  v_exp_f32 v26, v26
  v_exp_f32 v27, v27
  v_pk_fma_f32 v[20:21], v[20:21], v[142:143], v[142:143] op_sel:[0,1,1] op_sel_hi:[1,1,1]
  v_pk_fma_f32 v[22:23], v[22:23], v[142:143], v[142:143] op_sel:[0,1,1] op_sel_hi:[1,1,1]
  v_pk_fma_f32 v[24:25], v[24:25], v[142:143], v[142:143] op_sel:[0,1,1] op_sel_hi:[1,1,1]
  v_pk_fma_f32 v[26:27], v[26:27], v[142:143], v[142:143] op_sel:[0,1,1] op_sel_hi:[1,1,1]
  v_rcp_f32 v20, v20
  v_rcp_f32 v21, v21
  v_rcp_f32 v22, v22
  v_rcp_f32 v23, v23
  v_rcp_f32 v24, v24
  v_rcp_f32 v25, v25
  v_rcp_f32 v26, v26
  v_rcp_f32 v27, v27
  v_pk_mul_f32 v[20:21], v[76:77], v[20:21]
  v_pk_mul_f32 v[22:23], v[78:79], v[22:23]
  v_pk_mul_f32 v[24:25], v[80:81], v[24:25]
  v_pk_mul_f32 v[26:27], v[82:83], v[26:27]
  v_cvt_pk_bf16_f32 v32, v20, v21
  v_cvt_pk_bf16_f32 v33, v22, v23
  v_cvt_pk_bf16_f32 v34, v24, v25
  v_cvt_pk_bf16_f32 v35, v26, v27
  ds_write_b64 v152, v[32:33] offset:0
  ds_write_b64 v153, v[34:35] offset:0
  ds_read_b128 v[160:163], v154 offset:0
  ds_read_b128 v[164:167], v154 offset:1024
  v_pk_fma_f32 v[84:85], v[116:117], v[144:145], v[84:85] op_sel_hi:[1,0,1]
  v_pk_fma_f32 v[86:87], v[118:119], v[144:145], v[86:87] op_sel_hi:[1,0,1]
  v_pk_fma_f32 v[88:89], v[120:121], v[144:145], v[88:89] op_sel_hi:[1,0,1]
  v_pk_fma_f32 v[90:91], v[122:123], v[144:145], v[90:91] op_sel_hi:[1,0,1]
  v_pk_mul_f32 v[20:21], v[84:85], v[84:85]
  v_pk_mul_f32 v[22:23], v[86:87], v[86:87]
  v_pk_mul_f32 v[24:25], v[88:89], v[88:89]
  v_pk_mul_f32 v[26:27], v[90:91], v[90:91]
  v_pk_fma_f32 v[20:21], v[20:21], v[146:147], v[144:145] op_sel:[0,0,1] op_sel_hi:[1,0,1]
  v_pk_fma_f32 v[22:23], v[22:23], v[146:147], v[144:145] op_sel:[0,0,1] op_sel_hi:[1,0,1]
  v_pk_fma_f32 v[24:25], v[24:25], v[146:147], v[144:145] op_sel:[0,0,1] op_sel_hi:[1,0,1]
  v_pk_fma_f32 v[26:27], v[26:27], v[146:147], v[144:145] op_sel:[0,0,1] op_sel_hi:[1,0,1]
  v_pk_mul_f32 v[20:21], v[84:85], v[20:21]
  v_pk_mul_f32 v[22:23], v[86:87], v[22:23]
  v_pk_mul_f32 v[24:25], v[88:89], v[24:25]
  v_pk_mul_f32 v[26:27], v[90:91], v[26:27]
  v_exp_f32 v20, v20
  v_exp_f32 v21, v21
  v_exp_f32 v22, v22
  v_exp_f32 v23, v23
  v_exp_f32 v24, v24
  v_exp_f32 v25, v25
  v_exp_f32 v26, v26
  v_exp_f32 v27, v27
  s_waitcnt lgkmcnt(0)
  buffer_store_dwordx4 v[160:163], v156, s[28:31], s72 offen sc1
  buffer_store_dwordx4 v[164:167], v156, s[28:31], s73 offen sc1
  v_pk_fma_f32 v[20:21], v[20:21], v[146:147], v[146:147] op_sel:[0,1,1] op_sel_hi:[1,1,1]
  v_pk_fma_f32 v[22:23], v[22:23], v[146:147], v[146:147] op_sel:[0,1,1] op_sel_hi:[1,1,1]
  v_pk_fma_f32 v[24:25], v[24:25], v[146:147], v[146:147] op_sel:[0,1,1] op_sel_hi:[1,1,1]
  v_pk_fma_f32 v[26:27], v[26:27], v[146:147], v[146:147] op_sel:[0,1,1] op_sel_hi:[1,1,1]
  v_rcp_f32 v20, v20
  v_rcp_f32 v21, v21
  v_rcp_f32 v22, v22
  v_rcp_f32 v23, v23
  v_rcp_f32 v24, v24
  v_rcp_f32 v25, v25
  v_rcp_f32 v26, v26
  v_rcp_f32 v27, v27
  v_pk_mul_f32 v[20:21], v[84:85], v[20:21]
  v_pk_mul_f32 v[22:23], v[86:87], v[22:23]
  v_pk_mul_f32 v[24:25], v[88:89], v[24:25]
  v_pk_mul_f32 v[26:27], v[90:91], v[26:27]
  v_cvt_pk_bf16_f32 v28, v20, v21
  v_cvt_pk_bf16_f32 v29, v22, v23
  v_cvt_pk_bf16_f32 v30, v24, v25
  v_cvt_pk_bf16_f32 v31, v26, v27
  ds_write_b64 v150, v[28:29] offset:2048
  ds_write_b64 v151, v[30:31] offset:2048
  v_pk_fma_f32 v[92:93], v[124:125], v[144:145], v[92:93] op_sel_hi:[1,0,1]
  v_pk_fma_f32 v[94:95], v[126:127], v[144:145], v[94:95] op_sel_hi:[1,0,1]
  v_pk_fma_f32 v[96:97], v[128:129], v[144:145], v[96:97] op_sel_hi:[1,0,1]
  v_pk_fma_f32 v[98:99], v[130:131], v[144:145], v[98:99] op_sel_hi:[1,0,1]
  v_pk_mul_f32 v[20:21], v[92:93], v[92:93]
  v_pk_mul_f32 v[22:23], v[94:95], v[94:95]
  v_pk_mul_f32 v[24:25], v[96:97], v[96:97]
  v_pk_mul_f32 v[26:27], v[98:99], v[98:99]
  v_pk_fma_f32 v[20:21], v[20:21], v[146:147], v[144:145] op_sel:[0,0,1] op_sel_hi:[1,0,1]
  v_pk_fma_f32 v[22:23], v[22:23], v[146:147], v[144:145] op_sel:[0,0,1] op_sel_hi:[1,0,1]
  v_pk_fma_f32 v[24:25], v[24:25], v[146:147], v[144:145] op_sel:[0,0,1] op_sel_hi:[1,0,1]
  v_pk_fma_f32 v[26:27], v[26:27], v[146:147], v[144:145] op_sel:[0,0,1] op_sel_hi:[1,0,1]
  v_pk_mul_f32 v[20:21], v[92:93], v[20:21]
  v_pk_mul_f32 v[22:23], v[94:95], v[22:23]
  v_pk_mul_f32 v[24:25], v[96:97], v[24:25]
  v_pk_mul_f32 v[26:27], v[98:99], v[26:27]
  v_exp_f32 v20, v20
  v_exp_f32 v21, v21
  v_exp_f32 v22, v22
  v_exp_f32 v23, v23
  v_exp_f32 v24, v24
  v_exp_f32 v25, v25
  v_exp_f32 v26, v26
  v_exp_f32 v27, v27
  v_pk_fma_f32 v[20:21], v[20:21], v[146:147], v[146:147] op_sel:[0,1,1] op_sel_hi:[1,1,1]
  v_pk_fma_f32 v[22:23], v[22:23], v[146:147], v[146:147] op_sel:[0,1,1] op_sel_hi:[1,1,1]
  v_pk_fma_f32 v[24:25], v[24:25], v[146:147], v[146:147] op_sel:[0,1,1] op_sel_hi:[1,1,1]
  v_pk_fma_f32 v[26:27], v[26:27], v[146:147], v[146:147] op_sel:[0,1,1] op_sel_hi:[1,1,1]
  v_rcp_f32 v20, v20
  v_rcp_f32 v21, v21
  v_rcp_f32 v22, v22
  v_rcp_f32 v23, v23
  v_rcp_f32 v24, v24
  v_rcp_f32 v25, v25
  v_rcp_f32 v26, v26
  v_rcp_f32 v27, v27
  v_pk_mul_f32 v[20:21], v[92:93], v[20:21]
  v_pk_mul_f32 v[22:23], v[94:95], v[22:23]
  v_pk_mul_f32 v[24:25], v[96:97], v[24:25]
  v_pk_mul_f32 v[26:27], v[98:99], v[26:27]
  v_cvt_pk_bf16_f32 v32, v20, v21
  v_cvt_pk_bf16_f32 v33, v22, v23
  v_cvt_pk_bf16_f32 v34, v24, v25
  v_cvt_pk_bf16_f32 v35, v26, v27
  ds_write_b64 v152, v[32:33] offset:2048
  ds_write_b64 v153, v[34:35] offset:2048
  ds_read_b128 v[168:171], v154 offset:2048
  ds_read_b128 v[172:175], v154 offset:3072
  s_waitcnt lgkmcnt(0)
  buffer_store_dwordx4 v[168:171], v157, s[28:31], s72 offen sc1
  buffer_store_dwordx4 v[172:175], v157, s[28:31], s73 offen sc1
  s_waitcnt vmcnt(0)
  s_mov_b64 exec, 1
  v_mov_b32 v2, 0x22800
  v_mov_b32 v3, 1
  ds_add_rtn_u32 v4, v2, v3
  s_waitcnt lgkmcnt(0)
  v_readfirstlane_b32 s4, v4
  s_mov_b64 exec, -1
  s_cmp_eq_u32 s4, 3
  s_cbranch_scc0 L_cd_1031
  s_mov_b32 s28, s56
  s_mov_b32 s29, s57
  s_mov_b32 s30, 0x5800
  s_mov_b32 s31, 0x00020000
  s_add_u32 s4, s32, 0
  s_lshl_b32 s4, s4, 8
  v_mov_b32 v2, s4
  v_mov_b32 v3, 1
  s_mov_b64 exec, 1
  buffer_atomic_add v3, v2, s[28:31], 0 offen
  s_mov_b64 exec, -1
L_cd_1031:
  s_lshl_b32 s4, s32, 7
  s_lshl_b32 s5, s3, 5
  s_add_u32 s4, s4, s5
  v_and_b32 v176, 15, v0
  v_add_u32 v176, s4, v176
  v_bfe_u32 v1, v0, 4, 1
  v_lshlrev_b32 v1, 5, v1
  v_lshrrev_b32 v177, 5, v0
  v_lshl_add_u32 v177, v177, 4, v1
  v_lshl_add_u32 v176, v176, 10, v177
  v_add_u32 v177, 16384, v176
  s_mov_b32 s16, s36
  s_mov_b32 s17, s37
  s_mov_b32 s18, 0x200000
  s_mov_b32 s19, 0x00020000
  s_lshl_b32 s6, s33, 7
  s_add_u32 s7, s6, 64
  buffer_load_dwordx4 v[180:183], v176, s[16:19], s6 offen
  buffer_load_dwordx4 v[184:187], v176, s[16:19], s7 offen
  buffer_load_dwordx4 v[188:191], v177, s[16:19], s6 offen
  buffer_load_dwordx4 v[192:195], v177, s[16:19], s7 offen
  s_waitcnt vmcnt(0)
  v_permlane16_swap_b32 v180, v182
  v_permlane16_swap_b32 v181, v183
  v_permlane16_swap_b32 v184, v186
  v_permlane16_swap_b32 v185, v187
  v_permlane16_swap_b32 v188, v190
  v_permlane16_swap_b32 v189, v191
  v_permlane16_swap_b32 v192, v194
  v_permlane16_swap_b32 v193, v195
  v_mul_f32 v136, v136, v137
  v_sub_f32 v136, 0, v136
  v_lshlrev_b32 v68, 16, v180
  v_and_b32 v69, 0xffff0000, v180
  v_lshlrev_b32 v70, 16, v181
  v_and_b32 v71, 0xffff0000, v181
  v_pk_fma_f32 v[68:69], v[68:69], v[136:137], v[136:137] op_sel:[0,1,0] op_sel_hi:[1,1,0]
  v_pk_fma_f32 v[70:71], v[70:71], v[136:137], v[136:137] op_sel:[0,1,0] op_sel_hi:[1,1,0]
  v_lshlrev_b32 v72, 16, v182
  v_and_b32 v73, 0xffff0000, v182
  v_lshlrev_b32 v74, 16, v183
  v_and_b32 v75, 0xffff0000, v183
  v_pk_fma_f32 v[72:73], v[72:73], v[136:137], v[136:137] op_sel:[0,1,0] op_sel_hi:[1,1,0]
  v_pk_fma_f32 v[74:75], v[74:75], v[136:137], v[136:137] op_sel:[0,1,0] op_sel_hi:[1,1,0]
  v_lshlrev_b32 v76, 16, v184
  v_and_b32 v77, 0xffff0000, v184
  v_lshlrev_b32 v78, 16, v185
  v_and_b32 v79, 0xffff0000, v185
  v_pk_fma_f32 v[76:77], v[76:77], v[136:137], v[136:137] op_sel:[0,1,0] op_sel_hi:[1,1,0]
  v_pk_fma_f32 v[78:79], v[78:79], v[136:137], v[136:137] op_sel:[0,1,0] op_sel_hi:[1,1,0]
  v_lshlrev_b32 v80, 16, v186
  v_and_b32 v81, 0xffff0000, v186
  v_lshlrev_b32 v82, 16, v187
  v_and_b32 v83, 0xffff0000, v187
  v_pk_fma_f32 v[80:81], v[80:81], v[136:137], v[136:137] op_sel:[0,1,0] op_sel_hi:[1,1,0]
  v_pk_fma_f32 v[82:83], v[82:83], v[136:137], v[136:137] op_sel:[0,1,0] op_sel_hi:[1,1,0]
  v_mul_f32 v138, v138, v139
  v_sub_f32 v138, 0, v138
  v_lshlrev_b32 v84, 16, v188
  v_and_b32 v85, 0xffff0000, v188
  v_lshlrev_b32 v86, 16, v189
  v_and_b32 v87, 0xffff0000, v189
  v_pk_fma_f32 v[84:85], v[84:85], v[138:139], v[138:139] op_sel:[0,1,0] op_sel_hi:[1,1,0]
  v_pk_fma_f32 v[86:87], v[86:87], v[138:139], v[138:139] op_sel:[0,1,0] op_sel_hi:[1,1,0]
  v_lshlrev_b32 v88, 16, v190
  v_and_b32 v89, 0xffff0000, v190
  v_lshlrev_b32 v90, 16, v191
  v_and_b32 v91, 0xffff0000, v191
  v_pk_fma_f32 v[88:89], v[88:89], v[138:139], v[138:139] op_sel:[0,1,0] op_sel_hi:[1,1,0]
  v_pk_fma_f32 v[90:91], v[90:91], v[138:139], v[138:139] op_sel:[0,1,0] op_sel_hi:[1,1,0]
  v_lshlrev_b32 v92, 16, v192
  v_and_b32 v93, 0xffff0000, v192
  v_lshlrev_b32 v94, 16, v193
  v_and_b32 v95, 0xffff0000, v193
  v_pk_fma_f32 v[92:93], v[92:93], v[138:139], v[138:139] op_sel:[0,1,0] op_sel_hi:[1,1,0]
  v_pk_fma_f32 v[94:95], v[94:95], v[138:139], v[138:139] op_sel:[0,1,0] op_sel_hi:[1,1,0]
  v_lshlrev_b32 v96, 16, v194
  v_and_b32 v97, 0xffff0000, v194
  v_lshlrev_b32 v98, 16, v195
  v_and_b32 v99, 0xffff0000, v195
  v_pk_fma_f32 v[96:97], v[96:97], v[138:139], v[138:139] op_sel:[0,1,0] op_sel_hi:[1,1,0]
  v_pk_fma_f32 v[98:99], v[98:99], v[138:139], v[138:139] op_sel:[0,1,0] op_sel_hi:[1,1,0]
  s_cmp_lg_u32 s3, 0
  s_cbranch_scc1 L_c0_1032
  s_add_u32 s5, s32, 1
  s_min_u32 s5, s5, 15
  s_sub_u32 s7, s32, 1
  s_max_i32 s7, s7, 0
  s_lshl_b32 s89, s32, 8
  s_lshl_b32 s90, s5, 8
  s_lshl_b32 s91, s7, 8
  s_mov_b32 s28, s56
  s_mov_b32 s29, s57
  s_mov_b32 s30, 0x5800
  s_mov_b32 s31, 0x00020000
  v_mov_b32 v2, s89
  v_mov_b32 v3, s90
  v_cmp_eq_u32 vcc, 1, v0
  s_nop 1
  v_cndmask_b32 v2, v2, v3, vcc
  v_mov_b32 v3, s91
  v_cmp_eq_u32 vcc, 2, v0
  s_nop 1
  v_cndmask_b32 v2, v2, v3, vcc
  v_mov_b32 v3, 8
  s_mov_b32 s88, 0
L_poll_1033:
  buffer_load_dword v4, v2, s[28:31], 0 offen sc1
  s_waitcnt vmcnt(0)
  v_cmp_lt_u32 vcc, v4, v3
  s_add_u32 s88, s88, 1
  s_cmp_ge_u32 s88, 200000
  s_cbranch_scc1 L_polled_1034
  s_cbranch_vccz L_polled_1034
  s_sleep 1
  s_branch L_poll_1033
L_polled_1034:
L_c0_1032:
  s_add_u32 s24, s56, 0x740000
  s_addc_u32 s25, s57, 0
  s_mov_b32 s26, 0x240000
  s_mov_b32 s27, 0x00020000
  s_barrier
  s_barrier
  ds_read_b128 v[20:23], v8 offset:0
  ds_read_b64_tr_b16 v[28:29], v12 offset:0
  ds_read_b64_tr_b16 v[30:31], v12 offset:512
  ds_read_b64_tr_b16 v[32:33], v14 offset:0
  ds_read_b64_tr_b16 v[34:35], v14 offset:512
  ds_read_b128 v[24:27], v8 offset:2048
  ds_read_b64_tr_b16 v[36:37], v16 offset:0
  ds_read_b64_tr_b16 v[38:39], v16 offset:512
  ds_read_b64_tr_b16 v[40:41], v18 offset:0
  ds_read_b64_tr_b16 v[42:43], v18 offset:512
  s_waitcnt lgkmcnt(0)
  v_mfma_f32_16x16x32_bf16 v[68:71], v[28:31], v[20:23], v[68:71]
  ds_read_b128 v[44:47], v10 offset:0
  ds_read_b64_tr_b16 v[52:53], v12 offset:4096
  v_mfma_f32_16x16x32_bf16 v[72:75], v[32:35], v[20:23], v[72:75]
  ds_read_b64_tr_b16 v[54:55], v12 offset:4608
  ds_read_b64_tr_b16 v[56:57], v14 offset:4096
  v_mfma_f32_16x16x32_bf16 v[76:79], v[36:39], v[20:23], v[76:79]
  ds_read_b64_tr_b16 v[58:59], v14 offset:4608
  ds_read_b128 v[48:51], v10 offset:2048
  v_mfma_f32_16x16x32_bf16 v[80:83], v[40:43], v[20:23], v[80:83]
  ds_read_b64_tr_b16 v[60:61], v16 offset:4096
  ds_read_b64_tr_b16 v[62:63], v16 offset:4608
  v_mfma_f32_16x16x32_bf16 v[84:87], v[28:31], v[24:27], v[84:87]
  ds_read_b64_tr_b16 v[64:65], v18 offset:4096
  ds_read_b64_tr_b16 v[66:67], v18 offset:4608
  v_mfma_f32_16x16x32_bf16 v[88:91], v[32:35], v[24:27], v[88:91]
  v_mfma_f32_16x16x32_bf16 v[92:95], v[36:39], v[24:27], v[92:95]
  v_mfma_f32_16x16x32_bf16 v[96:99], v[40:43], v[24:27], v[96:99]
  s_waitcnt lgkmcnt(0)
  s_barrier
  v_mfma_f32_16x16x32_bf16 v[68:71], v[52:55], v[44:47], v[68:71]
  ds_read_b128 v[20:23], v8 offset:32768
  ds_read_b64_tr_b16 v[28:29], v12 offset:32768
  v_mfma_f32_16x16x32_bf16 v[72:75], v[56:59], v[44:47], v[72:75]
  ds_read_b64_tr_b16 v[30:31], v12 offset:33280
  ds_read_b64_tr_b16 v[32:33], v14 offset:32768
  v_mfma_f32_16x16x32_bf16 v[76:79], v[60:63], v[44:47], v[76:79]
  ds_read_b64_tr_b16 v[34:35], v14 offset:33280
  ds_read_b128 v[24:27], v8 offset:34816
  v_mfma_f32_16x16x32_bf16 v[80:83], v[64:67], v[44:47], v[80:83]
  ds_read_b64_tr_b16 v[36:37], v16 offset:32768
  ds_read_b64_tr_b16 v[38:39], v16 offset:33280
  v_mfma_f32_16x16x32_bf16 v[84:87], v[52:55], v[48:51], v[84:87]
  ds_read_b64_tr_b16 v[40:41], v18 offset:32768
  ds_read_b64_tr_b16 v[42:43], v18 offset:33280
  v_mfma_f32_16x16x32_bf16 v[88:91], v[56:59], v[48:51], v[88:91]
  v_mfma_f32_16x16x32_bf16 v[92:95], v[60:63], v[48:51], v[92:95]
  v_mfma_f32_16x16x32_bf16 v[96:99], v[64:67], v[48:51], v[96:99]
  s_waitcnt lgkmcnt(0)
  v_mfma_f32_16x16x32_bf16 v[68:71], v[28:31], v[20:23], v[68:71]
  ds_read_b128 v[44:47], v10 offset:32768
  ds_read_b64_tr_b16 v[52:53], v12 offset:36864
  v_mfma_f32_16x16x32_bf16 v[72:75], v[32:35], v[20:23], v[72:75]
  ds_read_b64_tr_b16 v[54:55], v12 offset:37376
  ds_read_b64_tr_b16 v[56:57], v14 offset:36864
  v_mfma_f32_16x16x32_bf16 v[76:79], v[36:39], v[20:23], v[76:79]
  ds_read_b64_tr_b16 v[58:59], v14 offset:37376
  ds_read_b128 v[48:51], v10 offset:34816
  v_mfma_f32_16x16x32_bf16 v[80:83], v[40:43], v[20:23], v[80:83]
  ds_read_b64_tr_b16 v[60:61], v16 offset:36864
  ds_read_b64_tr_b16 v[62:63], v16 offset:37376
  v_mfma_f32_16x16x32_bf16 v[84:87], v[28:31], v[24:27], v[84:87]
  ds_read_b64_tr_b16 v[64:65], v18 offset:36864
  ds_read_b64_tr_b16 v[66:67], v18 offset:37376
  v_mfma_f32_16x16x32_bf16 v[88:91], v[32:35], v[24:27], v[88:91]
  v_mfma_f32_16x16x32_bf16 v[92:95], v[36:39], v[24:27], v[92:95]
  v_mfma_f32_16x16x32_bf16 v[96:99], v[40:43], v[24:27], v[96:99]
  s_waitcnt lgkmcnt(0)
  s_barrier
  v_mfma_f32_16x16x32_bf16 v[68:71], v[52:55], v[44:47], v[68:71]
  ds_read_b128 v[20:23], v9 offset:0
  ds_read_b64_tr_b16 v[28:29], v13 offset:0
  v_mfma_f32_16x16x32_bf16 v[72:75], v[56:59], v[44:47], v[72:75]
  ds_read_b64_tr_b16 v[30:31], v13 offset:512
  ds_read_b64_tr_b16 v[32:33], v15 offset:0
  v_mfma_f32_16x16x32_bf16 v[76:79], v[60:63], v[44:47], v[76:79]
  ds_read_b64_tr_b16 v[34:35], v15 offset:512
  ds_read_b128 v[24:27], v9 offset:2048
  v_mfma_f32_16x16x32_bf16 v[80:83], v[64:67], v[44:47], v[80:83]
  ds_read_b64_tr_b16 v[36:37], v17 offset:0
  ds_read_b64_tr_b16 v[38:39], v17 offset:512
  v_mfma_f32_16x16x32_bf16 v[84:87], v[52:55], v[48:51], v[84:87]
  ds_read_b64_tr_b16 v[40:41], v19 offset:0
  ds_read_b64_tr_b16 v[42:43], v19 offset:512
  v_mfma_f32_16x16x32_bf16 v[88:91], v[56:59], v[48:51], v[88:91]
  v_mfma_f32_16x16x32_bf16 v[92:95], v[60:63], v[48:51], v[92:95]
  v_mfma_f32_16x16x32_bf16 v[96:99], v[64:67], v[48:51], v[96:99]
  s_waitcnt lgkmcnt(0)
  v_mfma_f32_16x16x32_bf16 v[68:71], v[28:31], v[20:23], v[68:71]
  ds_read_b128 v[44:47], v11 offset:0
  ds_read_b64_tr_b16 v[52:53], v13 offset:4096
  v_mfma_f32_16x16x32_bf16 v[72:75], v[32:35], v[20:23], v[72:75]
  ds_read_b64_tr_b16 v[54:55], v13 offset:4608
  ds_read_b64_tr_b16 v[56:57], v15 offset:4096
  v_mfma_f32_16x16x32_bf16 v[76:79], v[36:39], v[20:23], v[76:79]
  ds_read_b64_tr_b16 v[58:59], v15 offset:4608
  ds_read_b128 v[48:51], v11 offset:2048
  v_mfma_f32_16x16x32_bf16 v[80:83], v[40:43], v[20:23], v[80:83]
  ds_read_b64_tr_b16 v[60:61], v17 offset:4096
  ds_read_b64_tr_b16 v[62:63], v17 offset:4608
  v_mfma_f32_16x16x32_bf16 v[84:87], v[28:31], v[24:27], v[84:87]
  ds_read_b64_tr_b16 v[64:65], v19 offset:4096
  ds_read_b64_tr_b16 v[66:67], v19 offset:4608
  v_mfma_f32_16x16x32_bf16 v[88:91], v[32:35], v[24:27], v[88:91]
  v_mfma_f32_16x16x32_bf16 v[92:95], v[36:39], v[24:27], v[92:95]
  v_mfma_f32_16x16x32_bf16 v[96:99], v[40:43], v[24:27], v[96:99]
  s_waitcnt lgkmcnt(0)
  s_barrier
  v_mfma_f32_16x16x32_bf16 v[68:71], v[52:55], v[44:47], v[68:71]
  ds_read_b128 v[20:23], v9 offset:32768
  ds_read_b64_tr_b16 v[28:29], v13 offset:32768
  v_mfma_f32_16x16x32_bf16 v[72:75], v[56:59], v[44:47], v[72:75]
  ds_read_b64_tr_b16 v[30:31], v13 offset:33280
  ds_read_b64_tr_b16 v[32:33], v15 offset:32768
  v_mfma_f32_16x16x32_bf16 v[76:79], v[60:63], v[44:47], v[76:79]
  ds_read_b64_tr_b16 v[34:35], v15 offset:33280
  ds_read_b128 v[24:27], v9 offset:34816
  v_mfma_f32_16x16x32_bf16 v[80:83], v[64:67], v[44:47], v[80:83]
  ds_read_b64_tr_b16 v[36:37], v17 offset:32768
  ds_read_b64_tr_b16 v[38:39], v17 offset:33280
  v_mfma_f32_16x16x32_bf16 v[84:87], v[52:55], v[48:51], v[84:87]
  ds_read_b64_tr_b16 v[40:41], v19 offset:32768
  ds_read_b64_tr_b16 v[42:43], v19 offset:33280
  v_mfma_f32_16x16x32_bf16 v[88:91], v[56:59], v[48:51], v[88:91]
  v_mfma_f32_16x16x32_bf16 v[92:95], v[60:63], v[48:51], v[92:95]
  v_mfma_f32_16x16x32_bf16 v[96:99], v[64:67], v[48:51], v[96:99]
  s_waitcnt lgkmcnt(0)
  v_mfma_f32_16x16x32_bf16 v[68:71], v[28:31], v[20:23], v[68:71]
  ds_read_b128 v[44:47], v11 offset:32768
  ds_read_b64_tr_b16 v[52:53], v13 offset:36864
  v_mfma_f32_16x16x32_bf16 v[72:75], v[32:35], v[20:23], v[72:75]
  ds_read_b64_tr_b16 v[54:55], v13 offset:37376
  ds_read_b64_tr_b16 v[56:57], v15 offset:36864
  v_mfma_f32_16x16x32_bf16 v[76:79], v[36:39], v[20:23], v[76:79]
  ds_read_b64_tr_b16 v[58:59], v15 offset:37376
  ds_read_b128 v[48:51], v11 offset:34816
  v_mfma_f32_16x16x32_bf16 v[80:83], v[40:43], v[20:23], v[80:83]
  ds_read_b64_tr_b16 v[60:61], v17 offset:36864
  ds_read_b64_tr_b16 v[62:63], v17 offset:37376
  v_mfma_f32_16x16x32_bf16 v[84:87], v[28:31], v[24:27], v[84:87]
  ds_read_b64_tr_b16 v[64:65], v19 offset:36864
  ds_read_b64_tr_b16 v[66:67], v19 offset:37376
  v_mfma_f32_16x16x32_bf16 v[88:91], v[32:35], v[24:27], v[88:91]
  v_mfma_f32_16x16x32_bf16 v[92:95], v[36:39], v[24:27], v[92:95]
  v_mfma_f32_16x16x32_bf16 v[96:99], v[40:43], v[24:27], v[96:99]
  s_waitcnt lgkmcnt(0)
  s_barrier
  v_mfma_f32_16x16x32_bf16 v[68:71], v[52:55], v[44:47], v[68:71]
  ds_read_b128 v[20:23], v8 offset:0
  ds_read_b64_tr_b16 v[28:29], v12 offset:8192
  v_mfma_f32_16x16x32_bf16 v[72:75], v[56:59], v[44:47], v[72:75]
  ds_read_b64_tr_b16 v[30:31], v12 offset:8704
  ds_read_b64_tr_b16 v[32:33], v14 offset:8192
  v_mfma_f32_16x16x32_bf16 v[76:79], v[60:63], v[44:47], v[76:79]
  ds_read_b64_tr_b16 v[34:35], v14 offset:8704
  ds_read_b128 v[24:27], v8 offset:2048
  v_mfma_f32_16x16x32_bf16 v[80:83], v[64:67], v[44:47], v[80:83]
  ds_read_b64_tr_b16 v[36:37], v16 offset:8192
  ds_read_b64_tr_b16 v[38:39], v16 offset:8704
  v_mfma_f32_16x16x32_bf16 v[84:87], v[52:55], v[48:51], v[84:87]
  ds_read_b64_tr_b16 v[40:41], v18 offset:8192
  ds_read_b64_tr_b16 v[42:43], v18 offset:8704
  v_mfma_f32_16x16x32_bf16 v[88:91], v[56:59], v[48:51], v[88:91]
  v_mfma_f32_16x16x32_bf16 v[92:95], v[60:63], v[48:51], v[92:95]
  v_mfma_f32_16x16x32_bf16 v[96:99], v[64:67], v[48:51], v[96:99]
  s_waitcnt lgkmcnt(0)
  v_mfma_f32_16x16x32_bf16 v[68:71], v[28:31], v[20:23], v[68:71]
  ds_read_b128 v[44:47], v10 offset:0
  ds_read_b64_tr_b16 v[52:53], v12 offset:12288
  v_mfma_f32_16x16x32_bf16 v[72:75], v[32:35], v[20:23], v[72:75]
  ds_read_b64_tr_b16 v[54:55], v12 offset:12800
  ds_read_b64_tr_b16 v[56:57], v14 offset:12288
  v_mfma_f32_16x16x32_bf16 v[76:79], v[36:39], v[20:23], v[76:79]
  ds_read_b64_tr_b16 v[58:59], v14 offset:12800
  ds_read_b128 v[48:51], v10 offset:2048
  v_mfma_f32_16x16x32_bf16 v[80:83], v[40:43], v[20:23], v[80:83]
  ds_read_b64_tr_b16 v[60:61], v16 offset:12288
  ds_read_b64_tr_b16 v[62:63], v16 offset:12800
  v_mfma_f32_16x16x32_bf16 v[84:87], v[28:31], v[24:27], v[84:87]
  ds_read_b64_tr_b16 v[64:65], v18 offset:12288
  ds_read_b64_tr_b16 v[66:67], v18 offset:12800
  v_mfma_f32_16x16x32_bf16 v[88:91], v[32:35], v[24:27], v[88:91]
  v_mfma_f32_16x16x32_bf16 v[92:95], v[36:39], v[24:27], v[92:95]
  v_mfma_f32_16x16x32_bf16 v[96:99], v[40:43], v[24:27], v[96:99]
  s_waitcnt lgkmcnt(0)
  s_barrier
  v_mfma_f32_16x16x32_bf16 v[68:71], v[52:55], v[44:47], v[68:71]
  ds_read_b128 v[20:23], v8 offset:32768
  ds_read_b64_tr_b16 v[28:29], v12 offset:40960
  v_mfma_f32_16x16x32_bf16 v[72:75], v[56:59], v[44:47], v[72:75]
  ds_read_b64_tr_b16 v[30:31], v12 offset:41472
  ds_read_b64_tr_b16 v[32:33], v14 offset:40960
  v_mfma_f32_16x16x32_bf16 v[76:79], v[60:63], v[44:47], v[76:79]
  ds_read_b64_tr_b16 v[34:35], v14 offset:41472
  ds_read_b128 v[24:27], v8 offset:34816
  v_mfma_f32_16x16x32_bf16 v[80:83], v[64:67], v[44:47], v[80:83]
  ds_read_b64_tr_b16 v[36:37], v16 offset:40960
  ds_read_b64_tr_b16 v[38:39], v16 offset:41472
  v_mfma_f32_16x16x32_bf16 v[84:87], v[52:55], v[48:51], v[84:87]
  ds_read_b64_tr_b16 v[40:41], v18 offset:40960
  ds_read_b64_tr_b16 v[42:43], v18 offset:41472
  v_mfma_f32_16x16x32_bf16 v[88:91], v[56:59], v[48:51], v[88:91]
  v_mfma_f32_16x16x32_bf16 v[92:95], v[60:63], v[48:51], v[92:95]
  v_mfma_f32_16x16x32_bf16 v[96:99], v[64:67], v[48:51], v[96:99]
  s_waitcnt lgkmcnt(0)
  v_mfma_f32_16x16x32_bf16 v[68:71], v[28:31], v[20:23], v[68:71]
  ds_read_b128 v[44:47], v10 offset:32768
  ds_read_b64_tr_b16 v[52:53], v12 offset:45056
  v_mfma_f32_16x16x32_bf16 v[72:75], v[32:35], v[20:23], v[72:75]
  ds_read_b64_tr_b16 v[54:55], v12 offset:45568
  ds_read_b64_tr_b16 v[56:57], v14 offset:45056
  v_mfma_f32_16x16x32_bf16 v[76:79], v[36:39], v[20:23], v[76:79]
  ds_read_b64_tr_b16 v[58:59], v14 offset:45568
  ds_read_b128 v[48:51], v10 offset:34816
  v_mfma_f32_16x16x32_bf16 v[80:83], v[40:43], v[20:23], v[80:83]
  ds_read_b64_tr_b16 v[60:61], v16 offset:45056
  ds_read_b64_tr_b16 v[62:63], v16 offset:45568
  v_mfma_f32_16x16x32_bf16 v[84:87], v[28:31], v[24:27], v[84:87]
  ds_read_b64_tr_b16 v[64:65], v18 offset:45056
  ds_read_b64_tr_b16 v[66:67], v18 offset:45568
  v_mfma_f32_16x16x32_bf16 v[88:91], v[32:35], v[24:27], v[88:91]
  v_mfma_f32_16x16x32_bf16 v[92:95], v[36:39], v[24:27], v[92:95]
  v_mfma_f32_16x16x32_bf16 v[96:99], v[40:43], v[24:27], v[96:99]
  s_waitcnt lgkmcnt(0)
  s_barrier
  v_mfma_f32_16x16x32_bf16 v[68:71], v[52:55], v[44:47], v[68:71]
  ds_read_b128 v[20:23], v9 offset:0
  ds_read_b64_tr_b16 v[28:29], v13 offset:8192
  v_mfma_f32_16x16x32_bf16 v[72:75], v[56:59], v[44:47], v[72:75]
  ds_read_b64_tr_b16 v[30:31], v13 offset:8704
  ds_read_b64_tr_b16 v[32:33], v15 offset:8192
  v_mfma_f32_16x16x32_bf16 v[76:79], v[60:63], v[44:47], v[76:79]
  ds_read_b64_tr_b16 v[34:35], v15 offset:8704
  ds_read_b128 v[24:27], v9 offset:2048
  v_mfma_f32_16x16x32_bf16 v[80:83], v[64:67], v[44:47], v[80:83]
  ds_read_b64_tr_b16 v[36:37], v17 offset:8192
  ds_read_b64_tr_b16 v[38:39], v17 offset:8704
  v_mfma_f32_16x16x32_bf16 v[84:87], v[52:55], v[48:51], v[84:87]
  ds_read_b64_tr_b16 v[40:41], v19 offset:8192
  ds_read_b64_tr_b16 v[42:43], v19 offset:8704
  v_mfma_f32_16x16x32_bf16 v[88:91], v[56:59], v[48:51], v[88:91]
  v_mfma_f32_16x16x32_bf16 v[92:95], v[60:63], v[48:51], v[92:95]
  v_mfma_f32_16x16x32_bf16 v[96:99], v[64:67], v[48:51], v[96:99]
  s_waitcnt lgkmcnt(0)
  v_mfma_f32_16x16x32_bf16 v[68:71], v[28:31], v[20:23], v[68:71]
  ds_read_b128 v[44:47], v11 offset:0
  ds_read_b64_tr_b16 v[52:53], v13 offset:12288
  v_mfma_f32_16x16x32_bf16 v[72:75], v[32:35], v[20:23], v[72:75]
  ds_read_b64_tr_b16 v[54:55], v13 offset:12800
  ds_read_b64_tr_b16 v[56:57], v15 offset:12288
  v_mfma_f32_16x16x32_bf16 v[76:79], v[36:39], v[20:23], v[76:79]
  ds_read_b64_tr_b16 v[58:59], v15 offset:12800
  ds_read_b128 v[48:51], v11 offset:2048
  v_mfma_f32_16x16x32_bf16 v[80:83], v[40:43], v[20:23], v[80:83]
  ds_read_b64_tr_b16 v[60:61], v17 offset:12288
  ds_read_b64_tr_b16 v[62:63], v17 offset:12800
  v_mfma_f32_16x16x32_bf16 v[84:87], v[28:31], v[24:27], v[84:87]
  ds_read_b64_tr_b16 v[64:65], v19 offset:12288
  ds_read_b64_tr_b16 v[66:67], v19 offset:12800
  v_mfma_f32_16x16x32_bf16 v[88:91], v[32:35], v[24:27], v[88:91]
  v_mfma_f32_16x16x32_bf16 v[92:95], v[36:39], v[24:27], v[92:95]
  v_mfma_f32_16x16x32_bf16 v[96:99], v[40:43], v[24:27], v[96:99]
  s_waitcnt lgkmcnt(0)
  s_barrier
  v_mfma_f32_16x16x32_bf16 v[68:71], v[52:55], v[44:47], v[68:71]
  ds_read_b128 v[20:23], v9 offset:32768
  ds_read_b64_tr_b16 v[28:29], v13 offset:40960
  v_mfma_f32_16x16x32_bf16 v[72:75], v[56:59], v[44:47], v[72:75]
  ds_read_b64_tr_b16 v[30:31], v13 offset:41472
  ds_read_b64_tr_b16 v[32:33], v15 offset:40960
  v_mfma_f32_16x16x32_bf16 v[76:79], v[60:63], v[44:47], v[76:79]
  ds_read_b64_tr_b16 v[34:35], v15 offset:41472
  ds_read_b128 v[24:27], v9 offset:34816
  v_mfma_f32_16x16x32_bf16 v[80:83], v[64:67], v[44:47], v[80:83]
  ds_read_b64_tr_b16 v[36:37], v17 offset:40960
  ds_read_b64_tr_b16 v[38:39], v17 offset:41472
  v_mfma_f32_16x16x32_bf16 v[84:87], v[52:55], v[48:51], v[84:87]
  ds_read_b64_tr_b16 v[40:41], v19 offset:40960
  ds_read_b64_tr_b16 v[42:43], v19 offset:41472
  v_mfma_f32_16x16x32_bf16 v[88:91], v[56:59], v[48:51], v[88:91]
  v_mfma_f32_16x16x32_bf16 v[92:95], v[60:63], v[48:51], v[92:95]
  v_mfma_f32_16x16x32_bf16 v[96:99], v[64:67], v[48:51], v[96:99]
  s_waitcnt lgkmcnt(0)
  v_mfma_f32_16x16x32_bf16 v[68:71], v[28:31], v[20:23], v[68:71]
  ds_read_b128 v[44:47], v11 offset:32768
  ds_read_b64_tr_b16 v[52:53], v13 offset:45056
  v_mfma_f32_16x16x32_bf16 v[72:75], v[32:35], v[20:23], v[72:75]
  ds_read_b64_tr_b16 v[54:55], v13 offset:45568
  ds_read_b64_tr_b16 v[56:57], v15 offset:45056
  v_mfma_f32_16x16x32_bf16 v[76:79], v[36:39], v[20:23], v[76:79]
  ds_read_b64_tr_b16 v[58:59], v15 offset:45568
  ds_read_b128 v[48:51], v11 offset:34816
  v_mfma_f32_16x16x32_bf16 v[80:83], v[40:43], v[20:23], v[80:83]
  ds_read_b64_tr_b16 v[60:61], v17 offset:45056
  ds_read_b64_tr_b16 v[62:63], v17 offset:45568
  v_mfma_f32_16x16x32_bf16 v[84:87], v[28:31], v[24:27], v[84:87]
  ds_read_b64_tr_b16 v[64:65], v19 offset:45056
  ds_read_b64_tr_b16 v[66:67], v19 offset:45568
  v_mfma_f32_16x16x32_bf16 v[88:91], v[32:35], v[24:27], v[88:91]
  v_mfma_f32_16x16x32_bf16 v[92:95], v[36:39], v[24:27], v[92:95]
  v_mfma_f32_16x16x32_bf16 v[96:99], v[40:43], v[24:27], v[96:99]
  s_waitcnt lgkmcnt(0)
  s_barrier
  v_mfma_f32_16x16x32_bf16 v[68:71], v[52:55], v[44:47], v[68:71]
  v_mfma_f32_16x16x32_bf16 v[72:75], v[56:59], v[44:47], v[72:75]
  v_mfma_f32_16x16x32_bf16 v[76:79], v[60:63], v[44:47], v[76:79]
  v_mfma_f32_16x16x32_bf16 v[80:83], v[64:67], v[44:47], v[80:83]
  v_mfma_f32_16x16x32_bf16 v[84:87], v[52:55], v[48:51], v[84:87]
  v_mfma_f32_16x16x32_bf16 v[88:91], v[56:59], v[48:51], v[88:91]
  v_mfma_f32_16x16x32_bf16 v[92:95], v[60:63], v[48:51], v[92:95]
  v_mfma_f32_16x16x32_bf16 v[96:99], v[64:67], v[48:51], v[96:99]
  s_add_u32 s28, s56, 0x8000
  s_addc_u32 s29, s57, 0
  s_mov_b32 s30, 0x20000
  s_mov_b32 s31, 0x00020000
  s_nop 7
  s_nop 3
  v_cvt_pk_bf16_f32 v28, v68, v69
  v_cvt_pk_bf16_f32 v29, v70, v71
  v_cvt_pk_bf16_f32 v30, v72, v73
  v_cvt_pk_bf16_f32 v31, v74, v75
  ds_write_b64 v150, v[28:29] offset:0
  ds_write_b64 v151, v[30:31] offset:0
  v_cvt_pk_bf16_f32 v32, v76, v77
  v_cvt_pk_bf16_f32 v33, v78, v79
  v_cvt_pk_bf16_f32 v34, v80, v81
  v_cvt_pk_bf16_f32 v35, v82, v83
  ds_write_b64 v152, v[32:33] offset:0
  ds_write_b64 v153, v[34:35] offset:0
  ds_read_b128 v[160:163], v154 offset:0
  ds_read_b128 v[164:167], v154 offset:1024
  v_cvt_pk_bf16_f32 v28, v84, v85
  v_cvt_pk_bf16_f32 v29, v86, v87
  v_cvt_pk_bf16_f32 v30, v88, v89
  v_cvt_pk_bf16_f32 v31, v90, v91
  s_waitcnt lgkmcnt(0)
  buffer_store_dwordx4 v[160:163], v156, s[24:27], s72 offen sc1
  buffer_store_dwordx4 v[164:167], v156, s[24:27], s73 offen sc1
  ds_write_b64 v150, v[28:29] offset:2048
  ds_write_b64 v151, v[30:31] offset:2048
  v_cvt_pk_bf16_f32 v32, v92, v93
  v_cvt_pk_bf16_f32 v33, v94, v95
  v_cvt_pk_bf16_f32 v34, v96, v97
  v_cvt_pk_bf16_f32 v35, v98, v99
  ds_write_b64 v152, v[32:33] offset:2048
  ds_write_b64 v153, v[34:35] offset:2048
  ds_read_b128 v[168:171], v154 offset:2048
  ds_read_b128 v[172:175], v154 offset:3072
  v_pk_add_f32 v[20:21], v[68:69], v[70:71]
  v_pk_mul_f32 v[22:23], v[68:69], v[68:69]
  v_pk_fma_f32 v[22:23], v[70:71], v[70:71], v[22:23]
  v_pk_add_f32 v[20:21], v[20:21], v[72:73]
  v_pk_fma_f32 v[22:23], v[72:73], v[72:73], v[22:23]
  v_pk_add_f32 v[20:21], v[20:21], v[74:75]
  v_pk_fma_f32 v[22:23], v[74:75], v[74:75], v[22:23]
  v_pk_add_f32 v[20:21], v[20:21], v[76:77]
  v_pk_fma_f32 v[22:23], v[76:77], v[76:77], v[22:23]
  v_pk_add_f32 v[20:21], v[20:21], v[78:79]
  v_pk_fma_f32 v[22:23], v[78:79], v[78:79], v[22:23]
  v_pk_add_f32 v[20:21], v[20:21], v[80:81]
  v_pk_fma_f32 v[22:23], v[80:81], v[80:81], v[22:23]
  v_pk_add_f32 v[20:21], v[20:21], v[82:83]
  v_pk_fma_f32 v[22:23], v[82:83], v[82:83], v[22:23]
  v_add_f32 v200, v20, v21
  v_add_f32 v201, v22, v23
  s_waitcnt lgkmcnt(0)
  buffer_store_dwordx4 v[168:171], v157, s[24:27], s72 offen sc1
  buffer_store_dwordx4 v[172:175], v157, s[24:27], s73 offen sc1
  v_pk_add_f32 v[20:21], v[84:85], v[86:87]
  v_pk_mul_f32 v[22:23], v[84:85], v[84:85]
  v_pk_fma_f32 v[22:23], v[86:87], v[86:87], v[22:23]
  v_pk_add_f32 v[20:21], v[20:21], v[88:89]
  v_pk_fma_f32 v[22:23], v[88:89], v[88:89], v[22:23]
  v_pk_add_f32 v[20:21], v[20:21], v[90:91]
  v_pk_fma_f32 v[22:23], v[90:91], v[90:91], v[22:23]
  v_pk_add_f32 v[20:21], v[20:21], v[92:93]
  v_pk_fma_f32 v[22:23], v[92:93], v[92:93], v[22:23]
  v_pk_add_f32 v[20:21], v[20:21], v[94:95]
  v_pk_fma_f32 v[22:23], v[94:95], v[94:95], v[22:23]
  v_pk_add_f32 v[20:21], v[20:21], v[96:97]
  v_pk_fma_f32 v[22:23], v[96:97], v[96:97], v[22:23]
  v_pk_add_f32 v[20:21], v[20:21], v[98:99]
  v_pk_fma_f32 v[22:23], v[98:99], v[98:99], v[22:23]
  v_add_f32 v202, v20, v21
  v_add_f32 v203, v22, v23
  v_mov_b32 v20, v200
  v_mov_b32 v21, v201
  v_mov_b32 v22, v202
  v_mov_b32 v23, v203
  s_nop 1
  v_permlane32_swap_b32 v20, v200
  v_permlane32_swap_b32 v21, v201
  v_permlane32_swap_b32 v22, v202
  v_permlane32_swap_b32 v23, v203
  s_nop 1
  v_add_f32 v200, v200, v20
  v_add_f32 v201, v201, v21
  v_add_f32 v202, v202, v22
  v_add_f32 v203, v203, v23
  v_mov_b32 v20, v200
  v_mov_b32 v21, v201
  v_mov_b32 v22, v202
  v_mov_b32 v23, v203
  s_nop 1
  v_permlane16_swap_b32 v20, v200
  v_permlane16_swap_b32 v21, v201
  v_permlane16_swap_b32 v22, v202
  v_permlane16_swap_b32 v23, v203
  s_nop 1
  v_add_f32 v200, v200, v20
  v_add_f32 v201, v201, v21
  v_add_f32 v202, v202, v22
  v_add_f32 v203, v203, v23
  s_mov_b32 s4, 0xffff0000
  s_mov_b32 s5, 0
  v_cndmask_b32 v200, v200, v202, s[4:5]
  v_cndmask_b32 v201, v201, v203, s[4:5]
  s_lshl_b32 s4, s32, 3
  s_add_u32 s4, s4, s33
  s_lshl_b32 s4, s4, 10
  s_lshl_b32 s5, s3, 8
  s_add_u32 s4, s4, s5
  v_lshlrev_b32 v20, 3, v0
  s_mov_b32 exec_lo, 0xffffffff
  s_mov_b32 exec_hi, 0x0
  buffer_store_dwordx2 v[200:201], v20, s[28:31], s4 offen sc1
  s_mov_b64 exec, -1
  s_waitcnt vmcnt(0)
  s_mov_b64 exec, 1
  v_mov_b32 v2, 0x22804
  v_mov_b32 v3, 1
  ds_add_rtn_u32 v4, v2, v3
  s_waitcnt lgkmcnt(0)
  v_readfirstlane_b32 s4, v4
  s_mov_b64 exec, -1
  s_cmp_eq_u32 s4, 3
  s_cbranch_scc0 L_cd_1035
  s_mov_b32 s28, s56
  s_mov_b32 s29, s57
  s_mov_b32 s30, 0x5800
  s_mov_b32 s31, 0x00020000
  s_add_u32 s4, s32, 16
  s_lshl_b32 s4, s4, 8
  v_mov_b32 v2, s4
  v_mov_b32 v3, 1
  s_mov_b64 exec, 1
  buffer_atomic_add v3, v2, s[28:31], 0 offen
  s_mov_b64 exec, -1
L_cd_1035:
c3_entry:
  s_and_b32 s4, s2, 7
  s_lshr_b32 s5, s2, 3
  s_lshl_b32 s6, s4, 1
  s_and_b32 s7, s5, 1
  s_add_u32 s32, s6, s7
  s_lshr_b32 s5, s5, 1
  s_and_b32 s33, s5, 7
  s_cmp_eq_u32 s94, 1
  s_cbranch_scc1 c3_big
  s_cmp_ge_u32 s33, 6
  s_cbranch_scc1 c3_none
  v_and_b32 v2, 15, v0
  v_lshrrev_b32 v3, 4, v0
  v_bfe_u32 v4, v0, 1, 3
  v_xor_b32 v5, v3, v4
  v_lshlrev_b32 v5, 4, v5
  v_lshl_add_u32 v5, v2, 7, v5
  s_lshl_b32 s62, s3, 12
  v_add_u32 v8, s62, v5
  v_xor_b32 v10, 64, v8
  v_add_u32 v9, 0x10000, v8
  v_add_u32 v11, 0x10000, v10
  v_bfe_u32 v4, v0, 2, 2
  v_lshl_add_u32 v7, v3, 3, v4
  v_lshlrev_b32 v7, 7, v7
  v_and_b32 v5, 3, v0
  v_lshl_add_u32 v7, v5, 3, v7
  v_add_u32 v7, 0x4000, v7
  v_lshrrev_b32 v4, 1, v4
  v_and_b32 v6, 1, v3
  v_lshl_or_b32 v6, v6, 1, v4
  v_lshl_add_u32 v12, v6, 5, v7
  v_xor_b32 v14, 32, v12
  v_xor_b32 v16, 64, v12
  v_xor_b32 v18, 96, v12
  v_add_u32 v13, 0x10000, v12
  v_add_u32 v15, 0x10000, v14
  v_add_u32 v17, 0x10000, v16
  v_add_u32 v19, 0x10000, v18
  v_mov_b32 v132, 0x3f803f80
  v_mov_b32 v133, 0x3f803f80
  v_mov_b32 v134, 0x3f803f80
  v_mov_b32 v135, 0x3f803f80
  s_mov_b32 s75, 2816
  s_lshl_b32 s72, s33, 7
  s_add_u32 s72, s72, 2048
  s_add_u32 s73, s72, 22528
  s_lshl_b32 s4, s3, 12
  s_add_u32 s4, s4, 0x22900
  v_lshrrev_b32 v150, 5, v0
  v_and_b32 v151, 7, v0
  v_xor_b32 v150, v150, v151
  v_lshlrev_b32 v150, 4, v150
  v_and_b32 v151, 15, v0
  v_lshl_add_u32 v150, v151, 7, v150
  v_bfe_u32 v151, v0, 4, 1
  v_lshl_add_u32 v150, v151, 3, v150
  v_add_u32 v150, s4, v150
  v_xor_b32 v151, 32, v150
  v_xor_b32 v152, 64, v150
  v_xor_b32 v153, 96, v150
  v_lshrrev_b32 v156, 3, v0
  v_and_b32 v157, 7, v0
  v_xor_b32 v154, v156, v157
  v_lshlrev_b32 v154, 4, v154
  v_lshl_add_u32 v154, v156, 7, v154
  v_add_u32 v154, s4, v154
  s_lshl_b32 s4, s32, 7
  s_lshl_b32 s5, s3, 5
  s_add_u32 s4, s4, s5
  v_add_u32 v156, s4, v156
  v_lshlrev_b32 v157, 4, v157
  v_mad_u32_u24 v156, v156, s75, v157
  s_lshl_b32 s4, s75, 4
  v_add_u32 v157, s4, v156
  s_lshl_b32 s4, s32, 13
  s_lshl_b32 s5, s3, 8
  s_add_u32 s4, s4, s5
  v_and_b32 v176, 15, v0
  v_lshlrev_b32 v176, 3, v176
  v_lshrrev_b32 v3, 4, v0
  v_lshl_add_u32 v176, v3, 11, v176
  v_add_u32 v176, s4, v176
  s_cmp_lg_u32 s3, 0
  s_cbranch_scc1 L_c0_1036
  s_add_u32 s5, s32, 16
  s_lshl_b32 s89, s5, 8
  s_mov_b32 s28, s56
  s_mov_b32 s29, s57
  s_mov_b32 s30, 0x5800
  s_mov_b32 s31, 0x00020000
  v_mov_b32 v2, s89
  v_mov_b32 v3, 8
  s_mov_b32 s88, 0
L_poll_1037:
  buffer_load_dword v4, v2, s[28:31], 0 offen sc1
  s_waitcnt vmcnt(0)
  v_cmp_lt_u32 vcc, v4, v3
  s_add_u32 s88, s88, 1
  s_cmp_ge_u32 s88, 200000
  s_cbranch_scc1 L_polled_1038
  s_cbranch_vccz L_polled_1038
  s_sleep 1
  s_branch L_poll_1037
L_polled_1038:
L_c0_1036:
  s_add_u32 s16, s56, 0x8000
  s_addc_u32 s17, s57, 0
  s_mov_b32 s18, 0x20000
  s_mov_b32 s19, 0x00020000
  s_add_u32 s24, s56, 0x980000
  s_addc_u32 s25, s57, 0
  s_mov_b32 s26, 0x580000
  s_mov_b32 s27, 0x00020000
  s_barrier
  buffer_load_dwordx2 v[180:181], v176, s[16:19], 0 offen offset:0 sc1
  buffer_load_dwordx2 v[182:183], v176, s[16:19], 0 offen offset:1024 sc1
  buffer_load_dwordx2 v[184:185], v176, s[16:19], 0 offen offset:128 sc1
  buffer_load_dwordx2 v[186:187], v176, s[16:19], 0 offen offset:1152 sc1
  s_barrier
  ds_read_b128 v[20:23], v8 offset:0
  ds_read_b64_tr_b16 v[28:29], v12 offset:0
  ds_read_b64_tr_b16 v[30:31], v12 offset:512
  ds_read_b64_tr_b16 v[32:33], v14 offset:0
  ds_read_b64_tr_b16 v[34:35], v14 offset:512
  ds_read_b128 v[24:27], v8 offset:2048
  ds_read_b64_tr_b16 v[36:37], v16 offset:0
  ds_read_b64_tr_b16 v[38:39], v16 offset:512
  ds_read_b64_tr_b16 v[40:41], v18 offset:0
  ds_read_b64_tr_b16 v[42:43], v18 offset:512
  s_waitcnt lgkmcnt(0)
  v_mfma_f32_16x16x32_bf16 v[68:71], v[28:31], v[20:23], 0
  ds_read_b128 v[44:47], v10 offset:0
  v_mfma_f32_16x16x32_bf16 v[72:75], v[32:35], v[20:23], 0
  ds_read_b64_tr_b16 v[52:53], v12 offset:4096
  v_mfma_f32_16x16x32_bf16 v[76:79], v[36:39], v[20:23], 0
  ds_read_b64_tr_b16 v[54:55], v12 offset:4608
  v_mfma_f32_16x16x32_bf16 v[80:83], v[40:43], v[20:23], 0
  ds_read_b64_tr_b16 v[56:57], v14 offset:4096
  v_mfma_f32_16x16x32_bf16 v[84:87], v[28:31], v[24:27], 0
  ds_read_b64_tr_b16 v[58:59], v14 offset:4608
  v_mfma_f32_16x16x32_bf16 v[88:91], v[32:35], v[24:27], 0
  ds_read_b128 v[48:51], v10 offset:2048
  v_mfma_f32_16x16x32_bf16 v[92:95], v[36:39], v[24:27], 0
  ds_read_b64_tr_b16 v[60:61], v16 offset:4096
  v_mfma_f32_16x16x32_bf16 v[96:99], v[40:43], v[24:27], 0
  ds_read_b64_tr_b16 v[62:63], v16 offset:4608
  v_mfma_f32_16x16x32_bf16 v[116:119], v[28:31], v[132:135], 0
  ds_read_b64_tr_b16 v[64:65], v18 offset:4096
  v_mfma_f32_16x16x32_bf16 v[120:123], v[32:35], v[132:135], 0
  ds_read_b64_tr_b16 v[66:67], v18 offset:4608
  v_mfma_f32_16x16x32_bf16 v[124:127], v[36:39], v[132:135], 0
  v_mfma_f32_16x16x32_bf16 v[128:131], v[40:43], v[132:135], 0
  s_waitcnt lgkmcnt(0)
  s_barrier
  v_mfma_f32_16x16x32_bf16 v[68:71], v[52:55], v[44:47], v[68:71]
  ds_read_b128 v[20:23], v8 offset:32768
  v_mfma_f32_16x16x32_bf16 v[72:75], v[56:59], v[44:47], v[72:75]
  ds_read_b64_tr_b16 v[28:29], v12 offset:32768
  v_mfma_f32_16x16x32_bf16 v[76:79], v[60:63], v[44:47], v[76:79]
  ds_read_b64_tr_b16 v[30:31], v12 offset:33280
  v_mfma_f32_16x16x32_bf16 v[80:83], v[64:67], v[44:47], v[80:83]
  ds_read_b64_tr_b16 v[32:33], v14 offset:32768
  v_mfma_f32_16x16x32_bf16 v[84:87], v[52:55], v[48:51], v[84:87]
  ds_read_b64_tr_b16 v[34:35], v14 offset:33280
  v_mfma_f32_16x16x32_bf16 v[88:91], v[56:59], v[48:51], v[88:91]
  ds_read_b128 v[24:27], v8 offset:34816
  v_mfma_f32_16x16x32_bf16 v[92:95], v[60:63], v[48:51], v[92:95]
  ds_read_b64_tr_b16 v[36:37], v16 offset:32768
  v_mfma_f32_16x16x32_bf16 v[96:99], v[64:67], v[48:51], v[96:99]
  ds_read_b64_tr_b16 v[38:39], v16 offset:33280
  v_mfma_f32_16x16x32_bf16 v[116:119], v[52:55], v[132:135], v[116:119]
  ds_read_b64_tr_b16 v[40:41], v18 offset:32768
  v_mfma_f32_16x16x32_bf16 v[120:123], v[56:59], v[132:135], v[120:123]
  ds_read_b64_tr_b16 v[42:43], v18 offset:33280
  v_mfma_f32_16x16x32_bf16 v[124:127], v[60:63], v[132:135], v[124:127]
  v_mfma_f32_16x16x32_bf16 v[128:131], v[64:67], v[132:135], v[128:131]
  s_waitcnt lgkmcnt(0)
  v_mfma_f32_16x16x32_bf16 v[68:71], v[28:31], v[20:23], v[68:71]
  ds_read_b128 v[44:47], v10 offset:32768
  v_mfma_f32_16x16x32_bf16 v[72:75], v[32:35], v[20:23], v[72:75]
  ds_read_b64_tr_b16 v[52:53], v12 offset:36864
  v_mfma_f32_16x16x32_bf16 v[76:79], v[36:39], v[20:23], v[76:79]
  ds_read_b64_tr_b16 v[54:55], v12 offset:37376
  v_mfma_f32_16x16x32_bf16 v[80:83], v[40:43], v[20:23], v[80:83]
  ds_read_b64_tr_b16 v[56:57], v14 offset:36864
  v_mfma_f32_16x16x32_bf16 v[84:87], v[28:31], v[24:27], v[84:87]
  ds_read_b64_tr_b16 v[58:59], v14 offset:37376
  v_mfma_f32_16x16x32_bf16 v[88:91], v[32:35], v[24:27], v[88:91]
  ds_read_b128 v[48:51], v10 offset:34816
  v_mfma_f32_16x16x32_bf16 v[92:95], v[36:39], v[24:27], v[92:95]
  ds_read_b64_tr_b16 v[60:61], v16 offset:36864
  v_mfma_f32_16x16x32_bf16 v[96:99], v[40:43], v[24:27], v[96:99]
  ds_read_b64_tr_b16 v[62:63], v16 offset:37376
  v_mfma_f32_16x16x32_bf16 v[116:119], v[28:31], v[132:135], v[116:119]
  ds_read_b64_tr_b16 v[64:65], v18 offset:36864
  v_mfma_f32_16x16x32_bf16 v[120:123], v[32:35], v[132:135], v[120:123]
  ds_read_b64_tr_b16 v[66:67], v18 offset:37376
  v_mfma_f32_16x16x32_bf16 v[124:127], v[36:39], v[132:135], v[124:127]
  s_waitcnt vmcnt(0)
  s_mov_b64 exec, 1
  v_mov_b32 v2, 0x22800
  v_mov_b32 v3, 1
  ds_add_rtn_u32 v4, v2, v3
  s_waitcnt lgkmcnt(0)
  v_readfirstlane_b32 s4, v4
  s_mov_b64 exec, -1
  s_cmp_eq_u32 s4, 3
  s_cbranch_scc0 L_cd_3039
  s_mov_b32 s28, s56
  s_mov_b32 s29, s57
  s_mov_b32 s30, 0x5800
  s_mov_b32 s31, 0x00020000
  s_mov_b32 s4, s99
  s_lshl_b32 s4, s4, 8
  v_mov_b32 v2, s4
  v_mov_b32 v3, 1
  s_mov_b64 exec, 1
  buffer_atomic_add v3, v2, s[28:31], 0 offen
  s_mov_b64 exec, -1
  L_cd_3039:
  v_mfma_f32_16x16x32_bf16 v[128:131], v[40:43], v[132:135], v[128:131]
  s_waitcnt lgkmcnt(0)
  s_barrier
  v_mfma_f32_16x16x32_bf16 v[68:71], v[52:55], v[44:47], v[68:71]
  ds_read_b128 v[20:23], v9 offset:0
  v_mfma_f32_16x16x32_bf16 v[72:75], v[56:59], v[44:47], v[72:75]
  ds_read_b64_tr_b16 v[28:29], v13 offset:0
  v_mfma_f32_16x16x32_bf16 v[76:79], v[60:63], v[44:47], v[76:79]
  ds_read_b64_tr_b16 v[30:31], v13 offset:512
  v_mfma_f32_16x16x32_bf16 v[80:83], v[64:67], v[44:47], v[80:83]
  ds_read_b64_tr_b16 v[32:33], v15 offset:0
  v_mfma_f32_16x16x32_bf16 v[84:87], v[52:55], v[48:51], v[84:87]
  ds_read_b64_tr_b16 v[34:35], v15 offset:512
  v_mfma_f32_16x16x32_bf16 v[88:91], v[56:59], v[48:51], v[88:91]
  ds_read_b128 v[24:27], v9 offset:2048
  v_mfma_f32_16x16x32_bf16 v[92:95], v[60:63], v[48:51], v[92:95]
  ds_read_b64_tr_b16 v[36:37], v17 offset:0
  v_mfma_f32_16x16x32_bf16 v[96:99], v[64:67], v[48:51], v[96:99]
  ds_read_b64_tr_b16 v[38:39], v17 offset:512
  v_mfma_f32_16x16x32_bf16 v[116:119], v[52:55], v[132:135], v[116:119]
  ds_read_b64_tr_b16 v[40:41], v19 offset:0
  v_mfma_f32_16x16x32_bf16 v[120:123], v[56:59], v[132:135], v[120:123]
  ds_read_b64_tr_b16 v[42:43], v19 offset:512
  v_mfma_f32_16x16x32_bf16 v[124:127], v[60:63], v[132:135], v[124:127]
  v_mfma_f32_16x16x32_bf16 v[128:131], v[64:67], v[132:135], v[128:131]
  s_waitcnt lgkmcnt(0)
  v_mfma_f32_16x16x32_bf16 v[68:71], v[28:31], v[20:23], v[68:71]
  ds_read_b128 v[44:47], v11 offset:0
  v_mfma_f32_16x16x32_bf16 v[72:75], v[32:35], v[20:23], v[72:75]
  ds_read_b64_tr_b16 v[52:53], v13 offset:4096
  v_mfma_f32_16x16x32_bf16 v[76:79], v[36:39], v[20:23], v[76:79]
  ds_read_b64_tr_b16 v[54:55], v13 offset:4608
  v_mfma_f32_16x16x32_bf16 v[80:83], v[40:43], v[20:23], v[80:83]
  ds_read_b64_tr_b16 v[56:57], v15 offset:4096
  v_mfma_f32_16x16x32_bf16 v[84:87], v[28:31], v[24:27], v[84:87]
  ds_read_b64_tr_b16 v[58:59], v15 offset:4608
  v_mfma_f32_16x16x32_bf16 v[88:91], v[32:35], v[24:27], v[88:91]
  ds_read_b128 v[48:51], v11 offset:2048
  v_mfma_f32_16x16x32_bf16 v[92:95], v[36:39], v[24:27], v[92:95]
  ds_read_b64_tr_b16 v[60:61], v17 offset:4096
  v_mfma_f32_16x16x32_bf16 v[96:99], v[40:43], v[24:27], v[96:99]
  ds_read_b64_tr_b16 v[62:63], v17 offset:4608
  v_mfma_f32_16x16x32_bf16 v[116:119], v[28:31], v[132:135], v[116:119]
  ds_read_b64_tr_b16 v[64:65], v19 offset:4096
  v_mfma_f32_16x16x32_bf16 v[120:123], v[32:35], v[132:135], v[120:123]
  ds_read_b64_tr_b16 v[66:67], v19 offset:4608
  v_mfma_f32_16x16x32_bf16 v[124:127], v[36:39], v[132:135], v[124:127]
  v_mfma_f32_16x16x32_bf16 v[128:131], v[40:43], v[132:135], v[128:131]
  s_waitcnt lgkmcnt(0)
  s_barrier
  v_mfma_f32_16x16x32_bf16 v[68:71], v[52:55], v[44:47], v[68:71]
  ds_read_b128 v[20:23], v9 offset:32768
  v_mfma_f32_16x16x32_bf16 v[72:75], v[56:59], v[44:47], v[72:75]
  ds_read_b64_tr_b16 v[28:29], v13 offset:32768
  v_mfma_f32_16x16x32_bf16 v[76:79], v[60:63], v[44:47], v[76:79]
  ds_read_b64_tr_b16 v[30:31], v13 offset:33280
  v_mfma_f32_16x16x32_bf16 v[80:83], v[64:67], v[44:47], v[80:83]
  ds_read_b64_tr_b16 v[32:33], v15 offset:32768
  v_mfma_f32_16x16x32_bf16 v[84:87], v[52:55], v[48:51], v[84:87]
  ds_read_b64_tr_b16 v[34:35], v15 offset:33280
  v_mfma_f32_16x16x32_bf16 v[88:91], v[56:59], v[48:51], v[88:91]
  ds_read_b128 v[24:27], v9 offset:34816
  v_mfma_f32_16x16x32_bf16 v[92:95], v[60:63], v[48:51], v[92:95]
  ds_read_b64_tr_b16 v[36:37], v17 offset:32768
  v_mfma_f32_16x16x32_bf16 v[96:99], v[64:67], v[48:51], v[96:99]
  ds_read_b64_tr_b16 v[38:39], v17 offset:33280
  v_mfma_f32_16x16x32_bf16 v[116:119], v[52:55], v[132:135], v[116:119]
  ds_read_b64_tr_b16 v[40:41], v19 offset:32768
  v_mfma_f32_16x16x32_bf16 v[120:123], v[56:59], v[132:135], v[120:123]
  ds_read_b64_tr_b16 v[42:43], v19 offset:33280
  v_mfma_f32_16x16x32_bf16 v[124:127], v[60:63], v[132:135], v[124:127]
  v_mfma_f32_16x16x32_bf16 v[128:131], v[64:67], v[132:135], v[128:131]
  s_waitcnt lgkmcnt(0)
  v_mfma_f32_16x16x32_bf16 v[68:71], v[28:31], v[20:23], v[68:71]
  ds_read_b128 v[44:47], v11 offset:32768
  v_mfma_f32_16x16x32_bf16 v[72:75], v[32:35], v[20:23], v[72:75]
  ds_read_b64_tr_b16 v[52:53], v13 offset:36864
  v_mfma_f32_16x16x32_bf16 v[76:79], v[36:39], v[20:23], v[76:79]
  ds_read_b64_tr_b16 v[54:55], v13 offset:37376
  v_mfma_f32_16x16x32_bf16 v[80:83], v[40:43], v[20:23], v[80:83]
  ds_read_b64_tr_b16 v[56:57], v15 offset:36864
  v_mfma_f32_16x16x32_bf16 v[84:87], v[28:31], v[24:27], v[84:87]
  ds_read_b64_tr_b16 v[58:59], v15 offset:37376
  v_mfma_f32_16x16x32_bf16 v[88:91], v[32:35], v[24:27], v[88:91]
  ds_read_b128 v[48:51], v11 offset:34816
  v_mfma_f32_16x16x32_bf16 v[92:95], v[36:39], v[24:27], v[92:95]
  ds_read_b64_tr_b16 v[60:61], v17 offset:36864
  v_mfma_f32_16x16x32_bf16 v[96:99], v[40:43], v[24:27], v[96:99]
  ds_read_b64_tr_b16 v[62:63], v17 offset:37376
  v_mfma_f32_16x16x32_bf16 v[116:119], v[28:31], v[132:135], v[116:119]
  ds_read_b64_tr_b16 v[64:65], v19 offset:36864
  v_mfma_f32_16x16x32_bf16 v[120:123], v[32:35], v[132:135], v[120:123]
  ds_read_b64_tr_b16 v[66:67], v19 offset:37376
  v_mfma_f32_16x16x32_bf16 v[124:127], v[36:39], v[132:135], v[124:127]
  v_mfma_f32_16x16x32_bf16 v[128:131], v[40:43], v[132:135], v[128:131]
  s_waitcnt lgkmcnt(0)
  s_barrier
  v_mfma_f32_16x16x32_bf16 v[68:71], v[52:55], v[44:47], v[68:71]
  ds_read_b128 v[20:23], v8 offset:0
  v_mfma_f32_16x16x32_bf16 v[72:75], v[56:59], v[44:47], v[72:75]
  ds_read_b64_tr_b16 v[28:29], v12 offset:8192
  v_mfma_f32_16x16x32_bf16 v[76:79], v[60:63], v[44:47], v[76:79]
  ds_read_b64_tr_b16 v[30:31], v12 offset:8704
  v_mfma_f32_16x16x32_bf16 v[80:83], v[64:67], v[44:47], v[80:83]
  ds_read_b64_tr_b16 v[32:33], v14 offset:8192
  v_mfma_f32_16x16x32_bf16 v[84:87], v[52:55], v[48:51], v[84:87]
  ds_read_b64_tr_b16 v[34:35], v14 offset:8704
  v_mfma_f32_16x16x32_bf16 v[88:91], v[56:59], v[48:51], v[88:91]
  ds_read_b128 v[24:27], v8 offset:2048
  v_mfma_f32_16x16x32_bf16 v[92:95], v[60:63], v[48:51], v[92:95]
  ds_read_b64_tr_b16 v[36:37], v16 offset:8192
  v_mfma_f32_16x16x32_bf16 v[96:99], v[64:67], v[48:51], v[96:99]
  ds_read_b64_tr_b16 v[38:39], v16 offset:8704
  v_mfma_f32_16x16x32_bf16 v[116:119], v[52:55], v[132:135], v[116:119]
  ds_read_b64_tr_b16 v[40:41], v18 offset:8192
  v_mfma_f32_16x16x32_bf16 v[120:123], v[56:59], v[132:135], v[120:123]
  ds_read_b64_tr_b16 v[42:43], v18 offset:8704
  v_mfma_f32_16x16x32_bf16 v[124:127], v[60:63], v[132:135], v[124:127]
  v_mfma_f32_16x16x32_bf16 v[128:131], v[64:67], v[132:135], v[128:131]
  s_waitcnt lgkmcnt(0)
  v_mfma_f32_16x16x32_bf16 v[68:71], v[28:31], v[20:23], v[68:71]
  ds_read_b128 v[44:47], v10 offset:0
  v_mfma_f32_16x16x32_bf16 v[72:75], v[32:35], v[20:23], v[72:75]
  ds_read_b64_tr_b16 v[52:53], v12 offset:12288
  v_mfma_f32_16x16x32_bf16 v[76:79], v[36:39], v[20:23], v[76:79]
  ds_read_b64_tr_b16 v[54:55], v12 offset:12800
  v_mfma_f32_16x16x32_bf16 v[80:83], v[40:43], v[20:23], v[80:83]
  ds_read_b64_tr_b16 v[56:57], v14 offset:12288
  v_mfma_f32_16x16x32_bf16 v[84:87], v[28:31], v[24:27], v[84:87]
  ds_read_b64_tr_b16 v[58:59], v14 offset:12800
  v_mfma_f32_16x16x32_bf16 v[88:91], v[32:35], v[24:27], v[88:91]
  ds_read_b128 v[48:51], v10 offset:2048
  v_mfma_f32_16x16x32_bf16 v[92:95], v[36:39], v[24:27], v[92:95]
  ds_read_b64_tr_b16 v[60:61], v16 offset:12288
  v_mfma_f32_16x16x32_bf16 v[96:99], v[40:43], v[24:27], v[96:99]
  ds_read_b64_tr_b16 v[62:63], v16 offset:12800
  v_mfma_f32_16x16x32_bf16 v[116:119], v[28:31], v[132:135], v[116:119]
  ds_read_b64_tr_b16 v[64:65], v18 offset:12288
  v_mfma_f32_16x16x32_bf16 v[120:123], v[32:35], v[132:135], v[120:123]
  ds_read_b64_tr_b16 v[66:67], v18 offset:12800
  v_mfma_f32_16x16x32_bf16 v[124:127], v[36:39], v[132:135], v[124:127]
  v_mfma_f32_16x16x32_bf16 v[128:131], v[40:43], v[132:135], v[128:131]
  s_waitcnt lgkmcnt(0)
  s_barrier
  v_mfma_f32_16x16x32_bf16 v[68:71], v[52:55], v[44:47], v[68:71]
  ds_read_b128 v[20:23], v8 offset:32768
  v_mfma_f32_16x16x32_bf16 v[72:75], v[56:59], v[44:47], v[72:75]
  ds_read_b64_tr_b16 v[28:29], v12 offset:40960
  v_mfma_f32_16x16x32_bf16 v[76:79], v[60:63], v[44:47], v[76:79]
  ds_read_b64_tr_b16 v[30:31], v12 offset:41472
  v_mfma_f32_16x16x32_bf16 v[80:83], v[64:67], v[44:47], v[80:83]
  ds_read_b64_tr_b16 v[32:33], v14 offset:40960
  v_mfma_f32_16x16x32_bf16 v[84:87], v[52:55], v[48:51], v[84:87]
  ds_read_b64_tr_b16 v[34:35], v14 offset:41472
  v_mfma_f32_16x16x32_bf16 v[88:91], v[56:59], v[48:51], v[88:91]
  ds_read_b128 v[24:27], v8 offset:34816
  v_mfma_f32_16x16x32_bf16 v[92:95], v[60:63], v[48:51], v[92:95]
  ds_read_b64_tr_b16 v[36:37], v16 offset:40960
  v_mfma_f32_16x16x32_bf16 v[96:99], v[64:67], v[48:51], v[96:99]
  ds_read_b64_tr_b16 v[38:39], v16 offset:41472
  v_mfma_f32_16x16x32_bf16 v[116:119], v[52:55], v[132:135], v[116:119]
  ds_read_b64_tr_b16 v[40:41], v18 offset:40960
  v_mfma_f32_16x16x32_bf16 v[120:123], v[56:59], v[132:135], v[120:123]
  ds_read_b64_tr_b16 v[42:43], v18 offset:41472
  v_mfma_f32_16x16x32_bf16 v[124:127], v[60:63], v[132:135], v[124:127]
  v_mfma_f32_16x16x32_bf16 v[128:131], v[64:67], v[132:135], v[128:131]
  s_waitcnt lgkmcnt(0)
  v_mfma_f32_16x16x32_bf16 v[68:71], v[28:31], v[20:23], v[68:71]
  ds_read_b128 v[44:47], v10 offset:32768
  v_mfma_f32_16x16x32_bf16 v[72:75], v[32:35], v[20:23], v[72:75]
  ds_read_b64_tr_b16 v[52:53], v12 offset:45056
  v_mfma_f32_16x16x32_bf16 v[76:79], v[36:39], v[20:23], v[76:79]
  ds_read_b64_tr_b16 v[54:55], v12 offset:45568
  v_mfma_f32_16x16x32_bf16 v[80:83], v[40:43], v[20:23], v[80:83]
  ds_read_b64_tr_b16 v[56:57], v14 offset:45056
  v_mfma_f32_16x16x32_bf16 v[84:87], v[28:31], v[24:27], v[84:87]
  ds_read_b64_tr_b16 v[58:59], v14 offset:45568
  v_mfma_f32_16x16x32_bf16 v[88:91], v[32:35], v[24:27], v[88:91]
  ds_read_b128 v[48:51], v10 offset:34816
  v_mfma_f32_16x16x32_bf16 v[92:95], v[36:39], v[24:27], v[92:95]
  ds_read_b64_tr_b16 v[60:61], v16 offset:45056
  v_mfma_f32_16x16x32_bf16 v[96:99], v[40:43], v[24:27], v[96:99]
  ds_read_b64_tr_b16 v[62:63], v16 offset:45568
  v_mfma_f32_16x16x32_bf16 v[116:119], v[28:31], v[132:135], v[116:119]
  ds_read_b64_tr_b16 v[64:65], v18 offset:45056
  v_mfma_f32_16x16x32_bf16 v[120:123], v[32:35], v[132:135], v[120:123]
  ds_read_b64_tr_b16 v[66:67], v18 offset:45568
  v_mfma_f32_16x16x32_bf16 v[124:127], v[36:39], v[132:135], v[124:127]
  v_mfma_f32_16x16x32_bf16 v[128:131], v[40:43], v[132:135], v[128:131]
  s_waitcnt lgkmcnt(0)
  s_barrier
  v_mfma_f32_16x16x32_bf16 v[68:71], v[52:55], v[44:47], v[68:71]
  ds_read_b128 v[20:23], v9 offset:0
  v_mfma_f32_16x16x32_bf16 v[72:75], v[56:59], v[44:47], v[72:75]
  ds_read_b64_tr_b16 v[28:29], v13 offset:8192
  v_mfma_f32_16x16x32_bf16 v[76:79], v[60:63], v[44:47], v[76:79]
  ds_read_b64_tr_b16 v[30:31], v13 offset:8704
  v_mfma_f32_16x16x32_bf16 v[80:83], v[64:67], v[44:47], v[80:83]
  ds_read_b64_tr_b16 v[32:33], v15 offset:8192
  v_mfma_f32_16x16x32_bf16 v[84:87], v[52:55], v[48:51], v[84:87]
  ds_read_b64_tr_b16 v[34:35], v15 offset:8704
  v_mfma_f32_16x16x32_bf16 v[88:91], v[56:59], v[48:51], v[88:91]
  ds_read_b128 v[24:27], v9 offset:2048
  v_mfma_f32_16x16x32_bf16 v[92:95], v[60:63], v[48:51], v[92:95]
  ds_read_b64_tr_b16 v[36:37], v17 offset:8192
  v_mfma_f32_16x16x32_bf16 v[96:99], v[64:67], v[48:51], v[96:99]
  ds_read_b64_tr_b16 v[38:39], v17 offset:8704
  v_mfma_f32_16x16x32_bf16 v[116:119], v[52:55], v[132:135], v[116:119]
  ds_read_b64_tr_b16 v[40:41], v19 offset:8192
  v_mfma_f32_16x16x32_bf16 v[120:123], v[56:59], v[132:135], v[120:123]
  ds_read_b64_tr_b16 v[42:43], v19 offset:8704
  v_mfma_f32_16x16x32_bf16 v[124:127], v[60:63], v[132:135], v[124:127]
  v_mfma_f32_16x16x32_bf16 v[128:131], v[64:67], v[132:135], v[128:131]
  s_waitcnt lgkmcnt(0)
  v_mfma_f32_16x16x32_bf16 v[68:71], v[28:31], v[20:23], v[68:71]
  ds_read_b128 v[44:47], v11 offset:0
  v_mfma_f32_16x16x32_bf16 v[72:75], v[32:35], v[20:23], v[72:75]
  ds_read_b64_tr_b16 v[52:53], v13 offset:12288
  v_mfma_f32_16x16x32_bf16 v[76:79], v[36:39], v[20:23], v[76:79]
  ds_read_b64_tr_b16 v[54:55], v13 offset:12800
  v_mfma_f32_16x16x32_bf16 v[80:83], v[40:43], v[20:23], v[80:83]
  ds_read_b64_tr_b16 v[56:57], v15 offset:12288
  v_mfma_f32_16x16x32_bf16 v[84:87], v[28:31], v[24:27], v[84:87]
  ds_read_b64_tr_b16 v[58:59], v15 offset:12800
  v_mfma_f32_16x16x32_bf16 v[88:91], v[32:35], v[24:27], v[88:91]
  ds_read_b128 v[48:51], v11 offset:2048
  v_mfma_f32_16x16x32_bf16 v[92:95], v[36:39], v[24:27], v[92:95]
  ds_read_b64_tr_b16 v[60:61], v17 offset:12288
  v_mfma_f32_16x16x32_bf16 v[96:99], v[40:43], v[24:27], v[96:99]
  ds_read_b64_tr_b16 v[62:63], v17 offset:12800
  v_mfma_f32_16x16x32_bf16 v[116:119], v[28:31], v[132:135], v[116:119]
  ds_read_b64_tr_b16 v[64:65], v19 offset:12288
  v_mfma_f32_16x16x32_bf16 v[120:123], v[32:35], v[132:135], v[120:123]
  ds_read_b64_tr_b16 v[66:67], v19 offset:12800
  v_mfma_f32_16x16x32_bf16 v[124:127], v[36:39], v[132:135], v[124:127]
  v_mfma_f32_16x16x32_bf16 v[128:131], v[40:43], v[132:135], v[128:131]
  s_waitcnt lgkmcnt(0)
  s_barrier
  v_mfma_f32_16x16x32_bf16 v[68:71], v[52:55], v[44:47], v[68:71]
  ds_read_b128 v[20:23], v9 offset:32768
  v_mfma_f32_16x16x32_bf16 v[72:75], v[56:59], v[44:47], v[72:75]
  ds_read_b64_tr_b16 v[28:29], v13 offset:40960
  v_mfma_f32_16x16x32_bf16 v[76:79], v[60:63], v[44:47], v[76:79]
  ds_read_b64_tr_b16 v[30:31], v13 offset:41472
  v_mfma_f32_16x16x32_bf16 v[80:83], v[64:67], v[44:47], v[80:83]
  ds_read_b64_tr_b16 v[32:33], v15 offset:40960
  v_mfma_f32_16x16x32_bf16 v[84:87], v[52:55], v[48:51], v[84:87]
  ds_read_b64_tr_b16 v[34:35], v15 offset:41472
  v_mfma_f32_16x16x32_bf16 v[88:91], v[56:59], v[48:51], v[88:91]
  ds_read_b128 v[24:27], v9 offset:34816
  v_mfma_f32_16x16x32_bf16 v[92:95], v[60:63], v[48:51], v[92:95]
  ds_read_b64_tr_b16 v[36:37], v17 offset:40960
  v_mfma_f32_16x16x32_bf16 v[96:99], v[64:67], v[48:51], v[96:99]
  ds_read_b64_tr_b16 v[38:39], v17 offset:41472
  v_mfma_f32_16x16x32_bf16 v[116:119], v[52:55], v[132:135], v[116:119]
  ds_read_b64_tr_b16 v[40:41], v19 offset:40960
  v_mfma_f32_16x16x32_bf16 v[120:123], v[56:59], v[132:135], v[120:123]
  ds_read_b64_tr_b16 v[42:43], v19 offset:41472
  v_mfma_f32_16x16x32_bf16 v[124:127], v[60:63], v[132:135], v[124:127]
  v_mfma_f32_16x16x32_bf16 v[128:131], v[64:67], v[132:135], v[128:131]
  s_waitcnt lgkmcnt(0)
  v_mfma_f32_16x16x32_bf16 v[68:71], v[28:31], v[20:23], v[68:71]
  ds_read_b128 v[44:47], v11 offset:32768
  v_mfma_f32_16x16x32_bf16 v[72:75], v[32:35], v[20:23], v[72:75]
  ds_read_b64_tr_b16 v[52:53], v13 offset:45056
  v_mfma_f32_16x16x32_bf16 v[76:79], v[36:39], v[20:23], v[76:79]
  ds_read_b64_tr_b16 v[54:55], v13 offset:45568
  v_mfma_f32_16x16x32_bf16 v[80:83], v[40:43], v[20:23], v[80:83]
  ds_read_b64_tr_b16 v[56:57], v15 offset:45056
  v_mfma_f32_16x16x32_bf16 v[84:87], v[28:31], v[24:27], v[84:87]
  ds_read_b64_tr_b16 v[58:59], v15 offset:45568
  v_mfma_f32_16x16x32_bf16 v[88:91], v[32:35], v[24:27], v[88:91]
  ds_read_b128 v[48:51], v11 offset:34816
  v_mfma_f32_16x16x32_bf16 v[92:95], v[36:39], v[24:27], v[92:95]
  ds_read_b64_tr_b16 v[60:61], v17 offset:45056
  v_mfma_f32_16x16x32_bf16 v[96:99], v[40:43], v[24:27], v[96:99]
  ds_read_b64_tr_b16 v[62:63], v17 offset:45568
  v_mfma_f32_16x16x32_bf16 v[116:119], v[28:31], v[132:135], v[116:119]
  ds_read_b64_tr_b16 v[64:65], v19 offset:45056
  v_mfma_f32_16x16x32_bf16 v[120:123], v[32:35], v[132:135], v[120:123]
  ds_read_b64_tr_b16 v[66:67], v19 offset:45568
  v_mfma_f32_16x16x32_bf16 v[124:127], v[36:39], v[132:135], v[124:127]
  v_mfma_f32_16x16x32_bf16 v[128:131], v[40:43], v[132:135], v[128:131]
  s_waitcnt lgkmcnt(0)
  s_barrier
  v_mfma_f32_16x16x32_bf16 v[68:71], v[52:55], v[44:47], v[68:71]
  v_mfma_f32_16x16x32_bf16 v[72:75], v[56:59], v[44:47], v[72:75]
  v_mfma_f32_16x16x32_bf16 v[76:79], v[60:63], v[44:47], v[76:79]
  v_mfma_f32_16x16x32_bf16 v[80:83], v[64:67], v[44:47], v[80:83]
  v_mfma_f32_16x16x32_bf16 v[84:87], v[52:55], v[48:51], v[84:87]
  v_mfma_f32_16x16x32_bf16 v[88:91], v[56:59], v[48:51], v[88:91]
  v_mfma_f32_16x16x32_bf16 v[92:95], v[60:63], v[48:51], v[92:95]
  v_mfma_f32_16x16x32_bf16 v[96:99], v[64:67], v[48:51], v[96:99]
  v_mfma_f32_16x16x32_bf16 v[116:119], v[52:55], v[132:135], v[116:119]
  v_mfma_f32_16x16x32_bf16 v[120:123], v[56:59], v[132:135], v[120:123]
  v_mfma_f32_16x16x32_bf16 v[124:127], v[60:63], v[132:135], v[124:127]
  v_mfma_f32_16x16x32_bf16 v[128:131], v[64:67], v[132:135], v[128:131]
  s_waitcnt vmcnt(0)
  v_pk_add_f32 v[180:181], v[180:181], v[182:183]
  v_pk_add_f32 v[184:185], v[184:185], v[186:187]
  v_mov_b32 v20, v180
  v_mov_b32 v21, v181
  v_mov_b32 v22, v184
  v_mov_b32 v23, v185
  s_nop 1
  v_permlane32_swap_b32 v20, v180
  v_permlane32_swap_b32 v21, v181
  v_permlane32_swap_b32 v22, v184
  v_permlane32_swap_b32 v23, v185
  s_nop 1
  v_add_f32 v180, v180, v20
  v_add_f32 v181, v181, v21
  v_add_f32 v184, v184, v22
  v_add_f32 v185, v185, v23
  v_mov_b32 v20, v180
  v_mov_b32 v21, v181
  v_mov_b32 v22, v184
  v_mov_b32 v23, v185
  s_nop 1
  v_permlane16_swap_b32 v20, v180
  v_permlane16_swap_b32 v21, v181
  v_permlane16_swap_b32 v22, v184
  v_permlane16_swap_b32 v23, v185
  s_nop 1
  v_add_f32 v180, v180, v20
  v_add_f32 v181, v181, v21
  v_add_f32 v184, v184, v22
  v_add_f32 v185, v185, v23
  v_mul_f32 v136, 0x3b000000, v180
  v_mul_f32 v181, 0x3b000000, v181
  v_fma_f32 v181, -v136, v136, v181
  v_add_f32 v181, 0x3727c5ac, v181
  v_rsq_f32 v137, v181
  v_mul_f32 v138, 0x3b000000, v184
  v_mul_f32 v185, 0x3b000000, v185
  v_fma_f32 v185, -v138, v138, v185
  v_add_f32 v185, 0x3727c5ac, v185
  v_rsq_f32 v139, v185
  s_nop 7
  s_nop 3
  v_mov_b32 v28, v137
  v_sub_f32 v140, 0, v136
  v_mul_f32 v141, 0xc0135761, v28
  v_mul_f32 v20, v28, v28
  v_rcp_f32 v143, v28
  v_mul_f32 v20, v20, v141
  v_mul_f32 v142, 0x3d372713, v20
  v_mov_b32 v29, v139
  v_sub_f32 v144, 0, v138
  v_mul_f32 v145, 0xc0135761, v29
  v_mul_f32 v21, v29, v29
  v_rcp_f32 v147, v29
  v_mul_f32 v21, v21, v145
  v_mul_f32 v146, 0x3d372713, v21
  v_pk_fma_f32 v[68:69], v[116:117], v[140:141], v[68:69] op_sel_hi:[1,0,1]
  v_pk_fma_f32 v[70:71], v[118:119], v[140:141], v[70:71] op_sel_hi:[1,0,1]
  v_pk_fma_f32 v[72:73], v[120:121], v[140:141], v[72:73] op_sel_hi:[1,0,1]
  v_pk_fma_f32 v[74:75], v[122:123], v[140:141], v[74:75] op_sel_hi:[1,0,1]
  v_pk_mul_f32 v[20:21], v[68:69], v[68:69]
  v_pk_mul_f32 v[22:23], v[70:71], v[70:71]
  v_pk_mul_f32 v[24:25], v[72:73], v[72:73]
  v_pk_mul_f32 v[26:27], v[74:75], v[74:75]
  v_pk_fma_f32 v[20:21], v[20:21], v[142:143], v[140:141] op_sel:[0,0,1] op_sel_hi:[1,0,1]
  v_pk_fma_f32 v[22:23], v[22:23], v[142:143], v[140:141] op_sel:[0,0,1] op_sel_hi:[1,0,1]
  v_pk_fma_f32 v[24:25], v[24:25], v[142:143], v[140:141] op_sel:[0,0,1] op_sel_hi:[1,0,1]
  v_pk_fma_f32 v[26:27], v[26:27], v[142:143], v[140:141] op_sel:[0,0,1] op_sel_hi:[1,0,1]
  v_pk_mul_f32 v[20:21], v[68:69], v[20:21]
  v_pk_mul_f32 v[22:23], v[70:71], v[22:23]
  v_pk_mul_f32 v[24:25], v[72:73], v[24:25]
  v_pk_mul_f32 v[26:27], v[74:75], v[26:27]
  v_exp_f32 v20, v20
  v_exp_f32 v21, v21
  v_exp_f32 v22, v22
  v_exp_f32 v23, v23
  v_exp_f32 v24, v24
  v_exp_f32 v25, v25
  v_exp_f32 v26, v26
  v_exp_f32 v27, v27
  v_pk_fma_f32 v[20:21], v[20:21], v[142:143], v[142:143] op_sel:[0,1,1] op_sel_hi:[1,1,1]
  v_pk_fma_f32 v[22:23], v[22:23], v[142:143], v[142:143] op_sel:[0,1,1] op_sel_hi:[1,1,1]
  v_pk_fma_f32 v[24:25], v[24:25], v[142:143], v[142:143] op_sel:[0,1,1] op_sel_hi:[1,1,1]
  v_pk_fma_f32 v[26:27], v[26:27], v[142:143], v[142:143] op_sel:[0,1,1] op_sel_hi:[1,1,1]
  v_rcp_f32 v20, v20
  v_rcp_f32 v21, v21
  v_rcp_f32 v22, v22
  v_rcp_f32 v23, v23
  v_rcp_f32 v24, v24
  v_rcp_f32 v25, v25
  v_rcp_f32 v26, v26
  v_rcp_f32 v27, v27
  v_pk_mul_f32 v[20:21], v[68:69], v[20:21]
  v_pk_mul_f32 v[22:23], v[70:71], v[22:23]
  v_pk_mul_f32 v[24:25], v[72:73], v[24:25]
  v_pk_mul_f32 v[26:27], v[74:75], v[26:27]
  v_cvt_pk_bf16_f32 v28, v20, v21
  v_cvt_pk_bf16_f32 v29, v22, v23
  v_cvt_pk_bf16_f32 v30, v24, v25
  v_cvt_pk_bf16_f32 v31, v26, v27
  ds_write_b64 v150, v[28:29] offset:0
  ds_write_b64 v151, v[30:31] offset:0
  v_pk_fma_f32 v[76:77], v[124:125], v[140:141], v[76:77] op_sel_hi:[1,0,1]
  v_pk_fma_f32 v[78:79], v[126:127], v[140:141], v[78:79] op_sel_hi:[1,0,1]
  v_pk_fma_f32 v[80:81], v[128:129], v[140:141], v[80:81] op_sel_hi:[1,0,1]
  v_pk_fma_f32 v[82:83], v[130:131], v[140:141], v[82:83] op_sel_hi:[1,0,1]
  v_pk_mul_f32 v[20:21], v[76:77], v[76:77]
  v_pk_mul_f32 v[22:23], v[78:79], v[78:79]
  v_pk_mul_f32 v[24:25], v[80:81], v[80:81]
  v_pk_mul_f32 v[26:27], v[82:83], v[82:83]
  v_pk_fma_f32 v[20:21], v[20:21], v[142:143], v[140:141] op_sel:[0,0,1] op_sel_hi:[1,0,1]
  v_pk_fma_f32 v[22:23], v[22:23], v[142:143], v[140:141] op_sel:[0,0,1] op_sel_hi:[1,0,1]
  v_pk_fma_f32 v[24:25], v[24:25], v[142:143], v[140:141] op_sel:[0,0,1] op_sel_hi:[1,0,1]
  v_pk_fma_f32 v[26:27], v[26:27], v[142:143], v[140:141] op_sel:[0,0,1] op_sel_hi:[1,0,1]
  v_pk_mul_f32 v[20:21], v[76:77], v[20:21]
  v_pk_mul_f32 v[22:23], v[78:79], v[22:23]
  v_pk_mul_f32 v[24:25], v[80:81], v[24:25]
  v_pk_mul_f32 v[26:27], v[82:83], v[26:27]
  v_exp_f32 v20, v20
  v_exp_f32 v21, v21
  v_exp_f32 v22, v22
  v_exp_f32 v23, v23
  v_exp_f32 v24, v24
  v_exp_f32 v25, v25
  v_exp_f32 v26, v26
  v_exp_f32 v27, v27
  v_pk_fma_f32 v[20:21], v[20:21], v[142:143], v[142:143] op_sel:[0,1,1] op_sel_hi:[1,1,1]
  v_pk_fma_f32 v[22:23], v[22:23], v[142:143], v[142:143] op_sel:[0,1,1] op_sel_hi:[1,1,1]
  v_pk_fma_f32 v[24:25], v[24:25], v[142:143], v[142:143] op_sel:[0,1,1] op_sel_hi:[1,1,1]
  v_pk_fma_f32 v[26:27], v[26:27], v[142:143], v[142:143] op_sel:[0,1,1] op_sel_hi:[1,1,1]
  v_rcp_f32 v20, v20
  v_rcp_f32 v21, v21
  v_rcp_f32 v22, v22
  v_rcp_f32 v23, v23
  v_rcp_f32 v24, v24
  v_rcp_f32 v25, v25
  v_rcp_f32 v26, v26
  v_rcp_f32 v27, v27
  v_pk_mul_f32 v[20:21], v[76:77], v[20:21]
  v_pk_mul_f32 v[22:23], v[78:79], v[22:23]
  v_pk_mul_f32 v[24:25], v[80:81], v[24:25]
  v_pk_mul_f32 v[26:27], v[82:83], v[26:27]
  v_cvt_pk_bf16_f32 v32, v20, v21
  v_cvt_pk_bf16_f32 v33, v22, v23
  v_cvt_pk_bf16_f32 v34, v24, v25
  v_cvt_pk_bf16_f32 v35, v26, v27
  ds_write_b64 v152, v[32:33] offset:0
  ds_write_b64 v153, v[34:35] offset:0
  ds_read_b128 v[160:163], v154 offset:0
  ds_read_b128 v[164:167], v154 offset:1024
  v_pk_fma_f32 v[84:85], v[116:117], v[144:145], v[84:85] op_sel_hi:[1,0,1]
  v_pk_fma_f32 v[86:87], v[118:119], v[144:145], v[86:87] op_sel_hi:[1,0,1]
  v_pk_fma_f32 v[88:89], v[120:121], v[144:145], v[88:89] op_sel_hi:[1,0,1]
  v_pk_fma_f32 v[90:91], v[122:123], v[144:145], v[90:91] op_sel_hi:[1,0,1]
  v_pk_mul_f32 v[20:21], v[84:85], v[84:85]
  v_pk_mul_f32 v[22:23], v[86:87], v[86:87]
  v_pk_mul_f32 v[24:25], v[88:89], v[88:89]
  v_pk_mul_f32 v[26:27], v[90:91], v[90:91]
  v_pk_fma_f32 v[20:21], v[20:21], v[146:147], v[144:145] op_sel:[0,0,1] op_sel_hi:[1,0,1]
  v_pk_fma_f32 v[22:23], v[22:23], v[146:147], v[144:145] op_sel:[0,0,1] op_sel_hi:[1,0,1]
  v_pk_fma_f32 v[24:25], v[24:25], v[146:147], v[144:145] op_sel:[0,0,1] op_sel_hi:[1,0,1]
  v_pk_fma_f32 v[26:27], v[26:27], v[146:147], v[144:145] op_sel:[0,0,1] op_sel_hi:[1,0,1]
  v_pk_mul_f32 v[20:21], v[84:85], v[20:21]
  v_pk_mul_f32 v[22:23], v[86:87], v[22:23]
  v_pk_mul_f32 v[24:25], v[88:89], v[24:25]
  v_pk_mul_f32 v[26:27], v[90:91], v[26:27]
  v_exp_f32 v20, v20
  v_exp_f32 v21, v21
  v_exp_f32 v22, v22
  v_exp_f32 v23, v23
  v_exp_f32 v24, v24
  v_exp_f32 v25, v25
  v_exp_f32 v26, v26
  v_exp_f32 v27, v27
  s_waitcnt lgkmcnt(0)
  buffer_store_dwordx4 v[160:163], v156, s[24:27], s72 offen sc1
  buffer_store_dwordx4 v[164:167], v156, s[24:27], s73 offen sc1
  v_pk_fma_f32 v[20:21], v[20:21], v[146:147], v[146:147] op_sel:[0,1,1] op_sel_hi:[1,1,1]
  v_pk_fma_f32 v[22:23], v[22:23], v[146:147], v[146:147] op_sel:[0,1,1] op_sel_hi:[1,1,1]
  v_pk_fma_f32 v[24:25], v[24:25], v[146:147], v[146:147] op_sel:[0,1,1] op_sel_hi:[1,1,1]
  v_pk_fma_f32 v[26:27], v[26:27], v[146:147], v[146:147] op_sel:[0,1,1] op_sel_hi:[1,1,1]
  v_rcp_f32 v20, v20
  v_rcp_f32 v21, v21
  v_rcp_f32 v22, v22
  v_rcp_f32 v23, v23
  v_rcp_f32 v24, v24
  v_rcp_f32 v25, v25
  v_rcp_f32 v26, v26
  v_rcp_f32 v27, v27
  v_pk_mul_f32 v[20:21], v[84:85], v[20:21]
  v_pk_mul_f32 v[22:23], v[86:87], v[22:23]
  v_pk_mul_f32 v[24:25], v[88:89], v[24:25]
  v_pk_mul_f32 v[26:27], v[90:91], v[26:27]
  v_cvt_pk_bf16_f32 v28, v20, v21
  v_cvt_pk_bf16_f32 v29, v22, v23
  v_cvt_pk_bf16_f32 v30, v24, v25
  v_cvt_pk_bf16_f32 v31, v26, v27
  ds_write_b64 v150, v[28:29] offset:2048
  ds_write_b64 v151, v[30:31] offset:2048
  v_pk_fma_f32 v[92:93], v[124:125], v[144:145], v[92:93] op_sel_hi:[1,0,1]
  v_pk_fma_f32 v[94:95], v[126:127], v[144:145], v[94:95] op_sel_hi:[1,0,1]
  v_pk_fma_f32 v[96:97], v[128:129], v[144:145], v[96:97] op_sel_hi:[1,0,1]
  v_pk_fma_f32 v[98:99], v[130:131], v[144:145], v[98:99] op_sel_hi:[1,0,1]
  v_pk_mul_f32 v[20:21], v[92:93], v[92:93]
  v_pk_mul_f32 v[22:23], v[94:95], v[94:95]
  v_pk_mul_f32 v[24:25], v[96:97], v[96:97]
  v_pk_mul_f32 v[26:27], v[98:99], v[98:99]
  v_pk_fma_f32 v[20:21], v[20:21], v[146:147], v[144:145] op_sel:[0,0,1] op_sel_hi:[1,0,1]
  v_pk_fma_f32 v[22:23], v[22:23], v[146:147], v[144:145] op_sel:[0,0,1] op_sel_hi:[1,0,1]
  v_pk_fma_f32 v[24:25], v[24:25], v[146:147], v[144:145] op_sel:[0,0,1] op_sel_hi:[1,0,1]
  v_pk_fma_f32 v[26:27], v[26:27], v[146:147], v[144:145] op_sel:[0,0,1] op_sel_hi:[1,0,1]
  v_pk_mul_f32 v[20:21], v[92:93], v[20:21]
  v_pk_mul_f32 v[22:23], v[94:95], v[22:23]
  v_pk_mul_f32 v[24:25], v[96:97], v[24:25]
  v_pk_mul_f32 v[26:27], v[98:99], v[26:27]
  v_exp_f32 v20, v20
  v_exp_f32 v21, v21
  v_exp_f32 v22, v22
  v_exp_f32 v23, v23
  v_exp_f32 v24, v24
  v_exp_f32 v25, v25
  v_exp_f32 v26, v26
  v_exp_f32 v27, v27
  v_pk_fma_f32 v[20:21], v[20:21], v[146:147], v[146:147] op_sel:[0,1,1] op_sel_hi:[1,1,1]
  v_pk_fma_f32 v[22:23], v[22:23], v[146:147], v[146:147] op_sel:[0,1,1] op_sel_hi:[1,1,1]
  v_pk_fma_f32 v[24:25], v[24:25], v[146:147], v[146:147] op_sel:[0,1,1] op_sel_hi:[1,1,1]
  v_pk_fma_f32 v[26:27], v[26:27], v[146:147], v[146:147] op_sel:[0,1,1] op_sel_hi:[1,1,1]
  v_rcp_f32 v20, v20
  v_rcp_f32 v21, v21
  v_rcp_f32 v22, v22
  v_rcp_f32 v23, v23
  v_rcp_f32 v24, v24
  v_rcp_f32 v25, v25
  v_rcp_f32 v26, v26
  v_rcp_f32 v27, v27
  v_pk_mul_f32 v[20:21], v[92:93], v[20:21]
  v_pk_mul_f32 v[22:23], v[94:95], v[22:23]
  v_pk_mul_f32 v[24:25], v[96:97], v[24:25]
  v_pk_mul_f32 v[26:27], v[98:99], v[26:27]
  v_cvt_pk_bf16_f32 v32, v20, v21
  v_cvt_pk_bf16_f32 v33, v22, v23
  v_cvt_pk_bf16_f32 v34, v24, v25
  v_cvt_pk_bf16_f32 v35, v26, v27
  ds_write_b64 v152, v[32:33] offset:2048
  ds_write_b64 v153, v[34:35] offset:2048
  ds_read_b128 v[168:171], v154 offset:2048
  ds_read_b128 v[172:175], v154 offset:3072
  s_waitcnt lgkmcnt(0)
  buffer_store_dwordx4 v[168:171], v157, s[24:27], s72 offen sc1
  buffer_store_dwordx4 v[172:175], v157, s[24:27], s73 offen sc1
  s_waitcnt vmcnt(0)
  s_mov_b64 exec, 1
  v_mov_b32 v2, 0x22808
  v_mov_b32 v3, 1
  ds_add_rtn_u32 v4, v2, v3
  s_waitcnt lgkmcnt(0)
  v_readfirstlane_b32 s4, v4
  s_mov_b64 exec, -1
  s_cmp_eq_u32 s4, 3
  s_cbranch_scc0 L_cd_3040
  s_mov_b32 s28, s56
  s_mov_b32 s29, s57
  s_mov_b32 s30, 0x5800
  s_mov_b32 s31, 0x00020000
  s_add_u32 s4, s32, 72
  s_lshl_b32 s4, s4, 8
  v_mov_b32 v2, s4
  v_mov_b32 v3, 1
  s_mov_b64 exec, 1
  buffer_atomic_add v3, v2, s[28:31], 0 offen
  s_mov_b64 exec, -1
L_cd_3040:
  s_branch c4_start
c3_none:
  s_waitcnt vmcnt(0)
  s_mov_b64 exec, 1
  v_mov_b32 v2, 0x22800
  v_mov_b32 v3, 1
  ds_add_rtn_u32 v4, v2, v3
  s_waitcnt lgkmcnt(0)
  v_readfirstlane_b32 s4, v4
  s_mov_b64 exec, -1
  s_cmp_eq_u32 s4, 3
  s_cbranch_scc0 L_cd_3041
  s_mov_b32 s28, s56
  s_mov_b32 s29, s57
  s_mov_b32 s30, 0x5800
  s_mov_b32 s31, 0x00020000
  s_mov_b32 s4, s99
  s_lshl_b32 s4, s4, 8
  v_mov_b32 v2, s4
  v_mov_b32 v3, 1
  s_mov_b64 exec, 1
  buffer_atomic_add v3, v2, s[28:31], 0 offen
  s_mov_b64 exec, -1
L_cd_3041:
  s_branch c4_start
c3_big:
  v_and_b32 v2, 15, v0
  v_lshrrev_b32 v3, 4, v0
  v_bfe_u32 v4, v0, 1, 3
  s_lshl_b32 s62, s34, 13
  s_lshl_b32 s63, s35, 12
  s_xor_b32 s64, s63, 0x1000
  s_add_u32 s63, s63, s62
  s_add_u32 s64, s64, s62
  v_xor_b32 v5, v3, v4
  v_lshlrev_b32 v5, 4, v5
  v_lshl_add_u32 v5, v2, 7, v5
  v_add_u32 v8, s63, v5
  v_xor_b32 v12, 64, v8
  v_add_u32 v9, 0x10000, v8
  v_add_u32 v13, 0x10000, v12
  v_add_u32 v10, s64, v5
  v_xor_b32 v14, 64, v10
  v_add_u32 v11, 0x10000, v10
  v_add_u32 v15, 0x10000, v14
  v_bfe_u32 v4, v0, 2, 2
  v_and_b32 v6, 1, v3
  v_lshl_or_b32 v6, v6, 2, v4
  v_lshl_add_u32 v7, v3, 3, v4
  v_lshlrev_b32 v7, 8, v7
  v_and_b32 v5, 3, v0
  v_lshl_add_u32 v7, v5, 3, v7
  v_add_u32 v7, 0x4000, v7
  s_lshl_b32 s62, s35, 2
  s_lshl_b32 s63, s34, 1
  s_add_u32 s62, s62, s63
  v_xor_b32 v5, s62, v6
  v_lshl_add_u32 v16, v5, 5, v7
  v_xor_b32 v18, 32, v16
  v_xor_b32 v20, 64, v16
  v_xor_b32 v22, 96, v16
  v_add_u32 v17, 0x10000, v16
  v_add_u32 v19, 0x10000, v18
  v_add_u32 v21, 0x10000, v20
  v_add_u32 v23, 0x10000, v22
  v_mov_b32 v160, 0x3f803f80
  v_mov_b32 v161, 0x3f803f80
  v_mov_b32 v162, 0x3f803f80
  v_mov_b32 v163, 0x3f803f80
  s_lshl_b32 s4, s32, 13
  s_lshl_b32 s5, s34, 9
  s_add_u32 s4, s4, s5
  s_lshl_b32 s5, s35, 8
  s_add_u32 s4, s4, s5
  v_and_b32 v200, 31, v0
  v_lshlrev_b32 v200, 3, v200
  v_lshrrev_b32 v3, 5, v0
  v_lshl_add_u32 v200, v3, 12, v200
  v_add_u32 v200, s4, v200
  s_mov_b32 s75, 2816
  s_lshl_b32 s4, s3, 12
  s_add_u32 s4, s4, 0x22900
  s_lshl_b32 s5, s34, 2
  v_lshrrev_b32 v202, 5, v0
  v_add_u32 v202, s5, v202
  v_and_b32 v203, 7, v0
  v_xor_b32 v202, v202, v203
  v_lshlrev_b32 v202, 4, v202
  v_and_b32 v203, 15, v0
  v_lshl_add_u32 v202, v203, 7, v202
  v_bfe_u32 v203, v0, 4, 1
  v_lshl_add_u32 v202, v203, 3, v202
  v_add_u32 v202, s4, v202
  v_xor_b32 v203, 32, v202
  v_xor_b32 v204, 64, v202
  v_xor_b32 v205, 96, v202
  v_lshrrev_b32 v164, 3, v0
  v_and_b32 v165, 7, v0
  v_xor_b32 v206, v164, v165
  v_lshlrev_b32 v206, 4, v206
  v_lshl_add_u32 v206, v164, 7, v206
  v_add_u32 v206, s4, v206
  s_lshl_b32 s4, s32, 7
  s_lshl_b32 s5, s34, 6
  s_add_u32 s4, s4, s5
  s_lshl_b32 s5, s35, 5
  s_xor_b32 s6, s5, 32
  s_add_u32 s5, s5, s4
  s_add_u32 s6, s6, s4
  v_lshlrev_b32 v165, 4, v165
  v_add_u32 v166, s6, v164
  v_add_u32 v164, s5, v164
  v_mad_u32_u24 v164, v164, s75, v165
  v_mad_u32_u24 v166, v166, s75, v165
  s_lshl_b32 s4, s75, 4
  v_add_u32 v165, s4, v164
  v_add_u32 v167, s4, v166
  s_lshl_b32 s4, s33, 8
  s_lshl_b32 s5, s35, 7
  s_add_u32 s72, s4, s5
  s_add_u32 s73, s72, 22528
  s_cmp_lg_u32 s3, 0
  s_cbranch_scc1 L_c0_3042
  s_add_u32 s5, s32, 16
  s_lshl_b32 s89, s5, 8
  s_mov_b32 s28, s56
  s_mov_b32 s29, s57
  s_mov_b32 s30, 0x5800
  s_mov_b32 s31, 0x00020000
  v_mov_b32 v2, s89
  v_mov_b32 v3, 8
  s_mov_b32 s88, 0
L_poll_3043:
  buffer_load_dword v4, v2, s[28:31], 0 offen sc1
  s_waitcnt vmcnt(0)
  v_cmp_lt_u32 vcc, v4, v3
  s_add_u32 s88, s88, 1
  s_cmp_ge_u32 s88, 200000
  s_cbranch_scc1 L_polled_3044
  s_cbranch_vccz L_polled_3044
  s_sleep 1
  s_branch L_poll_3043
L_polled_3044:
L_c0_3042:
  s_add_u32 s16, s56, 0x8000
  s_addc_u32 s17, s57, 0
  s_mov_b32 s18, 0x20000
  s_mov_b32 s19, 0x00020000
  s_add_u32 s28, s56, 0x980000
  s_addc_u32 s29, s57, 0
  s_mov_b32 s30, 0x580000
  s_mov_b32 s31, 0x00020000
  s_barrier
  buffer_load_dwordx2 v[168:169], v200, s[16:19], 0 offen offset:0 sc1
  buffer_load_dwordx2 v[170:171], v200, s[16:19], 0 offen offset:1024 sc1
  buffer_load_dwordx2 v[172:173], v200, s[16:19], 0 offen offset:2048 sc1
  buffer_load_dwordx2 v[174:175], v200, s[16:19], 0 offen offset:3072 sc1
  s_barrier
  ds_read_b128 v[24:27], v8 offset:0
  ds_read_b64_tr_b16 v[40:41], v16 offset:0
  ds_read_b64_tr_b16 v[42:43], v16 offset:1024
  ds_read_b128 v[28:31], v8 offset:2048
  ds_read_b64_tr_b16 v[44:45], v18 offset:0
  ds_read_b64_tr_b16 v[46:47], v18 offset:1024
  ds_read_b128 v[32:35], v10 offset:0
  ds_read_b64_tr_b16 v[48:49], v20 offset:0
  ds_read_b64_tr_b16 v[50:51], v20 offset:1024
  ds_read_b128 v[36:39], v10 offset:2048
  ds_read_b64_tr_b16 v[52:53], v22 offset:0
  ds_read_b64_tr_b16 v[54:55], v22 offset:1024
  s_waitcnt lgkmcnt(0)
  v_mfma_f32_16x16x32_bf16 v[88:91], v[40:43], v[24:27], 0
  ds_read_b128 v[56:59], v12 offset:0
  v_mfma_f32_16x16x32_bf16 v[92:95], v[44:47], v[24:27], 0
  ds_read_b64_tr_b16 v[72:73], v16 offset:8192
  v_mfma_f32_16x16x32_bf16 v[96:99], v[48:51], v[24:27], 0
  ds_read_b64_tr_b16 v[74:75], v16 offset:9216
  v_mfma_f32_16x16x32_bf16 v[100:103], v[52:55], v[24:27], 0
  ds_read_b128 v[60:63], v12 offset:2048
  v_mfma_f32_16x16x32_bf16 v[104:107], v[40:43], v[28:31], 0
  ds_read_b64_tr_b16 v[76:77], v18 offset:8192
  v_mfma_f32_16x16x32_bf16 v[108:111], v[44:47], v[28:31], 0
  ds_read_b64_tr_b16 v[78:79], v18 offset:9216
  v_mfma_f32_16x16x32_bf16 v[112:115], v[48:51], v[28:31], 0
  ds_read_b128 v[64:67], v14 offset:0
  v_mfma_f32_16x16x32_bf16 v[116:119], v[52:55], v[28:31], 0
  ds_read_b64_tr_b16 v[80:81], v20 offset:8192
  v_mfma_f32_16x16x32_bf16 v[120:123], v[40:43], v[32:35], 0
  ds_read_b64_tr_b16 v[82:83], v20 offset:9216
  v_mfma_f32_16x16x32_bf16 v[124:127], v[44:47], v[32:35], 0
  ds_read_b128 v[68:71], v14 offset:2048
  v_mfma_f32_16x16x32_bf16 v[128:131], v[48:51], v[32:35], 0
  ds_read_b64_tr_b16 v[84:85], v22 offset:8192
  v_mfma_f32_16x16x32_bf16 v[132:135], v[52:55], v[32:35], 0
  ds_read_b64_tr_b16 v[86:87], v22 offset:9216
  v_mfma_f32_16x16x32_bf16 v[136:139], v[40:43], v[36:39], 0
  v_mfma_f32_16x16x32_bf16 v[140:143], v[44:47], v[36:39], 0
  v_mfma_f32_16x16x32_bf16 v[144:147], v[48:51], v[36:39], 0
  v_mfma_f32_16x16x32_bf16 v[148:151], v[52:55], v[36:39], 0
  v_mfma_f32_16x16x32_bf16 v[152:155], v[160:163], v[40:43], 0
  v_mfma_f32_16x16x32_bf16 v[156:159], v[160:163], v[44:47], 0
  s_waitcnt lgkmcnt(0)
  s_barrier
  v_mfma_f32_16x16x32_bf16 v[88:91], v[72:75], v[56:59], v[88:91]
  ds_read_b128 v[24:27], v8 offset:32768
  v_mfma_f32_16x16x32_bf16 v[92:95], v[76:79], v[56:59], v[92:95]
  ds_read_b64_tr_b16 v[40:41], v16 offset:32768
  v_mfma_f32_16x16x32_bf16 v[96:99], v[80:83], v[56:59], v[96:99]
  ds_read_b64_tr_b16 v[42:43], v16 offset:33792
  v_mfma_f32_16x16x32_bf16 v[100:103], v[84:87], v[56:59], v[100:103]
  ds_read_b128 v[28:31], v8 offset:34816
  v_mfma_f32_16x16x32_bf16 v[104:107], v[72:75], v[60:63], v[104:107]
  ds_read_b64_tr_b16 v[44:45], v18 offset:32768
  v_mfma_f32_16x16x32_bf16 v[108:111], v[76:79], v[60:63], v[108:111]
  ds_read_b64_tr_b16 v[46:47], v18 offset:33792
  v_mfma_f32_16x16x32_bf16 v[112:115], v[80:83], v[60:63], v[112:115]
  ds_read_b128 v[32:35], v10 offset:32768
  v_mfma_f32_16x16x32_bf16 v[116:119], v[84:87], v[60:63], v[116:119]
  ds_read_b64_tr_b16 v[48:49], v20 offset:32768
  v_mfma_f32_16x16x32_bf16 v[120:123], v[72:75], v[64:67], v[120:123]
  ds_read_b64_tr_b16 v[50:51], v20 offset:33792
  v_mfma_f32_16x16x32_bf16 v[124:127], v[76:79], v[64:67], v[124:127]
  ds_read_b128 v[36:39], v10 offset:34816
  v_mfma_f32_16x16x32_bf16 v[128:131], v[80:83], v[64:67], v[128:131]
  ds_read_b64_tr_b16 v[52:53], v22 offset:32768
  v_mfma_f32_16x16x32_bf16 v[132:135], v[84:87], v[64:67], v[132:135]
  ds_read_b64_tr_b16 v[54:55], v22 offset:33792
  v_mfma_f32_16x16x32_bf16 v[136:139], v[72:75], v[68:71], v[136:139]
  v_mfma_f32_16x16x32_bf16 v[140:143], v[76:79], v[68:71], v[140:143]
  v_mfma_f32_16x16x32_bf16 v[144:147], v[80:83], v[68:71], v[144:147]
  v_mfma_f32_16x16x32_bf16 v[148:151], v[84:87], v[68:71], v[148:151]
  v_mfma_f32_16x16x32_bf16 v[152:155], v[160:163], v[72:75], v[152:155]
  v_mfma_f32_16x16x32_bf16 v[156:159], v[160:163], v[76:79], v[156:159]
  s_waitcnt lgkmcnt(0)
  v_mfma_f32_16x16x32_bf16 v[88:91], v[40:43], v[24:27], v[88:91]
  ds_read_b128 v[56:59], v12 offset:32768
  v_mfma_f32_16x16x32_bf16 v[92:95], v[44:47], v[24:27], v[92:95]
  ds_read_b64_tr_b16 v[72:73], v16 offset:40960
  v_mfma_f32_16x16x32_bf16 v[96:99], v[48:51], v[24:27], v[96:99]
  ds_read_b64_tr_b16 v[74:75], v16 offset:41984
  v_mfma_f32_16x16x32_bf16 v[100:103], v[52:55], v[24:27], v[100:103]
  ds_read_b128 v[60:63], v12 offset:34816
  v_mfma_f32_16x16x32_bf16 v[104:107], v[40:43], v[28:31], v[104:107]
  ds_read_b64_tr_b16 v[76:77], v18 offset:40960
  v_mfma_f32_16x16x32_bf16 v[108:111], v[44:47], v[28:31], v[108:111]
  ds_read_b64_tr_b16 v[78:79], v18 offset:41984
  v_mfma_f32_16x16x32_bf16 v[112:115], v[48:51], v[28:31], v[112:115]
  ds_read_b128 v[64:67], v14 offset:32768
  v_mfma_f32_16x16x32_bf16 v[116:119], v[52:55], v[28:31], v[116:119]
  ds_read_b64_tr_b16 v[80:81], v20 offset:40960
  v_mfma_f32_16x16x32_bf16 v[120:123], v[40:43], v[32:35], v[120:123]
  ds_read_b64_tr_b16 v[82:83], v20 offset:41984
  v_mfma_f32_16x16x32_bf16 v[124:127], v[44:47], v[32:35], v[124:127]
  ds_read_b128 v[68:71], v14 offset:34816
  v_mfma_f32_16x16x32_bf16 v[128:131], v[48:51], v[32:35], v[128:131]
  ds_read_b64_tr_b16 v[84:85], v22 offset:40960
  v_mfma_f32_16x16x32_bf16 v[132:135], v[52:55], v[32:35], v[132:135]
  ds_read_b64_tr_b16 v[86:87], v22 offset:41984
  v_mfma_f32_16x16x32_bf16 v[136:139], v[40:43], v[36:39], v[136:139]
  v_mfma_f32_16x16x32_bf16 v[140:143], v[44:47], v[36:39], v[140:143]
  v_mfma_f32_16x16x32_bf16 v[144:147], v[48:51], v[36:39], v[144:147]
  v_mfma_f32_16x16x32_bf16 v[148:151], v[52:55], v[36:39], v[148:151]
  v_mfma_f32_16x16x32_bf16 v[152:155], v[160:163], v[40:43], v[152:155]
  v_mfma_f32_16x16x32_bf16 v[156:159], v[160:163], v[44:47], v[156:159]
  s_waitcnt lgkmcnt(0)
  s_barrier
  v_mfma_f32_16x16x32_bf16 v[88:91], v[72:75], v[56:59], v[88:91]
  ds_read_b128 v[24:27], v9 offset:0
  v_mfma_f32_16x16x32_bf16 v[92:95], v[76:79], v[56:59], v[92:95]
  ds_read_b64_tr_b16 v[40:41], v17 offset:0
  v_mfma_f32_16x16x32_bf16 v[96:99], v[80:83], v[56:59], v[96:99]
  ds_read_b64_tr_b16 v[42:43], v17 offset:1024
  v_mfma_f32_16x16x32_bf16 v[100:103], v[84:87], v[56:59], v[100:103]
  ds_read_b128 v[28:31], v9 offset:2048
  v_mfma_f32_16x16x32_bf16 v[104:107], v[72:75], v[60:63], v[104:107]
  ds_read_b64_tr_b16 v[44:45], v19 offset:0
  v_mfma_f32_16x16x32_bf16 v[108:111], v[76:79], v[60:63], v[108:111]
  ds_read_b64_tr_b16 v[46:47], v19 offset:1024
  v_mfma_f32_16x16x32_bf16 v[112:115], v[80:83], v[60:63], v[112:115]
  ds_read_b128 v[32:35], v11 offset:0
  v_mfma_f32_16x16x32_bf16 v[116:119], v[84:87], v[60:63], v[116:119]
  ds_read_b64_tr_b16 v[48:49], v21 offset:0
  v_mfma_f32_16x16x32_bf16 v[120:123], v[72:75], v[64:67], v[120:123]
  ds_read_b64_tr_b16 v[50:51], v21 offset:1024
  v_mfma_f32_16x16x32_bf16 v[124:127], v[76:79], v[64:67], v[124:127]
  ds_read_b128 v[36:39], v11 offset:2048
  v_mfma_f32_16x16x32_bf16 v[128:131], v[80:83], v[64:67], v[128:131]
  ds_read_b64_tr_b16 v[52:53], v23 offset:0
  v_mfma_f32_16x16x32_bf16 v[132:135], v[84:87], v[64:67], v[132:135]
  ds_read_b64_tr_b16 v[54:55], v23 offset:1024
  v_mfma_f32_16x16x32_bf16 v[136:139], v[72:75], v[68:71], v[136:139]
  v_mfma_f32_16x16x32_bf16 v[140:143], v[76:79], v[68:71], v[140:143]
  v_mfma_f32_16x16x32_bf16 v[144:147], v[80:83], v[68:71], v[144:147]
  v_mfma_f32_16x16x32_bf16 v[148:151], v[84:87], v[68:71], v[148:151]
  v_mfma_f32_16x16x32_bf16 v[152:155], v[160:163], v[72:75], v[152:155]
  v_mfma_f32_16x16x32_bf16 v[156:159], v[160:163], v[76:79], v[156:159]
  s_waitcnt lgkmcnt(0)
  v_mfma_f32_16x16x32_bf16 v[88:91], v[40:43], v[24:27], v[88:91]
  ds_read_b128 v[56:59], v13 offset:0
  v_mfma_f32_16x16x32_bf16 v[92:95], v[44:47], v[24:27], v[92:95]
  ds_read_b64_tr_b16 v[72:73], v17 offset:8192
  v_mfma_f32_16x16x32_bf16 v[96:99], v[48:51], v[24:27], v[96:99]
  ds_read_b64_tr_b16 v[74:75], v17 offset:9216
  v_mfma_f32_16x16x32_bf16 v[100:103], v[52:55], v[24:27], v[100:103]
  ds_read_b128 v[60:63], v13 offset:2048
  v_mfma_f32_16x16x32_bf16 v[104:107], v[40:43], v[28:31], v[104:107]
  ds_read_b64_tr_b16 v[76:77], v19 offset:8192
  v_mfma_f32_16x16x32_bf16 v[108:111], v[44:47], v[28:31], v[108:111]
  ds_read_b64_tr_b16 v[78:79], v19 offset:9216
  v_mfma_f32_16x16x32_bf16 v[112:115], v[48:51], v[28:31], v[112:115]
  ds_read_b128 v[64:67], v15 offset:0
  v_mfma_f32_16x16x32_bf16 v[116:119], v[52:55], v[28:31], v[116:119]
  ds_read_b64_tr_b16 v[80:81], v21 offset:8192
  v_mfma_f32_16x16x32_bf16 v[120:123], v[40:43], v[32:35], v[120:123]
  ds_read_b64_tr_b16 v[82:83], v21 offset:9216
  v_mfma_f32_16x16x32_bf16 v[124:127], v[44:47], v[32:35], v[124:127]
  ds_read_b128 v[68:71], v15 offset:2048
  v_mfma_f32_16x16x32_bf16 v[128:131], v[48:51], v[32:35], v[128:131]
  ds_read_b64_tr_b16 v[84:85], v23 offset:8192
  v_mfma_f32_16x16x32_bf16 v[132:135], v[52:55], v[32:35], v[132:135]
  ds_read_b64_tr_b16 v[86:87], v23 offset:9216
  v_mfma_f32_16x16x32_bf16 v[136:139], v[40:43], v[36:39], v[136:139]
  v_mfma_f32_16x16x32_bf16 v[140:143], v[44:47], v[36:39], v[140:143]
  v_mfma_f32_16x16x32_bf16 v[144:147], v[48:51], v[36:39], v[144:147]
  v_mfma_f32_16x16x32_bf16 v[148:151], v[52:55], v[36:39], v[148:151]
  v_mfma_f32_16x16x32_bf16 v[152:155], v[160:163], v[40:43], v[152:155]
  v_mfma_f32_16x16x32_bf16 v[156:159], v[160:163], v[44:47], v[156:159]
  s_waitcnt lgkmcnt(0)
  s_barrier
  v_mfma_f32_16x16x32_bf16 v[88:91], v[72:75], v[56:59], v[88:91]
  ds_read_b128 v[24:27], v9 offset:32768
  v_mfma_f32_16x16x32_bf16 v[92:95], v[76:79], v[56:59], v[92:95]
  ds_read_b64_tr_b16 v[40:41], v17 offset:32768
  v_mfma_f32_16x16x32_bf16 v[96:99], v[80:83], v[56:59], v[96:99]
  ds_read_b64_tr_b16 v[42:43], v17 offset:33792
  v_mfma_f32_16x16x32_bf16 v[100:103], v[84:87], v[56:59], v[100:103]
  ds_read_b128 v[28:31], v9 offset:34816
  v_mfma_f32_16x16x32_bf16 v[104:107], v[72:75], v[60:63], v[104:107]
  ds_read_b64_tr_b16 v[44:45], v19 offset:32768
  v_mfma_f32_16x16x32_bf16 v[108:111], v[76:79], v[60:63], v[108:111]
  ds_read_b64_tr_b16 v[46:47], v19 offset:33792
  v_mfma_f32_16x16x32_bf16 v[112:115], v[80:83], v[60:63], v[112:115]
  ds_read_b128 v[32:35], v11 offset:32768
  v_mfma_f32_16x16x32_bf16 v[116:119], v[84:87], v[60:63], v[116:119]
  ds_read_b64_tr_b16 v[48:49], v21 offset:32768
  v_mfma_f32_16x16x32_bf16 v[120:123], v[72:75], v[64:67], v[120:123]
  ds_read_b64_tr_b16 v[50:51], v21 offset:33792
  v_mfma_f32_16x16x32_bf16 v[124:127], v[76:79], v[64:67], v[124:127]
  ds_read_b128 v[36:39], v11 offset:34816
  v_mfma_f32_16x16x32_bf16 v[128:131], v[80:83], v[64:67], v[128:131]
  ds_read_b64_tr_b16 v[52:53], v23 offset:32768
  v_mfma_f32_16x16x32_bf16 v[132:135], v[84:87], v[64:67], v[132:135]
  ds_read_b64_tr_b16 v[54:55], v23 offset:33792
  v_mfma_f32_16x16x32_bf16 v[136:139], v[72:75], v[68:71], v[136:139]
  v_mfma_f32_16x16x32_bf16 v[140:143], v[76:79], v[68:71], v[140:143]
  v_mfma_f32_16x16x32_bf16 v[144:147], v[80:83], v[68:71], v[144:147]
  v_mfma_f32_16x16x32_bf16 v[148:151], v[84:87], v[68:71], v[148:151]
  v_mfma_f32_16x16x32_bf16 v[152:155], v[160:163], v[72:75], v[152:155]
  v_mfma_f32_16x16x32_bf16 v[156:159], v[160:163], v[76:79], v[156:159]
  s_waitcnt lgkmcnt(0)
  v_mfma_f32_16x16x32_bf16 v[88:91], v[40:43], v[24:27], v[88:91]
  ds_read_b128 v[56:59], v13 offset:32768
  v_mfma_f32_16x16x32_bf16 v[92:95], v[44:47], v[24:27], v[92:95]
  ds_read_b64_tr_b16 v[72:73], v17 offset:40960
  v_mfma_f32_16x16x32_bf16 v[96:99], v[48:51], v[24:27], v[96:99]
  ds_read_b64_tr_b16 v[74:75], v17 offset:41984
  v_mfma_f32_16x16x32_bf16 v[100:103], v[52:55], v[24:27], v[100:103]
  ds_read_b128 v[60:63], v13 offset:34816
  v_mfma_f32_16x16x32_bf16 v[104:107], v[40:43], v[28:31], v[104:107]
  ds_read_b64_tr_b16 v[76:77], v19 offset:40960
  v_mfma_f32_16x16x32_bf16 v[108:111], v[44:47], v[28:31], v[108:111]
  ds_read_b64_tr_b16 v[78:79], v19 offset:41984
  v_mfma_f32_16x16x32_bf16 v[112:115], v[48:51], v[28:31], v[112:115]
  ds_read_b128 v[64:67], v15 offset:32768
  v_mfma_f32_16x16x32_bf16 v[116:119], v[52:55], v[28:31], v[116:119]
  ds_read_b64_tr_b16 v[80:81], v21 offset:40960
  v_mfma_f32_16x16x32_bf16 v[120:123], v[40:43], v[32:35], v[120:123]
  ds_read_b64_tr_b16 v[82:83], v21 offset:41984
  v_mfma_f32_16x16x32_bf16 v[124:127], v[44:47], v[32:35], v[124:127]
  ds_read_b128 v[68:71], v15 offset:34816
  v_mfma_f32_16x16x32_bf16 v[128:131], v[48:51], v[32:35], v[128:131]
  ds_read_b64_tr_b16 v[84:85], v23 offset:40960
  v_mfma_f32_16x16x32_bf16 v[132:135], v[52:55], v[32:35], v[132:135]
  ds_read_b64_tr_b16 v[86:87], v23 offset:41984
  v_mfma_f32_16x16x32_bf16 v[136:139], v[40:43], v[36:39], v[136:139]
  v_mfma_f32_16x16x32_bf16 v[140:143], v[44:47], v[36:39], v[140:143]
  v_mfma_f32_16x16x32_bf16 v[144:147], v[48:51], v[36:39], v[144:147]
  v_mfma_f32_16x16x32_bf16 v[148:151], v[52:55], v[36:39], v[148:151]
  v_mfma_f32_16x16x32_bf16 v[152:155], v[160:163], v[40:43], v[152:155]
  v_mfma_f32_16x16x32_bf16 v[156:159], v[160:163], v[44:47], v[156:159]
  s_waitcnt lgkmcnt(0)
  s_barrier
  v_mfma_f32_16x16x32_bf16 v[88:91], v[72:75], v[56:59], v[88:91]
  ds_read_b128 v[24:27], v8 offset:0
  v_mfma_f32_16x16x32_bf16 v[92:95], v[76:79], v[56:59], v[92:95]
  ds_read_b64_tr_b16 v[40:41], v16 offset:0
  v_mfma_f32_16x16x32_bf16 v[96:99], v[80:83], v[56:59], v[96:99]
  ds_read_b64_tr_b16 v[42:43], v16 offset:1024
  v_mfma_f32_16x16x32_bf16 v[100:103], v[84:87], v[56:59], v[100:103]
  ds_read_b128 v[28:31], v8 offset:2048
  v_mfma_f32_16x16x32_bf16 v[104:107], v[72:75], v[60:63], v[104:107]
  ds_read_b64_tr_b16 v[44:45], v18 offset:0
  v_mfma_f32_16x16x32_bf16 v[108:111], v[76:79], v[60:63], v[108:111]
  ds_read_b64_tr_b16 v[46:47], v18 offset:1024
  v_mfma_f32_16x16x32_bf16 v[112:115], v[80:83], v[60:63], v[112:115]
  ds_read_b128 v[32:35], v10 offset:0
  v_mfma_f32_16x16x32_bf16 v[116:119], v[84:87], v[60:63], v[116:119]
  ds_read_b64_tr_b16 v[48:49], v20 offset:0
  v_mfma_f32_16x16x32_bf16 v[120:123], v[72:75], v[64:67], v[120:123]
  ds_read_b64_tr_b16 v[50:51], v20 offset:1024
  v_mfma_f32_16x16x32_bf16 v[124:127], v[76:79], v[64:67], v[124:127]
  ds_read_b128 v[36:39], v10 offset:2048
  v_mfma_f32_16x16x32_bf16 v[128:131], v[80:83], v[64:67], v[128:131]
  ds_read_b64_tr_b16 v[52:53], v22 offset:0
  v_mfma_f32_16x16x32_bf16 v[132:135], v[84:87], v[64:67], v[132:135]
  ds_read_b64_tr_b16 v[54:55], v22 offset:1024
  v_mfma_f32_16x16x32_bf16 v[136:139], v[72:75], v[68:71], v[136:139]
  v_mfma_f32_16x16x32_bf16 v[140:143], v[76:79], v[68:71], v[140:143]
  v_mfma_f32_16x16x32_bf16 v[144:147], v[80:83], v[68:71], v[144:147]
  v_mfma_f32_16x16x32_bf16 v[148:151], v[84:87], v[68:71], v[148:151]
  v_mfma_f32_16x16x32_bf16 v[152:155], v[160:163], v[72:75], v[152:155]
  v_mfma_f32_16x16x32_bf16 v[156:159], v[160:163], v[76:79], v[156:159]
  s_waitcnt lgkmcnt(0)
  v_mfma_f32_16x16x32_bf16 v[88:91], v[40:43], v[24:27], v[88:91]
  ds_read_b128 v[56:59], v12 offset:0
  v_mfma_f32_16x16x32_bf16 v[92:95], v[44:47], v[24:27], v[92:95]
  ds_read_b64_tr_b16 v[72:73], v16 offset:8192
  v_mfma_f32_16x16x32_bf16 v[96:99], v[48:51], v[24:27], v[96:99]
  ds_read_b64_tr_b16 v[74:75], v16 offset:9216
  v_mfma_f32_16x16x32_bf16 v[100:103], v[52:55], v[24:27], v[100:103]
  ds_read_b128 v[60:63], v12 offset:2048
  v_mfma_f32_16x16x32_bf16 v[104:107], v[40:43], v[28:31], v[104:107]
  ds_read_b64_tr_b16 v[76:77], v18 offset:8192
  v_mfma_f32_16x16x32_bf16 v[108:111], v[44:47], v[28:31], v[108:111]
  ds_read_b64_tr_b16 v[78:79], v18 offset:9216
  v_mfma_f32_16x16x32_bf16 v[112:115], v[48:51], v[28:31], v[112:115]
  ds_read_b128 v[64:67], v14 offset:0
  v_mfma_f32_16x16x32_bf16 v[116:119], v[52:55], v[28:31], v[116:119]
  ds_read_b64_tr_b16 v[80:81], v20 offset:8192
  v_mfma_f32_16x16x32_bf16 v[120:123], v[40:43], v[32:35], v[120:123]
  ds_read_b64_tr_b16 v[82:83], v20 offset:9216
  v_mfma_f32_16x16x32_bf16 v[124:127], v[44:47], v[32:35], v[124:127]
  ds_read_b128 v[68:71], v14 offset:2048
  v_mfma_f32_16x16x32_bf16 v[128:131], v[48:51], v[32:35], v[128:131]
  ds_read_b64_tr_b16 v[84:85], v22 offset:8192
  v_mfma_f32_16x16x32_bf16 v[132:135], v[52:55], v[32:35], v[132:135]
  ds_read_b64_tr_b16 v[86:87], v22 offset:9216
  v_mfma_f32_16x16x32_bf16 v[136:139], v[40:43], v[36:39], v[136:139]
  v_mfma_f32_16x16x32_bf16 v[140:143], v[44:47], v[36:39], v[140:143]
  v_mfma_f32_16x16x32_bf16 v[144:147], v[48:51], v[36:39], v[144:147]
  v_mfma_f32_16x16x32_bf16 v[148:151], v[52:55], v[36:39], v[148:151]
  v_mfma_f32_16x16x32_bf16 v[152:155], v[160:163], v[40:43], v[152:155]
  v_mfma_f32_16x16x32_bf16 v[156:159], v[160:163], v[44:47], v[156:159]
  s_waitcnt lgkmcnt(0)
  s_barrier
  v_mfma_f32_16x16x32_bf16 v[88:91], v[72:75], v[56:59], v[88:91]
  ds_read_b128 v[24:27], v8 offset:32768
  v_mfma_f32_16x16x32_bf16 v[92:95], v[76:79], v[56:59], v[92:95]
  ds_read_b64_tr_b16 v[40:41], v16 offset:32768
  v_mfma_f32_16x16x32_bf16 v[96:99], v[80:83], v[56:59], v[96:99]
  ds_read_b64_tr_b16 v[42:43], v16 offset:33792
  v_mfma_f32_16x16x32_bf16 v[100:103], v[84:87], v[56:59], v[100:103]
  ds_read_b128 v[28:31], v8 offset:34816
  v_mfma_f32_16x16x32_bf16 v[104:107], v[72:75], v[60:63], v[104:107]
  ds_read_b64_tr_b16 v[44:45], v18 offset:32768
  v_mfma_f32_16x16x32_bf16 v[108:111], v[76:79], v[60:63], v[108:111]
  ds_read_b64_tr_b16 v[46:47], v18 offset:33792
  v_mfma_f32_16x16x32_bf16 v[112:115], v[80:83], v[60:63], v[112:115]
  ds_read_b128 v[32:35], v10 offset:32768
  v_mfma_f32_16x16x32_bf16 v[116:119], v[84:87], v[60:63], v[116:119]
  ds_read_b64_tr_b16 v[48:49], v20 offset:32768
  v_mfma_f32_16x16x32_bf16 v[120:123], v[72:75], v[64:67], v[120:123]
  ds_read_b64_tr_b16 v[50:51], v20 offset:33792
  v_mfma_f32_16x16x32_bf16 v[124:127], v[76:79], v[64:67], v[124:127]
  ds_read_b128 v[36:39], v10 offset:34816
  v_mfma_f32_16x16x32_bf16 v[128:131], v[80:83], v[64:67], v[128:131]
  ds_read_b64_tr_b16 v[52:53], v22 offset:32768
  v_mfma_f32_16x16x32_bf16 v[132:135], v[84:87], v[64:67], v[132:135]
  ds_read_b64_tr_b16 v[54:55], v22 offset:33792
  v_mfma_f32_16x16x32_bf16 v[136:139], v[72:75], v[68:71], v[136:139]
  v_mfma_f32_16x16x32_bf16 v[140:143], v[76:79], v[68:71], v[140:143]
  v_mfma_f32_16x16x32_bf16 v[144:147], v[80:83], v[68:71], v[144:147]
  v_mfma_f32_16x16x32_bf16 v[148:151], v[84:87], v[68:71], v[148:151]
  v_mfma_f32_16x16x32_bf16 v[152:155], v[160:163], v[72:75], v[152:155]
  v_mfma_f32_16x16x32_bf16 v[156:159], v[160:163], v[76:79], v[156:159]
  s_waitcnt lgkmcnt(0)
  v_mfma_f32_16x16x32_bf16 v[88:91], v[40:43], v[24:27], v[88:91]
  ds_read_b128 v[56:59], v12 offset:32768
  v_mfma_f32_16x16x32_bf16 v[92:95], v[44:47], v[24:27], v[92:95]
  ds_read_b64_tr_b16 v[72:73], v16 offset:40960
  v_mfma_f32_16x16x32_bf16 v[96:99], v[48:51], v[24:27], v[96:99]
  ds_read_b64_tr_b16 v[74:75], v16 offset:41984
  v_mfma_f32_16x16x32_bf16 v[100:103], v[52:55], v[24:27], v[100:103]
  ds_read_b128 v[60:63], v12 offset:34816
  v_mfma_f32_16x16x32_bf16 v[104:107], v[40:43], v[28:31], v[104:107]
  ds_read_b64_tr_b16 v[76:77], v18 offset:40960
  v_mfma_f32_16x16x32_bf16 v[108:111], v[44:47], v[28:31], v[108:111]
  ds_read_b64_tr_b16 v[78:79], v18 offset:41984
  v_mfma_f32_16x16x32_bf16 v[112:115], v[48:51], v[28:31], v[112:115]
  ds_read_b128 v[64:67], v14 offset:32768
  v_mfma_f32_16x16x32_bf16 v[116:119], v[52:55], v[28:31], v[116:119]
  ds_read_b64_tr_b16 v[80:81], v20 offset:40960
  v_mfma_f32_16x16x32_bf16 v[120:123], v[40:43], v[32:35], v[120:123]
  ds_read_b64_tr_b16 v[82:83], v20 offset:41984
  v_mfma_f32_16x16x32_bf16 v[124:127], v[44:47], v[32:35], v[124:127]
  ds_read_b128 v[68:71], v14 offset:34816
  v_mfma_f32_16x16x32_bf16 v[128:131], v[48:51], v[32:35], v[128:131]
  ds_read_b64_tr_b16 v[84:85], v22 offset:40960
  v_mfma_f32_16x16x32_bf16 v[132:135], v[52:55], v[32:35], v[132:135]
  ds_read_b64_tr_b16 v[86:87], v22 offset:41984
  v_mfma_f32_16x16x32_bf16 v[136:139], v[40:43], v[36:39], v[136:139]
  v_mfma_f32_16x16x32_bf16 v[140:143], v[44:47], v[36:39], v[140:143]
  v_mfma_f32_16x16x32_bf16 v[144:147], v[48:51], v[36:39], v[144:147]
  v_mfma_f32_16x16x32_bf16 v[148:151], v[52:55], v[36:39], v[148:151]
  v_mfma_f32_16x16x32_bf16 v[152:155], v[160:163], v[40:43], v[152:155]
  v_mfma_f32_16x16x32_bf16 v[156:159], v[160:163], v[44:47], v[156:159]
  s_waitcnt lgkmcnt(0)
  s_barrier
  v_mfma_f32_16x16x32_bf16 v[88:91], v[72:75], v[56:59], v[88:91]
  ds_read_b128 v[24:27], v9 offset:0
  v_mfma_f32_16x16x32_bf16 v[92:95], v[76:79], v[56:59], v[92:95]
  ds_read_b64_tr_b16 v[40:41], v17 offset:0
  v_mfma_f32_16x16x32_bf16 v[96:99], v[80:83], v[56:59], v[96:99]
  ds_read_b64_tr_b16 v[42:43], v17 offset:1024
  v_mfma_f32_16x16x32_bf16 v[100:103], v[84:87], v[56:59], v[100:103]
  ds_read_b128 v[28:31], v9 offset:2048
  v_mfma_f32_16x16x32_bf16 v[104:107], v[72:75], v[60:63], v[104:107]
  ds_read_b64_tr_b16 v[44:45], v19 offset:0
  v_mfma_f32_16x16x32_bf16 v[108:111], v[76:79], v[60:63], v[108:111]
  ds_read_b64_tr_b16 v[46:47], v19 offset:1024
  v_mfma_f32_16x16x32_bf16 v[112:115], v[80:83], v[60:63], v[112:115]
  ds_read_b128 v[32:35], v11 offset:0
  v_mfma_f32_16x16x32_bf16 v[116:119], v[84:87], v[60:63], v[116:119]
  ds_read_b64_tr_b16 v[48:49], v21 offset:0
  v_mfma_f32_16x16x32_bf16 v[120:123], v[72:75], v[64:67], v[120:123]
  ds_read_b64_tr_b16 v[50:51], v21 offset:1024
  v_mfma_f32_16x16x32_bf16 v[124:127], v[76:79], v[64:67], v[124:127]
  ds_read_b128 v[36:39], v11 offset:2048
  v_mfma_f32_16x16x32_bf16 v[128:131], v[80:83], v[64:67], v[128:131]
  ds_read_b64_tr_b16 v[52:53], v23 offset:0
  v_mfma_f32_16x16x32_bf16 v[132:135], v[84:87], v[64:67], v[132:135]
  ds_read_b64_tr_b16 v[54:55], v23 offset:1024
  v_mfma_f32_16x16x32_bf16 v[136:139], v[72:75], v[68:71], v[136:139]
  v_mfma_f32_16x16x32_bf16 v[140:143], v[76:79], v[68:71], v[140:143]
  v_mfma_f32_16x16x32_bf16 v[144:147], v[80:83], v[68:71], v[144:147]
  v_mfma_f32_16x16x32_bf16 v[148:151], v[84:87], v[68:71], v[148:151]
  v_mfma_f32_16x16x32_bf16 v[152:155], v[160:163], v[72:75], v[152:155]
  v_mfma_f32_16x16x32_bf16 v[156:159], v[160:163], v[76:79], v[156:159]
  s_waitcnt lgkmcnt(0)
  v_mfma_f32_16x16x32_bf16 v[88:91], v[40:43], v[24:27], v[88:91]
  ds_read_b128 v[56:59], v13 offset:0
  v_mfma_f32_16x16x32_bf16 v[92:95], v[44:47], v[24:27], v[92:95]
  ds_read_b64_tr_b16 v[72:73], v17 offset:8192
  v_mfma_f32_16x16x32_bf16 v[96:99], v[48:51], v[24:27], v[96:99]
  ds_read_b64_tr_b16 v[74:75], v17 offset:9216
  v_mfma_f32_16x16x32_bf16 v[100:103], v[52:55], v[24:27], v[100:103]
  ds_read_b128 v[60:63], v13 offset:2048
  v_mfma_f32_16x16x32_bf16 v[104:107], v[40:43], v[28:31], v[104:107]
  ds_read_b64_tr_b16 v[76:77], v19 offset:8192
  v_mfma_f32_16x16x32_bf16 v[108:111], v[44:47], v[28:31], v[108:111]
  ds_read_b64_tr_b16 v[78:79], v19 offset:9216
  v_mfma_f32_16x16x32_bf16 v[112:115], v[48:51], v[28:31], v[112:115]
  ds_read_b128 v[64:67], v15 offset:0
  v_mfma_f32_16x16x32_bf16 v[116:119], v[52:55], v[28:31], v[116:119]
  ds_read_b64_tr_b16 v[80:81], v21 offset:8192
  v_mfma_f32_16x16x32_bf16 v[120:123], v[40:43], v[32:35], v[120:123]
  ds_read_b64_tr_b16 v[82:83], v21 offset:9216
  v_mfma_f32_16x16x32_bf16 v[124:127], v[44:47], v[32:35], v[124:127]
  ds_read_b128 v[68:71], v15 offset:2048
  v_mfma_f32_16x16x32_bf16 v[128:131], v[48:51], v[32:35], v[128:131]
  ds_read_b64_tr_b16 v[84:85], v23 offset:8192
  v_mfma_f32_16x16x32_bf16 v[132:135], v[52:55], v[32:35], v[132:135]
  ds_read_b64_tr_b16 v[86:87], v23 offset:9216
  v_mfma_f32_16x16x32_bf16 v[136:139], v[40:43], v[36:39], v[136:139]
  v_mfma_f32_16x16x32_bf16 v[140:143], v[44:47], v[36:39], v[140:143]
  v_mfma_f32_16x16x32_bf16 v[144:147], v[48:51], v[36:39], v[144:147]
  v_mfma_f32_16x16x32_bf16 v[148:151], v[52:55], v[36:39], v[148:151]
  v_mfma_f32_16x16x32_bf16 v[152:155], v[160:163], v[40:43], v[152:155]
  v_mfma_f32_16x16x32_bf16 v[156:159], v[160:163], v[44:47], v[156:159]
  s_waitcnt lgkmcnt(0)
  s_barrier
  v_mfma_f32_16x16x32_bf16 v[88:91], v[72:75], v[56:59], v[88:91]
  ds_read_b128 v[24:27], v9 offset:32768
  v_mfma_f32_16x16x32_bf16 v[92:95], v[76:79], v[56:59], v[92:95]
  ds_read_b64_tr_b16 v[40:41], v17 offset:32768
  v_mfma_f32_16x16x32_bf16 v[96:99], v[80:83], v[56:59], v[96:99]
  ds_read_b64_tr_b16 v[42:43], v17 offset:33792
  v_mfma_f32_16x16x32_bf16 v[100:103], v[84:87], v[56:59], v[100:103]
  ds_read_b128 v[28:31], v9 offset:34816
  v_mfma_f32_16x16x32_bf16 v[104:107], v[72:75], v[60:63], v[104:107]
  ds_read_b64_tr_b16 v[44:45], v19 offset:32768
  v_mfma_f32_16x16x32_bf16 v[108:111], v[76:79], v[60:63], v[108:111]
  ds_read_b64_tr_b16 v[46:47], v19 offset:33792
  v_mfma_f32_16x16x32_bf16 v[112:115], v[80:83], v[60:63], v[112:115]
  ds_read_b128 v[32:35], v11 offset:32768
  v_mfma_f32_16x16x32_bf16 v[116:119], v[84:87], v[60:63], v[116:119]
  ds_read_b64_tr_b16 v[48:49], v21 offset:32768
  v_mfma_f32_16x16x32_bf16 v[120:123], v[72:75], v[64:67], v[120:123]
  ds_read_b64_tr_b16 v[50:51], v21 offset:33792
  v_mfma_f32_16x16x32_bf16 v[124:127], v[76:79], v[64:67], v[124:127]
  ds_read_b128 v[36:39], v11 offset:34816
  v_mfma_f32_16x16x32_bf16 v[128:131], v[80:83], v[64:67], v[128:131]
  ds_read_b64_tr_b16 v[52:53], v23 offset:32768
  v_mfma_f32_16x16x32_bf16 v[132:135], v[84:87], v[64:67], v[132:135]
  ds_read_b64_tr_b16 v[54:55], v23 offset:33792
  v_mfma_f32_16x16x32_bf16 v[136:139], v[72:75], v[68:71], v[136:139]
  v_mfma_f32_16x16x32_bf16 v[140:143], v[76:79], v[68:71], v[140:143]
  v_mfma_f32_16x16x32_bf16 v[144:147], v[80:83], v[68:71], v[144:147]
  v_mfma_f32_16x16x32_bf16 v[148:151], v[84:87], v[68:71], v[148:151]
  v_mfma_f32_16x16x32_bf16 v[152:155], v[160:163], v[72:75], v[152:155]
  v_mfma_f32_16x16x32_bf16 v[156:159], v[160:163], v[76:79], v[156:159]
  s_waitcnt lgkmcnt(0)
  v_mfma_f32_16x16x32_bf16 v[88:91], v[40:43], v[24:27], v[88:91]
  ds_read_b128 v[56:59], v13 offset:32768
  v_mfma_f32_16x16x32_bf16 v[92:95], v[44:47], v[24:27], v[92:95]
  ds_read_b64_tr_b16 v[72:73], v17 offset:40960
  v_mfma_f32_16x16x32_bf16 v[96:99], v[48:51], v[24:27], v[96:99]
  ds_read_b64_tr_b16 v[74:75], v17 offset:41984
  v_mfma_f32_16x16x32_bf16 v[100:103], v[52:55], v[24:27], v[100:103]
  ds_read_b128 v[60:63], v13 offset:34816
  v_mfma_f32_16x16x32_bf16 v[104:107], v[40:43], v[28:31], v[104:107]
  ds_read_b64_tr_b16 v[76:77], v19 offset:40960
  v_mfma_f32_16x16x32_bf16 v[108:111], v[44:47], v[28:31], v[108:111]
  ds_read_b64_tr_b16 v[78:79], v19 offset:41984
  v_mfma_f32_16x16x32_bf16 v[112:115], v[48:51], v[28:31], v[112:115]
  ds_read_b128 v[64:67], v15 offset:32768
  v_mfma_f32_16x16x32_bf16 v[116:119], v[52:55], v[28:31], v[116:119]
  ds_read_b64_tr_b16 v[80:81], v21 offset:40960
  v_mfma_f32_16x16x32_bf16 v[120:123], v[40:43], v[32:35], v[120:123]
  ds_read_b64_tr_b16 v[82:83], v21 offset:41984
  v_mfma_f32_16x16x32_bf16 v[124:127], v[44:47], v[32:35], v[124:127]
  ds_read_b128 v[68:71], v15 offset:34816
  v_mfma_f32_16x16x32_bf16 v[128:131], v[48:51], v[32:35], v[128:131]
  ds_read_b64_tr_b16 v[84:85], v23 offset:40960
  v_mfma_f32_16x16x32_bf16 v[132:135], v[52:55], v[32:35], v[132:135]
  ds_read_b64_tr_b16 v[86:87], v23 offset:41984
  v_mfma_f32_16x16x32_bf16 v[136:139], v[40:43], v[36:39], v[136:139]
  v_mfma_f32_16x16x32_bf16 v[140:143], v[44:47], v[36:39], v[140:143]
  v_mfma_f32_16x16x32_bf16 v[144:147], v[48:51], v[36:39], v[144:147]
  v_mfma_f32_16x16x32_bf16 v[148:151], v[52:55], v[36:39], v[148:151]
  v_mfma_f32_16x16x32_bf16 v[152:155], v[160:163], v[40:43], v[152:155]
  v_mfma_f32_16x16x32_bf16 v[156:159], v[160:163], v[44:47], v[156:159]
  s_waitcnt lgkmcnt(0)
  s_barrier
  v_mfma_f32_16x16x32_bf16 v[88:91], v[72:75], v[56:59], v[88:91]
  v_mfma_f32_16x16x32_bf16 v[92:95], v[76:79], v[56:59], v[92:95]
  v_mfma_f32_16x16x32_bf16 v[96:99], v[80:83], v[56:59], v[96:99]
  v_mfma_f32_16x16x32_bf16 v[100:103], v[84:87], v[56:59], v[100:103]
  v_mfma_f32_16x16x32_bf16 v[104:107], v[72:75], v[60:63], v[104:107]
  v_mfma_f32_16x16x32_bf16 v[108:111], v[76:79], v[60:63], v[108:111]
  v_mfma_f32_16x16x32_bf16 v[112:115], v[80:83], v[60:63], v[112:115]
  v_mfma_f32_16x16x32_bf16 v[116:119], v[84:87], v[60:63], v[116:119]
  v_mfma_f32_16x16x32_bf16 v[120:123], v[72:75], v[64:67], v[120:123]
  v_mfma_f32_16x16x32_bf16 v[124:127], v[76:79], v[64:67], v[124:127]
  v_mfma_f32_16x16x32_bf16 v[128:131], v[80:83], v[64:67], v[128:131]
  v_mfma_f32_16x16x32_bf16 v[132:135], v[84:87], v[64:67], v[132:135]
  v_mfma_f32_16x16x32_bf16 v[136:139], v[72:75], v[68:71], v[136:139]
  v_mfma_f32_16x16x32_bf16 v[140:143], v[76:79], v[68:71], v[140:143]
  v_mfma_f32_16x16x32_bf16 v[144:147], v[80:83], v[68:71], v[144:147]
  v_mfma_f32_16x16x32_bf16 v[148:151], v[84:87], v[68:71], v[148:151]
  v_mfma_f32_16x16x32_bf16 v[152:155], v[160:163], v[72:75], v[152:155]
  v_mfma_f32_16x16x32_bf16 v[156:159], v[160:163], v[76:79], v[156:159]
  s_waitcnt vmcnt(0)
  v_pk_add_f32 v[168:169], v[168:169], v[172:173]
  v_pk_add_f32 v[170:171], v[170:171], v[174:175]
  v_pk_add_f32 v[168:169], v[168:169], v[170:171]
  v_mov_b32 v172, v168
  v_mov_b32 v173, v169
  s_nop 1
  v_permlane32_swap_b32 v172, v168
  v_permlane32_swap_b32 v173, v169
  s_nop 1
  v_pk_add_f32 v[168:169], v[168:169], v[172:173]
  v_mul_f32 v168, 0x3b000000, v168
  v_mul_f32 v169, 0x3b000000, v169
  v_fma_f32 v169, -v168, v168, v169
  v_add_f32 v169, 0x3727c5ac, v169
  v_rsq_f32 v169, v169
  s_lshl_b32 s4, s34, 8
  s_lshl_b32 s5, s35, 7
  s_add_u32 s4, s4, s5
  s_add_u32 s4, s4, 0x20000
  v_and_b32 v2, 31, v0
  v_lshl_add_u32 v2, v2, 2, s4
  ds_write_b32 v2, v168
  ds_write_b32 v2, v169 offset:512
  s_lshl_b32 s4, s35, 8
  s_lshl_b32 s5, s34, 7
  s_add_u32 s4, s4, s5
  s_add_u32 s4, s4, 0x20400
  v_and_b32 v36, 15, v0
  v_lshl_add_u32 v36, v36, 2, s4
  ds_write_b32 v36, v152 offset:0
  ds_write_b32 v36, v156 offset:64
  s_waitcnt lgkmcnt(0)
  s_barrier
  s_lshl_b32 s4, s34, 8
  s_add_u32 s4, s4, 0x20000
  s_lshl_b32 s5, s35, 7
  s_xor_b32 s6, s5, 128
  s_add_u32 s5, s5, s4
  s_add_u32 s6, s6, s4
  v_and_b32 v28, 15, v0
  v_lshl_add_u32 v24, v28, 2, s5
  v_lshl_add_u32 v25, v28, 2, s6
  s_lshl_b32 s4, s35, 8
  s_add_u32 s4, s4, 0x20400
  s_lshl_b32 s5, s34, 7
  s_xor_b32 s6, s5, 128
  s_add_u32 s5, s5, s4
  s_add_u32 s6, s6, s4
  v_lshrrev_b32 v28, 4, v0
  v_lshl_add_u32 v26, v28, 4, s5
  v_lshl_add_u32 v27, v28, 4, s6
  ds_read_b32 v28, v24 offset:0
  ds_read_b32 v32, v24 offset:512
  ds_read_b32 v29, v24 offset:64
  ds_read_b32 v33, v24 offset:576
  ds_read_b32 v30, v25 offset:0
  ds_read_b32 v34, v25 offset:512
  ds_read_b32 v31, v25 offset:64
  ds_read_b32 v35, v25 offset:576
  ds_read_b128 v[36:39], v26 offset:0
  ds_read_b128 v[40:43], v26 offset:64
  ds_read_b128 v[44:47], v27 offset:0
  ds_read_b128 v[48:51], v27 offset:64
  s_waitcnt lgkmcnt(0)
  v_sub_f32 v52, 0, v28
  v_mul_f32 v53, 0xc0135761, v32
  v_mul_f32 v68, v32, v32
  v_rcp_f32 v55, v32
  v_mul_f32 v68, v68, v53
  v_mul_f32 v54, 0x3d372713, v68
  v_sub_f32 v56, 0, v29
  v_mul_f32 v57, 0xc0135761, v33
  v_mul_f32 v69, v33, v33
  v_rcp_f32 v59, v33
  v_mul_f32 v69, v69, v57
  v_mul_f32 v58, 0x3d372713, v69
  v_sub_f32 v60, 0, v30
  v_mul_f32 v61, 0xc0135761, v34
  v_mul_f32 v70, v34, v34
  v_rcp_f32 v63, v34
  v_mul_f32 v70, v70, v61
  v_mul_f32 v62, 0x3d372713, v70
  v_sub_f32 v64, 0, v31
  v_mul_f32 v65, 0xc0135761, v35
  v_mul_f32 v71, v35, v35
  v_rcp_f32 v67, v35
  v_mul_f32 v71, v71, v65
  v_mul_f32 v66, 0x3d372713, v71
  v_pk_fma_f32 v[88:89], v[36:37], v[52:53], v[88:89] op_sel_hi:[1,0,1]
  v_pk_fma_f32 v[90:91], v[38:39], v[52:53], v[90:91] op_sel_hi:[1,0,1]
  v_pk_fma_f32 v[92:93], v[40:41], v[52:53], v[92:93] op_sel_hi:[1,0,1]
  v_pk_fma_f32 v[94:95], v[42:43], v[52:53], v[94:95] op_sel_hi:[1,0,1]
  v_pk_mul_f32 v[68:69], v[88:89], v[88:89]
  v_pk_mul_f32 v[70:71], v[90:91], v[90:91]
  v_pk_mul_f32 v[72:73], v[92:93], v[92:93]
  v_pk_mul_f32 v[74:75], v[94:95], v[94:95]
  v_pk_fma_f32 v[68:69], v[68:69], v[54:55], v[52:53] op_sel:[0,0,1] op_sel_hi:[1,0,1]
  v_pk_fma_f32 v[70:71], v[70:71], v[54:55], v[52:53] op_sel:[0,0,1] op_sel_hi:[1,0,1]
  v_pk_fma_f32 v[72:73], v[72:73], v[54:55], v[52:53] op_sel:[0,0,1] op_sel_hi:[1,0,1]
  v_pk_fma_f32 v[74:75], v[74:75], v[54:55], v[52:53] op_sel:[0,0,1] op_sel_hi:[1,0,1]
  v_pk_mul_f32 v[68:69], v[88:89], v[68:69]
  v_pk_mul_f32 v[70:71], v[90:91], v[70:71]
  v_pk_mul_f32 v[72:73], v[92:93], v[72:73]
  v_pk_mul_f32 v[74:75], v[94:95], v[74:75]
  v_exp_f32 v68, v68
  v_exp_f32 v69, v69
  v_exp_f32 v70, v70
  v_exp_f32 v71, v71
  v_exp_f32 v72, v72
  v_exp_f32 v73, v73
  v_exp_f32 v74, v74
  v_exp_f32 v75, v75
  v_pk_fma_f32 v[68:69], v[68:69], v[54:55], v[54:55] op_sel:[0,1,1] op_sel_hi:[1,1,1]
  v_pk_fma_f32 v[70:71], v[70:71], v[54:55], v[54:55] op_sel:[0,1,1] op_sel_hi:[1,1,1]
  v_pk_fma_f32 v[72:73], v[72:73], v[54:55], v[54:55] op_sel:[0,1,1] op_sel_hi:[1,1,1]
  v_pk_fma_f32 v[74:75], v[74:75], v[54:55], v[54:55] op_sel:[0,1,1] op_sel_hi:[1,1,1]
  v_rcp_f32 v68, v68
  v_rcp_f32 v69, v69
  v_rcp_f32 v70, v70
  v_rcp_f32 v71, v71
  v_rcp_f32 v72, v72
  v_rcp_f32 v73, v73
  v_rcp_f32 v74, v74
  v_rcp_f32 v75, v75
  v_pk_mul_f32 v[68:69], v[88:89], v[68:69]
  v_pk_mul_f32 v[70:71], v[90:91], v[70:71]
  v_pk_mul_f32 v[72:73], v[92:93], v[72:73]
  v_pk_mul_f32 v[74:75], v[94:95], v[74:75]
  v_cvt_pk_bf16_f32 v76, v68, v69
  v_cvt_pk_bf16_f32 v77, v70, v71
  v_cvt_pk_bf16_f32 v78, v72, v73
  v_cvt_pk_bf16_f32 v79, v74, v75
  ds_write_b64 v202, v[76:77] offset:0
  ds_write_b64 v203, v[78:79] offset:0
  v_pk_fma_f32 v[96:97], v[44:45], v[52:53], v[96:97] op_sel_hi:[1,0,1]
  v_pk_fma_f32 v[98:99], v[46:47], v[52:53], v[98:99] op_sel_hi:[1,0,1]
  v_pk_fma_f32 v[100:101], v[48:49], v[52:53], v[100:101] op_sel_hi:[1,0,1]
  v_pk_fma_f32 v[102:103], v[50:51], v[52:53], v[102:103] op_sel_hi:[1,0,1]
  v_pk_mul_f32 v[68:69], v[96:97], v[96:97]
  v_pk_mul_f32 v[70:71], v[98:99], v[98:99]
  v_pk_mul_f32 v[72:73], v[100:101], v[100:101]
  v_pk_mul_f32 v[74:75], v[102:103], v[102:103]
  v_pk_fma_f32 v[68:69], v[68:69], v[54:55], v[52:53] op_sel:[0,0,1] op_sel_hi:[1,0,1]
  v_pk_fma_f32 v[70:71], v[70:71], v[54:55], v[52:53] op_sel:[0,0,1] op_sel_hi:[1,0,1]
  v_pk_fma_f32 v[72:73], v[72:73], v[54:55], v[52:53] op_sel:[0,0,1] op_sel_hi:[1,0,1]
  v_pk_fma_f32 v[74:75], v[74:75], v[54:55], v[52:53] op_sel:[0,0,1] op_sel_hi:[1,0,1]
  v_pk_mul_f32 v[68:69], v[96:97], v[68:69]
  v_pk_mul_f32 v[70:71], v[98:99], v[70:71]
  v_pk_mul_f32 v[72:73], v[100:101], v[72:73]
  v_pk_mul_f32 v[74:75], v[102:103], v[74:75]
  v_exp_f32 v68, v68
  v_exp_f32 v69, v69
  v_exp_f32 v70, v70
  v_exp_f32 v71, v71
  v_exp_f32 v72, v72
  v_exp_f32 v73, v73
  v_exp_f32 v74, v74
  v_exp_f32 v75, v75
  v_pk_fma_f32 v[68:69], v[68:69], v[54:55], v[54:55] op_sel:[0,1,1] op_sel_hi:[1,1,1]
  v_pk_fma_f32 v[70:71], v[70:71], v[54:55], v[54:55] op_sel:[0,1,1] op_sel_hi:[1,1,1]
  v_pk_fma_f32 v[72:73], v[72:73], v[54:55], v[54:55] op_sel:[0,1,1] op_sel_hi:[1,1,1]
  v_pk_fma_f32 v[74:75], v[74:75], v[54:55], v[54:55] op_sel:[0,1,1] op_sel_hi:[1,1,1]
  v_rcp_f32 v68, v68
  v_rcp_f32 v69, v69
  v_rcp_f32 v70, v70
  v_rcp_f32 v71, v71
  v_rcp_f32 v72, v72
  v_rcp_f32 v73, v73
  v_rcp_f32 v74, v74
  v_rcp_f32 v75, v75
  v_pk_mul_f32 v[68:69], v[96:97], v[68:69]
  v_pk_mul_f32 v[70:71], v[98:99], v[70:71]
  v_pk_mul_f32 v[72:73], v[100:101], v[72:73]
  v_pk_mul_f32 v[74:75], v[102:103], v[74:75]
  v_cvt_pk_bf16_f32 v80, v68, v69
  v_cvt_pk_bf16_f32 v81, v70, v71
  v_cvt_pk_bf16_f32 v82, v72, v73
  v_cvt_pk_bf16_f32 v83, v74, v75
  ds_write_b64 v204, v[80:81] offset:0
  ds_write_b64 v205, v[82:83] offset:0
  ds_read_b128 v[184:187], v206 offset:0
  ds_read_b128 v[188:191], v206 offset:1024
  v_pk_fma_f32 v[104:105], v[36:37], v[56:57], v[104:105] op_sel_hi:[1,0,1]
  v_pk_fma_f32 v[106:107], v[38:39], v[56:57], v[106:107] op_sel_hi:[1,0,1]
  v_pk_fma_f32 v[108:109], v[40:41], v[56:57], v[108:109] op_sel_hi:[1,0,1]
  v_pk_fma_f32 v[110:111], v[42:43], v[56:57], v[110:111] op_sel_hi:[1,0,1]
  v_pk_mul_f32 v[68:69], v[104:105], v[104:105]
  v_pk_mul_f32 v[70:71], v[106:107], v[106:107]
  v_pk_mul_f32 v[72:73], v[108:109], v[108:109]
  v_pk_mul_f32 v[74:75], v[110:111], v[110:111]
  v_pk_fma_f32 v[68:69], v[68:69], v[58:59], v[56:57] op_sel:[0,0,1] op_sel_hi:[1,0,1]
  v_pk_fma_f32 v[70:71], v[70:71], v[58:59], v[56:57] op_sel:[0,0,1] op_sel_hi:[1,0,1]
  v_pk_fma_f32 v[72:73], v[72:73], v[58:59], v[56:57] op_sel:[0,0,1] op_sel_hi:[1,0,1]
  v_pk_fma_f32 v[74:75], v[74:75], v[58:59], v[56:57] op_sel:[0,0,1] op_sel_hi:[1,0,1]
  s_waitcnt lgkmcnt(0)
  buffer_store_dwordx4 v[184:187], v164, s[28:31], s72 offen sc1
  buffer_store_dwordx4 v[188:191], v164, s[28:31], s73 offen sc1
  v_pk_mul_f32 v[68:69], v[104:105], v[68:69]
  v_pk_mul_f32 v[70:71], v[106:107], v[70:71]
  v_pk_mul_f32 v[72:73], v[108:109], v[72:73]
  v_pk_mul_f32 v[74:75], v[110:111], v[74:75]
  v_exp_f32 v68, v68
  v_exp_f32 v69, v69
  v_exp_f32 v70, v70
  v_exp_f32 v71, v71
  v_exp_f32 v72, v72
  v_exp_f32 v73, v73
  v_exp_f32 v74, v74
  v_exp_f32 v75, v75
  v_pk_fma_f32 v[68:69], v[68:69], v[58:59], v[58:59] op_sel:[0,1,1] op_sel_hi:[1,1,1]
  v_pk_fma_f32 v[70:71], v[70:71], v[58:59], v[58:59] op_sel:[0,1,1] op_sel_hi:[1,1,1]
  v_pk_fma_f32 v[72:73], v[72:73], v[58:59], v[58:59] op_sel:[0,1,1] op_sel_hi:[1,1,1]
  v_pk_fma_f32 v[74:75], v[74:75], v[58:59], v[58:59] op_sel:[0,1,1] op_sel_hi:[1,1,1]
  v_rcp_f32 v68, v68
  v_rcp_f32 v69, v69
  v_rcp_f32 v70, v70
  v_rcp_f32 v71, v71
  v_rcp_f32 v72, v72
  v_rcp_f32 v73, v73
  v_rcp_f32 v74, v74
  v_rcp_f32 v75, v75
  v_pk_mul_f32 v[68:69], v[104:105], v[68:69]
  v_pk_mul_f32 v[70:71], v[106:107], v[70:71]
  v_pk_mul_f32 v[72:73], v[108:109], v[72:73]
  v_pk_mul_f32 v[74:75], v[110:111], v[74:75]
  v_cvt_pk_bf16_f32 v76, v68, v69
  v_cvt_pk_bf16_f32 v77, v70, v71
  v_cvt_pk_bf16_f32 v78, v72, v73
  v_cvt_pk_bf16_f32 v79, v74, v75
  ds_write_b64 v202, v[76:77] offset:2048
  ds_write_b64 v203, v[78:79] offset:2048
  v_pk_fma_f32 v[112:113], v[44:45], v[56:57], v[112:113] op_sel_hi:[1,0,1]
  v_pk_fma_f32 v[114:115], v[46:47], v[56:57], v[114:115] op_sel_hi:[1,0,1]
  v_pk_fma_f32 v[116:117], v[48:49], v[56:57], v[116:117] op_sel_hi:[1,0,1]
  v_pk_fma_f32 v[118:119], v[50:51], v[56:57], v[118:119] op_sel_hi:[1,0,1]
  v_pk_mul_f32 v[68:69], v[112:113], v[112:113]
  v_pk_mul_f32 v[70:71], v[114:115], v[114:115]
  v_pk_mul_f32 v[72:73], v[116:117], v[116:117]
  v_pk_mul_f32 v[74:75], v[118:119], v[118:119]
  v_pk_fma_f32 v[68:69], v[68:69], v[58:59], v[56:57] op_sel:[0,0,1] op_sel_hi:[1,0,1]
  v_pk_fma_f32 v[70:71], v[70:71], v[58:59], v[56:57] op_sel:[0,0,1] op_sel_hi:[1,0,1]
  v_pk_fma_f32 v[72:73], v[72:73], v[58:59], v[56:57] op_sel:[0,0,1] op_sel_hi:[1,0,1]
  v_pk_fma_f32 v[74:75], v[74:75], v[58:59], v[56:57] op_sel:[0,0,1] op_sel_hi:[1,0,1]
  v_pk_mul_f32 v[68:69], v[112:113], v[68:69]
  v_pk_mul_f32 v[70:71], v[114:115], v[70:71]
  v_pk_mul_f32 v[72:73], v[116:117], v[72:73]
  v_pk_mul_f32 v[74:75], v[118:119], v[74:75]
  v_exp_f32 v68, v68
  v_exp_f32 v69, v69
  v_exp_f32 v70, v70
  v_exp_f32 v71, v71
  v_exp_f32 v72, v72
  v_exp_f32 v73, v73
  v_exp_f32 v74, v74
  v_exp_f32 v75, v75
  v_pk_fma_f32 v[68:69], v[68:69], v[58:59], v[58:59] op_sel:[0,1,1] op_sel_hi:[1,1,1]
  v_pk_fma_f32 v[70:71], v[70:71], v[58:59], v[58:59] op_sel:[0,1,1] op_sel_hi:[1,1,1]
  v_pk_fma_f32 v[72:73], v[72:73], v[58:59], v[58:59] op_sel:[0,1,1] op_sel_hi:[1,1,1]
  v_pk_fma_f32 v[74:75], v[74:75], v[58:59], v[58:59] op_sel:[0,1,1] op_sel_hi:[1,1,1]
  v_rcp_f32 v68, v68
  v_rcp_f32 v69, v69
  v_rcp_f32 v70, v70
  v_rcp_f32 v71, v71
  v_rcp_f32 v72, v72
  v_rcp_f32 v73, v73
  v_rcp_f32 v74, v74
  v_rcp_f32 v75, v75
  v_pk_mul_f32 v[68:69], v[112:113], v[68:69]
  v_pk_mul_f32 v[70:71], v[114:115], v[70:71]
  v_pk_mul_f32 v[72:73], v[116:117], v[72:73]
  v_pk_mul_f32 v[74:75], v[118:119], v[74:75]
  v_cvt_pk_bf16_f32 v80, v68, v69
  v_cvt_pk_bf16_f32 v81, v70, v71
  v_cvt_pk_bf16_f32 v82, v72, v73
  v_cvt_pk_bf16_f32 v83, v74, v75
  ds_write_b64 v204, v[80:81] offset:2048
  ds_write_b64 v205, v[82:83] offset:2048
  ds_read_b128 v[192:195], v206 offset:2048
  ds_read_b128 v[196:199], v206 offset:3072
  v_pk_fma_f32 v[120:121], v[36:37], v[60:61], v[120:121] op_sel_hi:[1,0,1]
  v_pk_fma_f32 v[122:123], v[38:39], v[60:61], v[122:123] op_sel_hi:[1,0,1]
  v_pk_fma_f32 v[124:125], v[40:41], v[60:61], v[124:125] op_sel_hi:[1,0,1]
  v_pk_fma_f32 v[126:127], v[42:43], v[60:61], v[126:127] op_sel_hi:[1,0,1]
  v_pk_mul_f32 v[68:69], v[120:121], v[120:121]
  v_pk_mul_f32 v[70:71], v[122:123], v[122:123]
  v_pk_mul_f32 v[72:73], v[124:125], v[124:125]
  v_pk_mul_f32 v[74:75], v[126:127], v[126:127]
  v_pk_fma_f32 v[68:69], v[68:69], v[62:63], v[60:61] op_sel:[0,0,1] op_sel_hi:[1,0,1]
  v_pk_fma_f32 v[70:71], v[70:71], v[62:63], v[60:61] op_sel:[0,0,1] op_sel_hi:[1,0,1]
  v_pk_fma_f32 v[72:73], v[72:73], v[62:63], v[60:61] op_sel:[0,0,1] op_sel_hi:[1,0,1]
  v_pk_fma_f32 v[74:75], v[74:75], v[62:63], v[60:61] op_sel:[0,0,1] op_sel_hi:[1,0,1]
  s_waitcnt lgkmcnt(0)
  buffer_store_dwordx4 v[192:195], v165, s[28:31], s72 offen sc1
  buffer_store_dwordx4 v[196:199], v165, s[28:31], s73 offen sc1
  v_pk_mul_f32 v[68:69], v[120:121], v[68:69]
  v_pk_mul_f32 v[70:71], v[122:123], v[70:71]
  v_pk_mul_f32 v[72:73], v[124:125], v[72:73]
  v_pk_mul_f32 v[74:75], v[126:127], v[74:75]
  v_exp_f32 v68, v68
  v_exp_f32 v69, v69
  v_exp_f32 v70, v70
  v_exp_f32 v71, v71
  v_exp_f32 v72, v72
  v_exp_f32 v73, v73
  v_exp_f32 v74, v74
  v_exp_f32 v75, v75
  v_pk_fma_f32 v[68:69], v[68:69], v[62:63], v[62:63] op_sel:[0,1,1] op_sel_hi:[1,1,1]
  v_pk_fma_f32 v[70:71], v[70:71], v[62:63], v[62:63] op_sel:[0,1,1] op_sel_hi:[1,1,1]
  v_pk_fma_f32 v[72:73], v[72:73], v[62:63], v[62:63] op_sel:[0,1,1] op_sel_hi:[1,1,1]
  v_pk_fma_f32 v[74:75], v[74:75], v[62:63], v[62:63] op_sel:[0,1,1] op_sel_hi:[1,1,1]
  v_rcp_f32 v68, v68
  v_rcp_f32 v69, v69
  v_rcp_f32 v70, v70
  v_rcp_f32 v71, v71
  v_rcp_f32 v72, v72
  v_rcp_f32 v73, v73
  v_rcp_f32 v74, v74
  v_rcp_f32 v75, v75
  v_pk_mul_f32 v[68:69], v[120:121], v[68:69]
  v_pk_mul_f32 v[70:71], v[122:123], v[70:71]
  v_pk_mul_f32 v[72:73], v[124:125], v[72:73]
  v_pk_mul_f32 v[74:75], v[126:127], v[74:75]
  v_cvt_pk_bf16_f32 v76, v68, v69
  v_cvt_pk_bf16_f32 v77, v70, v71
  v_cvt_pk_bf16_f32 v78, v72, v73
  v_cvt_pk_bf16_f32 v79, v74, v75
  ds_write_b64 v202, v[76:77] offset:0
  ds_write_b64 v203, v[78:79] offset:0
  v_pk_fma_f32 v[128:129], v[44:45], v[60:61], v[128:129] op_sel_hi:[1,0,1]
  v_pk_fma_f32 v[130:131], v[46:47], v[60:61], v[130:131] op_sel_hi:[1,0,1]
  v_pk_fma_f32 v[132:133], v[48:49], v[60:61], v[132:133] op_sel_hi:[1,0,1]
  v_pk_fma_f32 v[134:135], v[50:51], v[60:61], v[134:135] op_sel_hi:[1,0,1]
  v_pk_mul_f32 v[68:69], v[128:129], v[128:129]
  v_pk_mul_f32 v[70:71], v[130:131], v[130:131]
  v_pk_mul_f32 v[72:73], v[132:133], v[132:133]
  v_pk_mul_f32 v[74:75], v[134:135], v[134:135]
  v_pk_fma_f32 v[68:69], v[68:69], v[62:63], v[60:61] op_sel:[0,0,1] op_sel_hi:[1,0,1]
  v_pk_fma_f32 v[70:71], v[70:71], v[62:63], v[60:61] op_sel:[0,0,1] op_sel_hi:[1,0,1]
  v_pk_fma_f32 v[72:73], v[72:73], v[62:63], v[60:61] op_sel:[0,0,1] op_sel_hi:[1,0,1]
  v_pk_fma_f32 v[74:75], v[74:75], v[62:63], v[60:61] op_sel:[0,0,1] op_sel_hi:[1,0,1]
  v_pk_mul_f32 v[68:69], v[128:129], v[68:69]
  v_pk_mul_f32 v[70:71], v[130:131], v[70:71]
  v_pk_mul_f32 v[72:73], v[132:133], v[72:73]
  v_pk_mul_f32 v[74:75], v[134:135], v[74:75]
  v_exp_f32 v68, v68
  v_exp_f32 v69, v69
  v_exp_f32 v70, v70
  v_exp_f32 v71, v71
  v_exp_f32 v72, v72
  v_exp_f32 v73, v73
  v_exp_f32 v74, v74
  v_exp_f32 v75, v75
  v_pk_fma_f32 v[68:69], v[68:69], v[62:63], v[62:63] op_sel:[0,1,1] op_sel_hi:[1,1,1]
  v_pk_fma_f32 v[70:71], v[70:71], v[62:63], v[62:63] op_sel:[0,1,1] op_sel_hi:[1,1,1]
  v_pk_fma_f32 v[72:73], v[72:73], v[62:63], v[62:63] op_sel:[0,1,1] op_sel_hi:[1,1,1]
  v_pk_fma_f32 v[74:75], v[74:75], v[62:63], v[62:63] op_sel:[0,1,1] op_sel_hi:[1,1,1]
  v_rcp_f32 v68, v68
  v_rcp_f32 v69, v69
  v_rcp_f32 v70, v70
  v_rcp_f32 v71, v71
  v_rcp_f32 v72, v72
  v_rcp_f32 v73, v73
  v_rcp_f32 v74, v74
  v_rcp_f32 v75, v75
  v_pk_mul_f32 v[68:69], v[128:129], v[68:69]
  v_pk_mul_f32 v[70:71], v[130:131], v[70:71]
  v_pk_mul_f32 v[72:73], v[132:133], v[72:73]
  v_pk_mul_f32 v[74:75], v[134:135], v[74:75]
  v_cvt_pk_bf16_f32 v80, v68, v69
  v_cvt_pk_bf16_f32 v81, v70, v71
  v_cvt_pk_bf16_f32 v82, v72, v73
  v_cvt_pk_bf16_f32 v83, v74, v75
  ds_write_b64 v204, v[80:81] offset:0
  ds_write_b64 v205, v[82:83] offset:0
  ds_read_b128 v[184:187], v206 offset:0
  ds_read_b128 v[188:191], v206 offset:1024
  v_pk_fma_f32 v[136:137], v[36:37], v[64:65], v[136:137] op_sel_hi:[1,0,1]
  v_pk_fma_f32 v[138:139], v[38:39], v[64:65], v[138:139] op_sel_hi:[1,0,1]
  v_pk_fma_f32 v[140:141], v[40:41], v[64:65], v[140:141] op_sel_hi:[1,0,1]
  v_pk_fma_f32 v[142:143], v[42:43], v[64:65], v[142:143] op_sel_hi:[1,0,1]
  v_pk_mul_f32 v[68:69], v[136:137], v[136:137]
  v_pk_mul_f32 v[70:71], v[138:139], v[138:139]
  v_pk_mul_f32 v[72:73], v[140:141], v[140:141]
  v_pk_mul_f32 v[74:75], v[142:143], v[142:143]
  v_pk_fma_f32 v[68:69], v[68:69], v[66:67], v[64:65] op_sel:[0,0,1] op_sel_hi:[1,0,1]
  v_pk_fma_f32 v[70:71], v[70:71], v[66:67], v[64:65] op_sel:[0,0,1] op_sel_hi:[1,0,1]
  v_pk_fma_f32 v[72:73], v[72:73], v[66:67], v[64:65] op_sel:[0,0,1] op_sel_hi:[1,0,1]
  v_pk_fma_f32 v[74:75], v[74:75], v[66:67], v[64:65] op_sel:[0,0,1] op_sel_hi:[1,0,1]
  s_waitcnt lgkmcnt(0)
  buffer_store_dwordx4 v[184:187], v166, s[28:31], s72 offen sc1
  buffer_store_dwordx4 v[188:191], v166, s[28:31], s73 offen sc1
  v_pk_mul_f32 v[68:69], v[136:137], v[68:69]
  v_pk_mul_f32 v[70:71], v[138:139], v[70:71]
  v_pk_mul_f32 v[72:73], v[140:141], v[72:73]
  v_pk_mul_f32 v[74:75], v[142:143], v[74:75]
  v_exp_f32 v68, v68
  v_exp_f32 v69, v69
  v_exp_f32 v70, v70
  v_exp_f32 v71, v71
  v_exp_f32 v72, v72
  v_exp_f32 v73, v73
  v_exp_f32 v74, v74
  v_exp_f32 v75, v75
  v_pk_fma_f32 v[68:69], v[68:69], v[66:67], v[66:67] op_sel:[0,1,1] op_sel_hi:[1,1,1]
  v_pk_fma_f32 v[70:71], v[70:71], v[66:67], v[66:67] op_sel:[0,1,1] op_sel_hi:[1,1,1]
  v_pk_fma_f32 v[72:73], v[72:73], v[66:67], v[66:67] op_sel:[0,1,1] op_sel_hi:[1,1,1]
  v_pk_fma_f32 v[74:75], v[74:75], v[66:67], v[66:67] op_sel:[0,1,1] op_sel_hi:[1,1,1]
  v_rcp_f32 v68, v68
  v_rcp_f32 v69, v69
  v_rcp_f32 v70, v70
  v_rcp_f32 v71, v71
  v_rcp_f32 v72, v72
  v_rcp_f32 v73, v73
  v_rcp_f32 v74, v74
  v_rcp_f32 v75, v75
  v_pk_mul_f32 v[68:69], v[136:137], v[68:69]
  v_pk_mul_f32 v[70:71], v[138:139], v[70:71]
  v_pk_mul_f32 v[72:73], v[140:141], v[72:73]
  v_pk_mul_f32 v[74:75], v[142:143], v[74:75]
  v_cvt_pk_bf16_f32 v76, v68, v69
  v_cvt_pk_bf16_f32 v77, v70, v71
  v_cvt_pk_bf16_f32 v78, v72, v73
  v_cvt_pk_bf16_f32 v79, v74, v75
  ds_write_b64 v202, v[76:77] offset:2048
  ds_write_b64 v203, v[78:79] offset:2048
  v_pk_fma_f32 v[144:145], v[44:45], v[64:65], v[144:145] op_sel_hi:[1,0,1]
  v_pk_fma_f32 v[146:147], v[46:47], v[64:65], v[146:147] op_sel_hi:[1,0,1]
  v_pk_fma_f32 v[148:149], v[48:49], v[64:65], v[148:149] op_sel_hi:[1,0,1]
  v_pk_fma_f32 v[150:151], v[50:51], v[64:65], v[150:151] op_sel_hi:[1,0,1]
  v_pk_mul_f32 v[68:69], v[144:145], v[144:145]
  v_pk_mul_f32 v[70:71], v[146:147], v[146:147]
  v_pk_mul_f32 v[72:73], v[148:149], v[148:149]
  v_pk_mul_f32 v[74:75], v[150:151], v[150:151]
  v_pk_fma_f32 v[68:69], v[68:69], v[66:67], v[64:65] op_sel:[0,0,1] op_sel_hi:[1,0,1]
  v_pk_fma_f32 v[70:71], v[70:71], v[66:67], v[64:65] op_sel:[0,0,1] op_sel_hi:[1,0,1]
  v_pk_fma_f32 v[72:73], v[72:73], v[66:67], v[64:65] op_sel:[0,0,1] op_sel_hi:[1,0,1]
  v_pk_fma_f32 v[74:75], v[74:75], v[66:67], v[64:65] op_sel:[0,0,1] op_sel_hi:[1,0,1]
  v_pk_mul_f32 v[68:69], v[144:145], v[68:69]
  v_pk_mul_f32 v[70:71], v[146:147], v[70:71]
  v_pk_mul_f32 v[72:73], v[148:149], v[72:73]
  v_pk_mul_f32 v[74:75], v[150:151], v[74:75]
  v_exp_f32 v68, v68
  v_exp_f32 v69, v69
  v_exp_f32 v70, v70
  v_exp_f32 v71, v71
  v_exp_f32 v72, v72
  v_exp_f32 v73, v73
  v_exp_f32 v74, v74
  v_exp_f32 v75, v75
  v_pk_fma_f32 v[68:69], v[68:69], v[66:67], v[66:67] op_sel:[0,1,1] op_sel_hi:[1,1,1]
  v_pk_fma_f32 v[70:71], v[70:71], v[66:67], v[66:67] op_sel:[0,1,1] op_sel_hi:[1,1,1]
  v_pk_fma_f32 v[72:73], v[72:73], v[66:67], v[66:67] op_sel:[0,1,1] op_sel_hi:[1,1,1]
  v_pk_fma_f32 v[74:75], v[74:75], v[66:67], v[66:67] op_sel:[0,1,1] op_sel_hi:[1,1,1]
  v_rcp_f32 v68, v68
  v_rcp_f32 v69, v69
  v_rcp_f32 v70, v70
  v_rcp_f32 v71, v71
  v_rcp_f32 v72, v72
  v_rcp_f32 v73, v73
  v_rcp_f32 v74, v74
  v_rcp_f32 v75, v75
  v_pk_mul_f32 v[68:69], v[144:145], v[68:69]
  v_pk_mul_f32 v[70:71], v[146:147], v[70:71]
  v_pk_mul_f32 v[72:73], v[148:149], v[72:73]
  v_pk_mul_f32 v[74:75], v[150:151], v[74:75]
  v_cvt_pk_bf16_f32 v80, v68, v69
  v_cvt_pk_bf16_f32 v81, v70, v71
  v_cvt_pk_bf16_f32 v82, v72, v73
  v_cvt_pk_bf16_f32 v83, v74, v75
  ds_write_b64 v204, v[80:81] offset:2048
  ds_write_b64 v205, v[82:83] offset:2048
  ds_read_b128 v[192:195], v206 offset:2048
  ds_read_b128 v[196:199], v206 offset:3072
  s_waitcnt lgkmcnt(0)
  buffer_store_dwordx4 v[192:195], v167, s[28:31], s72 offen sc1
  buffer_store_dwordx4 v[196:199], v167, s[28:31], s73 offen sc1
  s_waitcnt vmcnt(0)
  s_mov_b64 exec, 1
  v_mov_b32 v2, 0x22808
  v_mov_b32 v3, 1
  ds_add_rtn_u32 v4, v2, v3
  s_waitcnt lgkmcnt(0)
  v_readfirstlane_b32 s4, v4
  s_mov_b64 exec, -1
  s_cmp_eq_u32 s4, 3
  s_cbranch_scc0 L_cd_3045
  s_mov_b32 s28, s56
  s_mov_b32 s29, s57
  s_mov_b32 s30, 0x5800
  s_mov_b32 s31, 0x00020000
  s_add_u32 s4, s32, 40
  s_lshl_b32 s4, s4, 8
  v_mov_b32 v2, s4
  v_mov_b32 v3, 1
  s_mov_b64 exec, 1
  buffer_atomic_add v3, v2, s[28:31], 0 offen
  s_mov_b64 exec, -1
L_cd_3045:
c4_start:
  s_and_b32 s4, s2, 7
  s_lshr_b32 s5, s2, 3
  s_lshl_b32 s6, s4, 2
  s_and_b32 s7, s5, 3
  s_add_u32 s32, s6, s7
  s_lshr_b32 s33, s5, 2
  s_mov_b32 s58, 0
  s_lshl_b32 s4, s32, 6
  s_lshl_b32 s5, s34, 5
  s_add_u32 s4, s4, s5
  v_and_b32 v100, 15, v0
  v_add_u32 v100, s4, v100
  v_bfe_u32 v1, v0, 4, 1
  v_lshlrev_b32 v1, 5, v1
  v_lshrrev_b32 v101, 5, v0
  v_lshl_add_u32 v101, v101, 4, v1
  v_lshl_add_u32 v100, v100, 10, v101
  v_add_u32 v101, 16384, v100
  s_lshl_b32 s4, s33, 7
  s_lshl_b32 s5, s35, 6
  s_add_u32 s72, s4, s5
  s_mov_b32 s24, s52
  s_mov_b32 s25, s53
  s_mov_b32 s26, 0x200000
  s_mov_b32 s27, 0x00020000
  s_lshl_b32 s5, s35, 2
  v_lshrrev_b32 v2, 5, v0
  v_add_u32 v2, s5, v2
  v_and_b32 v3, 7, v0
  v_xor_b32 v2, v2, v3
  v_lshlrev_b32 v2, 4, v2
  v_and_b32 v3, 15, v0
  v_lshl_add_u32 v2, v3, 7, v2
  v_bfe_u32 v3, v0, 4, 1
  v_lshl_add_u32 v2, v3, 3, v2
  s_lshl_b32 s4, s34, 12
  s_add_u32 s4, s4, 0x22900
  v_add_u32 v102, s4, v2
  v_xor_b32 v103, 32, v102
  v_and_b32 v2, 15, v0
  v_lshrrev_b32 v3, 4, v0
  v_xor_b32 v4, v3, v2
  v_lshlrev_b32 v4, 4, v4
  v_lshl_add_u32 v4, v2, 8, v4
  s_lshl_b32 s62, s34, 13
  v_add_u32 v8, s62, v4
  v_xor_b32 v10, 64, v8
  v_xor_b32 v12, 128, v8
  v_xor_b32 v14, 192, v8
  v_add_u32 v9, 0x10000, v8
  v_add_u32 v11, 0x10000, v10
  v_add_u32 v13, 0x10000, v12
  v_add_u32 v15, 0x10000, v14
  v_bfe_u32 v4, v0, 2, 2
  v_lshl_add_u32 v7, v3, 3, v4
  v_lshlrev_b32 v7, 7, v7
  v_and_b32 v5, 3, v0
  v_lshl_add_u32 v7, v5, 3, v7
  v_add_u32 v7, 0x4000, v7
  v_lshrrev_b32 v4, 1, v4
  v_and_b32 v6, 1, v3
  v_lshl_or_b32 v6, v6, 1, v4
  s_lshl_b32 s62, s35, 1
  v_xor_b32 v5, s62, v6
  v_lshl_add_u32 v16, v5, 5, v7
  v_xor_b32 v18, 32, v16
  v_add_u32 v17, 0x10000, v16
  v_add_u32 v19, 0x10000, v18
  s_barrier
  ds_read_b128 v[20:23], v8 offset:0
  ds_read_b64_tr_b16 v[52:53], v16 offset:0
  ds_read_b64_tr_b16 v[54:55], v16 offset:512
  ds_read_b128 v[24:27], v8 offset:4096
  ds_read_b64_tr_b16 v[56:57], v18 offset:0
  ds_read_b64_tr_b16 v[58:59], v18 offset:512
  ds_read_b128 v[28:31], v10 offset:0
  ds_read_b64_tr_b16 v[60:61], v16 offset:4096
  ds_read_b64_tr_b16 v[62:63], v16 offset:4608
  ds_read_b128 v[32:35], v10 offset:4096
  ds_read_b64_tr_b16 v[64:65], v18 offset:4096
  ds_read_b64_tr_b16 v[66:67], v18 offset:4608
  s_waitcnt lgkmcnt(0)
  v_mfma_f32_16x16x32_bf16 v[84:87], v[52:55], v[20:23], 0
  ds_read_b128 v[36:39], v12 offset:0
  ds_read_b64_tr_b16 v[68:69], v16 offset:8192
  v_mfma_f32_16x16x32_bf16 v[88:91], v[56:59], v[20:23], 0
  ds_read_b64_tr_b16 v[70:71], v16 offset:8704
  ds_read_b128 v[40:43], v12 offset:4096
  v_mfma_f32_16x16x32_bf16 v[92:95], v[52:55], v[24:27], 0
  ds_read_b64_tr_b16 v[72:73], v18 offset:8192
  ds_read_b64_tr_b16 v[74:75], v18 offset:8704
  v_mfma_f32_16x16x32_bf16 v[96:99], v[56:59], v[24:27], 0
  ds_read_b128 v[44:47], v14 offset:0
  ds_read_b64_tr_b16 v[76:77], v16 offset:12288
  v_mfma_f32_16x16x32_bf16 v[84:87], v[60:63], v[28:31], v[84:87]
  ds_read_b64_tr_b16 v[78:79], v16 offset:12800
  ds_read_b128 v[48:51], v14 offset:4096
  v_mfma_f32_16x16x32_bf16 v[88:91], v[64:67], v[28:31], v[88:91]
  ds_read_b64_tr_b16 v[80:81], v18 offset:12288
  ds_read_b64_tr_b16 v[82:83], v18 offset:12800
  v_mfma_f32_16x16x32_bf16 v[92:95], v[60:63], v[32:35], v[92:95]
  v_mfma_f32_16x16x32_bf16 v[96:99], v[64:67], v[32:35], v[96:99]
  s_waitcnt lgkmcnt(0)
  s_barrier
  v_mfma_f32_16x16x32_bf16 v[84:87], v[68:71], v[36:39], v[84:87]
  ds_read_b128 v[20:23], v8 offset:32768
  ds_read_b64_tr_b16 v[52:53], v16 offset:32768
  v_mfma_f32_16x16x32_bf16 v[88:91], v[72:75], v[36:39], v[88:91]
  ds_read_b64_tr_b16 v[54:55], v16 offset:33280
  ds_read_b128 v[24:27], v8 offset:36864
  v_mfma_f32_16x16x32_bf16 v[92:95], v[68:71], v[40:43], v[92:95]
  ds_read_b64_tr_b16 v[56:57], v18 offset:32768
  ds_read_b64_tr_b16 v[58:59], v18 offset:33280
  v_mfma_f32_16x16x32_bf16 v[96:99], v[72:75], v[40:43], v[96:99]
  ds_read_b128 v[28:31], v10 offset:32768
  ds_read_b64_tr_b16 v[60:61], v16 offset:36864
  v_mfma_f32_16x16x32_bf16 v[84:87], v[76:79], v[44:47], v[84:87]
  ds_read_b64_tr_b16 v[62:63], v16 offset:37376
  ds_read_b128 v[32:35], v10 offset:36864
  v_mfma_f32_16x16x32_bf16 v[88:91], v[80:83], v[44:47], v[88:91]
  ds_read_b64_tr_b16 v[64:65], v18 offset:36864
  ds_read_b64_tr_b16 v[66:67], v18 offset:37376
  v_mfma_f32_16x16x32_bf16 v[92:95], v[76:79], v[48:51], v[92:95]
  v_mfma_f32_16x16x32_bf16 v[96:99], v[80:83], v[48:51], v[96:99]
  s_waitcnt lgkmcnt(0)
  v_mfma_f32_16x16x32_bf16 v[84:87], v[52:55], v[20:23], v[84:87]
  ds_read_b128 v[36:39], v12 offset:32768
  ds_read_b64_tr_b16 v[68:69], v16 offset:40960
  v_mfma_f32_16x16x32_bf16 v[88:91], v[56:59], v[20:23], v[88:91]
  ds_read_b64_tr_b16 v[70:71], v16 offset:41472
  ds_read_b128 v[40:43], v12 offset:36864
  v_mfma_f32_16x16x32_bf16 v[92:95], v[52:55], v[24:27], v[92:95]
  ds_read_b64_tr_b16 v[72:73], v18 offset:40960
  ds_read_b64_tr_b16 v[74:75], v18 offset:41472
  v_mfma_f32_16x16x32_bf16 v[96:99], v[56:59], v[24:27], v[96:99]
  ds_read_b128 v[44:47], v14 offset:32768
  ds_read_b64_tr_b16 v[76:77], v16 offset:45056
  v_mfma_f32_16x16x32_bf16 v[84:87], v[60:63], v[28:31], v[84:87]
  ds_read_b64_tr_b16 v[78:79], v16 offset:45568
  ds_read_b128 v[48:51], v14 offset:36864
  v_mfma_f32_16x16x32_bf16 v[88:91], v[64:67], v[28:31], v[88:91]
  ds_read_b64_tr_b16 v[80:81], v18 offset:45056
  ds_read_b64_tr_b16 v[82:83], v18 offset:45568
  v_mfma_f32_16x16x32_bf16 v[92:95], v[60:63], v[32:35], v[92:95]
  v_mfma_f32_16x16x32_bf16 v[96:99], v[64:67], v[32:35], v[96:99]
  s_waitcnt lgkmcnt(0)
  s_barrier
  v_mfma_f32_16x16x32_bf16 v[84:87], v[68:71], v[36:39], v[84:87]
  ds_read_b128 v[20:23], v9 offset:0
  ds_read_b64_tr_b16 v[52:53], v17 offset:0
  v_mfma_f32_16x16x32_bf16 v[88:91], v[72:75], v[36:39], v[88:91]
  ds_read_b64_tr_b16 v[54:55], v17 offset:512
  ds_read_b128 v[24:27], v9 offset:4096
  v_mfma_f32_16x16x32_bf16 v[92:95], v[68:71], v[40:43], v[92:95]
  ds_read_b64_tr_b16 v[56:57], v19 offset:0
  ds_read_b64_tr_b16 v[58:59], v19 offset:512
  v_mfma_f32_16x16x32_bf16 v[96:99], v[72:75], v[40:43], v[96:99]
  ds_read_b128 v[28:31], v11 offset:0
  ds_read_b64_tr_b16 v[60:61], v17 offset:4096
  v_mfma_f32_16x16x32_bf16 v[84:87], v[76:79], v[44:47], v[84:87]
  ds_read_b64_tr_b16 v[62:63], v17 offset:4608
  ds_read_b128 v[32:35], v11 offset:4096
  v_mfma_f32_16x16x32_bf16 v[88:91], v[80:83], v[44:47], v[88:91]
  ds_read_b64_tr_b16 v[64:65], v19 offset:4096
  ds_read_b64_tr_b16 v[66:67], v19 offset:4608
  v_mfma_f32_16x16x32_bf16 v[92:95], v[76:79], v[48:51], v[92:95]
  v_mfma_f32_16x16x32_bf16 v[96:99], v[80:83], v[48:51], v[96:99]
  s_waitcnt lgkmcnt(0)
  v_mfma_f32_16x16x32_bf16 v[84:87], v[52:55], v[20:23], v[84:87]
  ds_read_b128 v[36:39], v13 offset:0
  ds_read_b64_tr_b16 v[68:69], v17 offset:8192
  v_mfma_f32_16x16x32_bf16 v[88:91], v[56:59], v[20:23], v[88:91]
  ds_read_b64_tr_b16 v[70:71], v17 offset:8704
  ds_read_b128 v[40:43], v13 offset:4096
  v_mfma_f32_16x16x32_bf16 v[92:95], v[52:55], v[24:27], v[92:95]
  ds_read_b64_tr_b16 v[72:73], v19 offset:8192
  ds_read_b64_tr_b16 v[74:75], v19 offset:8704
  v_mfma_f32_16x16x32_bf16 v[96:99], v[56:59], v[24:27], v[96:99]
  ds_read_b128 v[44:47], v15 offset:0
  ds_read_b64_tr_b16 v[76:77], v17 offset:12288
  v_mfma_f32_16x16x32_bf16 v[84:87], v[60:63], v[28:31], v[84:87]
  ds_read_b64_tr_b16 v[78:79], v17 offset:12800
  ds_read_b128 v[48:51], v15 offset:4096
  v_mfma_f32_16x16x32_bf16 v[88:91], v[64:67], v[28:31], v[88:91]
  ds_read_b64_tr_b16 v[80:81], v19 offset:12288
  ds_read_b64_tr_b16 v[82:83], v19 offset:12800
  v_mfma_f32_16x16x32_bf16 v[92:95], v[60:63], v[32:35], v[92:95]
  v_mfma_f32_16x16x32_bf16 v[96:99], v[64:67], v[32:35], v[96:99]
  s_waitcnt lgkmcnt(0)
  s_barrier
  v_mfma_f32_16x16x32_bf16 v[84:87], v[68:71], v[36:39], v[84:87]
  ds_read_b128 v[20:23], v9 offset:32768
  ds_read_b64_tr_b16 v[52:53], v17 offset:32768
  v_mfma_f32_16x16x32_bf16 v[88:91], v[72:75], v[36:39], v[88:91]
  ds_read_b64_tr_b16 v[54:55], v17 offset:33280
  ds_read_b128 v[24:27], v9 offset:36864
  v_mfma_f32_16x16x32_bf16 v[92:95], v[68:71], v[40:43], v[92:95]
  ds_read_b64_tr_b16 v[56:57], v19 offset:32768
  ds_read_b64_tr_b16 v[58:59], v19 offset:33280
  v_mfma_f32_16x16x32_bf16 v[96:99], v[72:75], v[40:43], v[96:99]
  ds_read_b128 v[28:31], v11 offset:32768
  ds_read_b64_tr_b16 v[60:61], v17 offset:36864
  v_mfma_f32_16x16x32_bf16 v[84:87], v[76:79], v[44:47], v[84:87]
  ds_read_b64_tr_b16 v[62:63], v17 offset:37376
  ds_read_b128 v[32:35], v11 offset:36864
  v_mfma_f32_16x16x32_bf16 v[88:91], v[80:83], v[44:47], v[88:91]
  ds_read_b64_tr_b16 v[64:65], v19 offset:36864
  ds_read_b64_tr_b16 v[66:67], v19 offset:37376
  v_mfma_f32_16x16x32_bf16 v[92:95], v[76:79], v[48:51], v[92:95]
  v_mfma_f32_16x16x32_bf16 v[96:99], v[80:83], v[48:51], v[96:99]
  s_waitcnt lgkmcnt(0)
  v_mfma_f32_16x16x32_bf16 v[84:87], v[52:55], v[20:23], v[84:87]
  ds_read_b128 v[36:39], v13 offset:32768
  ds_read_b64_tr_b16 v[68:69], v17 offset:40960
  v_mfma_f32_16x16x32_bf16 v[88:91], v[56:59], v[20:23], v[88:91]
  ds_read_b64_tr_b16 v[70:71], v17 offset:41472
  ds_read_b128 v[40:43], v13 offset:36864
  v_mfma_f32_16x16x32_bf16 v[92:95], v[52:55], v[24:27], v[92:95]
  ds_read_b64_tr_b16 v[72:73], v19 offset:40960
  ds_read_b64_tr_b16 v[74:75], v19 offset:41472
  v_mfma_f32_16x16x32_bf16 v[96:99], v[56:59], v[24:27], v[96:99]
  ds_read_b128 v[44:47], v15 offset:32768
  ds_read_b64_tr_b16 v[76:77], v17 offset:45056
  v_mfma_f32_16x16x32_bf16 v[84:87], v[60:63], v[28:31], v[84:87]
  ds_read_b64_tr_b16 v[78:79], v17 offset:45568
  ds_read_b128 v[48:51], v15 offset:36864
  v_mfma_f32_16x16x32_bf16 v[88:91], v[64:67], v[28:31], v[88:91]
  ds_read_b64_tr_b16 v[80:81], v19 offset:45056
  ds_read_b64_tr_b16 v[82:83], v19 offset:45568
  v_mfma_f32_16x16x32_bf16 v[92:95], v[60:63], v[32:35], v[92:95]
  v_mfma_f32_16x16x32_bf16 v[96:99], v[64:67], v[32:35], v[96:99]
  s_waitcnt lgkmcnt(0)
  s_barrier
  s_barrier
  v_mfma_f32_16x16x32_bf16 v[84:87], v[68:71], v[36:39], v[84:87]
  ds_read_b128 v[20:23], v8 offset:0
  ds_read_b64_tr_b16 v[52:53], v16 offset:0
  v_mfma_f32_16x16x32_bf16 v[88:91], v[72:75], v[36:39], v[88:91]
  ds_read_b64_tr_b16 v[54:55], v16 offset:512
  ds_read_b128 v[24:27], v8 offset:4096
  v_mfma_f32_16x16x32_bf16 v[92:95], v[68:71], v[40:43], v[92:95]
  ds_read_b64_tr_b16 v[56:57], v18 offset:0
  ds_read_b64_tr_b16 v[58:59], v18 offset:512
  v_mfma_f32_16x16x32_bf16 v[96:99], v[72:75], v[40:43], v[96:99]
  ds_read_b128 v[28:31], v10 offset:0
  ds_read_b64_tr_b16 v[60:61], v16 offset:4096
  v_mfma_f32_16x16x32_bf16 v[84:87], v[76:79], v[44:47], v[84:87]
  ds_read_b64_tr_b16 v[62:63], v16 offset:4608
  ds_read_b128 v[32:35], v10 offset:4096
  v_mfma_f32_16x16x32_bf16 v[88:91], v[80:83], v[44:47], v[88:91]
  ds_read_b64_tr_b16 v[64:65], v18 offset:4096
  ds_read_b64_tr_b16 v[66:67], v18 offset:4608
  v_mfma_f32_16x16x32_bf16 v[92:95], v[76:79], v[48:51], v[92:95]
  v_mfma_f32_16x16x32_bf16 v[96:99], v[80:83], v[48:51], v[96:99]
  s_waitcnt lgkmcnt(0)
  v_mfma_f32_16x16x32_bf16 v[84:87], v[52:55], v[20:23], v[84:87]
  ds_read_b128 v[36:39], v12 offset:0
  ds_read_b64_tr_b16 v[68:69], v16 offset:8192
  v_mfma_f32_16x16x32_bf16 v[88:91], v[56:59], v[20:23], v[88:91]
  ds_read_b64_tr_b16 v[70:71], v16 offset:8704
  ds_read_b128 v[40:43], v12 offset:4096
  v_mfma_f32_16x16x32_bf16 v[92:95], v[52:55], v[24:27], v[92:95]
  ds_read_b64_tr_b16 v[72:73], v18 offset:8192
  ds_read_b64_tr_b16 v[74:75], v18 offset:8704
  v_mfma_f32_16x16x32_bf16 v[96:99], v[56:59], v[24:27], v[96:99]
  ds_read_b128 v[44:47], v14 offset:0
  ds_read_b64_tr_b16 v[76:77], v16 offset:12288
  v_mfma_f32_16x16x32_bf16 v[84:87], v[60:63], v[28:31], v[84:87]
  ds_read_b64_tr_b16 v[78:79], v16 offset:12800
  ds_read_b128 v[48:51], v14 offset:4096
  v_mfma_f32_16x16x32_bf16 v[88:91], v[64:67], v[28:31], v[88:91]
  ds_read_b64_tr_b16 v[80:81], v18 offset:12288
  ds_read_b64_tr_b16 v[82:83], v18 offset:12800
  v_mfma_f32_16x16x32_bf16 v[92:95], v[60:63], v[32:35], v[92:95]
  v_mfma_f32_16x16x32_bf16 v[96:99], v[64:67], v[32:35], v[96:99]
  s_waitcnt lgkmcnt(0)
  s_barrier
  v_mfma_f32_16x16x32_bf16 v[84:87], v[68:71], v[36:39], v[84:87]
  ds_read_b128 v[20:23], v8 offset:32768
  ds_read_b64_tr_b16 v[52:53], v16 offset:32768
  v_mfma_f32_16x16x32_bf16 v[88:91], v[72:75], v[36:39], v[88:91]
  ds_read_b64_tr_b16 v[54:55], v16 offset:33280
  ds_read_b128 v[24:27], v8 offset:36864
  v_mfma_f32_16x16x32_bf16 v[92:95], v[68:71], v[40:43], v[92:95]
  ds_read_b64_tr_b16 v[56:57], v18 offset:32768
  ds_read_b64_tr_b16 v[58:59], v18 offset:33280
  v_mfma_f32_16x16x32_bf16 v[96:99], v[72:75], v[40:43], v[96:99]
  ds_read_b128 v[28:31], v10 offset:32768
  ds_read_b64_tr_b16 v[60:61], v16 offset:36864
  v_mfma_f32_16x16x32_bf16 v[84:87], v[76:79], v[44:47], v[84:87]
  ds_read_b64_tr_b16 v[62:63], v16 offset:37376
  ds_read_b128 v[32:35], v10 offset:36864
  v_mfma_f32_16x16x32_bf16 v[88:91], v[80:83], v[44:47], v[88:91]
  ds_read_b64_tr_b16 v[64:65], v18 offset:36864
  ds_read_b64_tr_b16 v[66:67], v18 offset:37376
  v_mfma_f32_16x16x32_bf16 v[92:95], v[76:79], v[48:51], v[92:95]
  v_mfma_f32_16x16x32_bf16 v[96:99], v[80:83], v[48:51], v[96:99]
  s_waitcnt lgkmcnt(0)
  v_mfma_f32_16x16x32_bf16 v[84:87], v[52:55], v[20:23], v[84:87]
  ds_read_b128 v[36:39], v12 offset:32768
  ds_read_b64_tr_b16 v[68:69], v16 offset:40960
  v_mfma_f32_16x16x32_bf16 v[88:91], v[56:59], v[20:23], v[88:91]
  ds_read_b64_tr_b16 v[70:71], v16 offset:41472
  ds_read_b128 v[40:43], v12 offset:36864
  v_mfma_f32_16x16x32_bf16 v[92:95], v[52:55], v[24:27], v[92:95]
  ds_read_b64_tr_b16 v[72:73], v18 offset:40960
  ds_read_b64_tr_b16 v[74:75], v18 offset:41472
  v_mfma_f32_16x16x32_bf16 v[96:99], v[56:59], v[24:27], v[96:99]
  ds_read_b128 v[44:47], v14 offset:32768
  ds_read_b64_tr_b16 v[76:77], v16 offset:45056
  v_mfma_f32_16x16x32_bf16 v[84:87], v[60:63], v[28:31], v[84:87]
  ds_read_b64_tr_b16 v[78:79], v16 offset:45568
  ds_read_b128 v[48:51], v14 offset:36864
  v_mfma_f32_16x16x32_bf16 v[88:91], v[64:67], v[28:31], v[88:91]
  ds_read_b64_tr_b16 v[80:81], v18 offset:45056
  ds_read_b64_tr_b16 v[82:83], v18 offset:45568
  v_mfma_f32_16x16x32_bf16 v[92:95], v[60:63], v[32:35], v[92:95]
  v_mfma_f32_16x16x32_bf16 v[96:99], v[64:67], v[32:35], v[96:99]
  s_waitcnt lgkmcnt(0)
  s_barrier
  v_mfma_f32_16x16x32_bf16 v[84:87], v[68:71], v[36:39], v[84:87]
  ds_read_b128 v[20:23], v9 offset:0
  ds_read_b64_tr_b16 v[52:53], v17 offset:0
  v_mfma_f32_16x16x32_bf16 v[88:91], v[72:75], v[36:39], v[88:91]
  ds_read_b64_tr_b16 v[54:55], v17 offset:512
  ds_read_b128 v[24:27], v9 offset:4096
  v_mfma_f32_16x16x32_bf16 v[92:95], v[68:71], v[40:43], v[92:95]
  ds_read_b64_tr_b16 v[56:57], v19 offset:0
  ds_read_b64_tr_b16 v[58:59], v19 offset:512
  v_mfma_f32_16x16x32_bf16 v[96:99], v[72:75], v[40:43], v[96:99]
  ds_read_b128 v[28:31], v11 offset:0
  ds_read_b64_tr_b16 v[60:61], v17 offset:4096
  v_mfma_f32_16x16x32_bf16 v[84:87], v[76:79], v[44:47], v[84:87]
  ds_read_b64_tr_b16 v[62:63], v17 offset:4608
  ds_read_b128 v[32:35], v11 offset:4096
  v_mfma_f32_16x16x32_bf16 v[88:91], v[80:83], v[44:47], v[88:91]
  ds_read_b64_tr_b16 v[64:65], v19 offset:4096
  ds_read_b64_tr_b16 v[66:67], v19 offset:4608
  v_mfma_f32_16x16x32_bf16 v[92:95], v[76:79], v[48:51], v[92:95]
  v_mfma_f32_16x16x32_bf16 v[96:99], v[80:83], v[48:51], v[96:99]
  s_waitcnt lgkmcnt(0)
  v_mfma_f32_16x16x32_bf16 v[84:87], v[52:55], v[20:23], v[84:87]
  ds_read_b128 v[36:39], v13 offset:0
  ds_read_b64_tr_b16 v[68:69], v17 offset:8192
  v_mfma_f32_16x16x32_bf16 v[88:91], v[56:59], v[20:23], v[88:91]
  ds_read_b64_tr_b16 v[70:71], v17 offset:8704
  ds_read_b128 v[40:43], v13 offset:4096
  v_mfma_f32_16x16x32_bf16 v[92:95], v[52:55], v[24:27], v[92:95]
  ds_read_b64_tr_b16 v[72:73], v19 offset:8192
  ds_read_b64_tr_b16 v[74:75], v19 offset:8704
  v_mfma_f32_16x16x32_bf16 v[96:99], v[56:59], v[24:27], v[96:99]
  ds_read_b128 v[44:47], v15 offset:0
  ds_read_b64_tr_b16 v[76:77], v17 offset:12288
  v_mfma_f32_16x16x32_bf16 v[84:87], v[60:63], v[28:31], v[84:87]
  ds_read_b64_tr_b16 v[78:79], v17 offset:12800
  ds_read_b128 v[48:51], v15 offset:4096
  v_mfma_f32_16x16x32_bf16 v[88:91], v[64:67], v[28:31], v[88:91]
  ds_read_b64_tr_b16 v[80:81], v19 offset:12288
  ds_read_b64_tr_b16 v[82:83], v19 offset:12800
  v_mfma_f32_16x16x32_bf16 v[92:95], v[60:63], v[32:35], v[92:95]
  v_mfma_f32_16x16x32_bf16 v[96:99], v[64:67], v[32:35], v[96:99]
  s_waitcnt lgkmcnt(0)
  s_barrier
  v_mfma_f32_16x16x32_bf16 v[84:87], v[68:71], v[36:39], v[84:87]
  ds_read_b128 v[20:23], v9 offset:32768
  ds_read_b64_tr_b16 v[52:53], v17 offset:32768
  v_mfma_f32_16x16x32_bf16 v[88:91], v[72:75], v[36:39], v[88:91]
  ds_read_b64_tr_b16 v[54:55], v17 offset:33280
  ds_read_b128 v[24:27], v9 offset:36864
  v_mfma_f32_16x16x32_bf16 v[92:95], v[68:71], v[40:43], v[92:95]
  ds_read_b64_tr_b16 v[56:57], v19 offset:32768
  ds_read_b64_tr_b16 v[58:59], v19 offset:33280
  v_mfma_f32_16x16x32_bf16 v[96:99], v[72:75], v[40:43], v[96:99]
  ds_read_b128 v[28:31], v11 offset:32768
  ds_read_b64_tr_b16 v[60:61], v17 offset:36864
  v_mfma_f32_16x16x32_bf16 v[84:87], v[76:79], v[44:47], v[84:87]
  ds_read_b64_tr_b16 v[62:63], v17 offset:37376
  ds_read_b128 v[32:35], v11 offset:36864
  v_mfma_f32_16x16x32_bf16 v[88:91], v[80:83], v[44:47], v[88:91]
  ds_read_b64_tr_b16 v[64:65], v19 offset:36864
  ds_read_b64_tr_b16 v[66:67], v19 offset:37376
  v_mfma_f32_16x16x32_bf16 v[92:95], v[76:79], v[48:51], v[92:95]
  v_mfma_f32_16x16x32_bf16 v[96:99], v[80:83], v[48:51], v[96:99]
  s_waitcnt lgkmcnt(0)
  v_mfma_f32_16x16x32_bf16 v[84:87], v[52:55], v[20:23], v[84:87]
  ds_read_b128 v[36:39], v13 offset:32768
  ds_read_b64_tr_b16 v[68:69], v17 offset:40960
  v_mfma_f32_16x16x32_bf16 v[88:91], v[56:59], v[20:23], v[88:91]
  ds_read_b64_tr_b16 v[70:71], v17 offset:41472
  ds_read_b128 v[40:43], v13 offset:36864
  v_mfma_f32_16x16x32_bf16 v[92:95], v[52:55], v[24:27], v[92:95]
  ds_read_b64_tr_b16 v[72:73], v19 offset:40960
  ds_read_b64_tr_b16 v[74:75], v19 offset:41472
  v_mfma_f32_16x16x32_bf16 v[96:99], v[56:59], v[24:27], v[96:99]
  ds_read_b128 v[44:47], v15 offset:32768
  ds_read_b64_tr_b16 v[76:77], v17 offset:45056
  v_mfma_f32_16x16x32_bf16 v[84:87], v[60:63], v[28:31], v[84:87]
  ds_read_b64_tr_b16 v[78:79], v17 offset:45568
  ds_read_b128 v[48:51], v15 offset:36864
  v_mfma_f32_16x16x32_bf16 v[88:91], v[64:67], v[28:31], v[88:91]
  ds_read_b64_tr_b16 v[80:81], v19 offset:45056
  ds_read_b64_tr_b16 v[82:83], v19 offset:45568
  v_mfma_f32_16x16x32_bf16 v[92:95], v[60:63], v[32:35], v[92:95]
  v_mfma_f32_16x16x32_bf16 v[96:99], v[64:67], v[32:35], v[96:99]
  s_waitcnt lgkmcnt(0)
  s_barrier
  v_mfma_f32_16x16x32_bf16 v[84:87], v[68:71], v[36:39], v[84:87]
  ds_read_b128 v[20:23], v8 offset:0
  ds_read_b64_tr_b16 v[52:53], v16 offset:0
  v_mfma_f32_16x16x32_bf16 v[88:91], v[72:75], v[36:39], v[88:91]
  ds_read_b64_tr_b16 v[54:55], v16 offset:512
  ds_read_b128 v[24:27], v8 offset:4096
  v_mfma_f32_16x16x32_bf16 v[92:95], v[68:71], v[40:43], v[92:95]
  ds_read_b64_tr_b16 v[56:57], v18 offset:0
  ds_read_b64_tr_b16 v[58:59], v18 offset:512
  v_mfma_f32_16x16x32_bf16 v[96:99], v[72:75], v[40:43], v[96:99]
  ds_read_b128 v[28:31], v10 offset:0
  ds_read_b64_tr_b16 v[60:61], v16 offset:4096
  v_mfma_f32_16x16x32_bf16 v[84:87], v[76:79], v[44:47], v[84:87]
  ds_read_b64_tr_b16 v[62:63], v16 offset:4608
  ds_read_b128 v[32:35], v10 offset:4096
  v_mfma_f32_16x16x32_bf16 v[88:91], v[80:83], v[44:47], v[88:91]
  ds_read_b64_tr_b16 v[64:65], v18 offset:4096
  ds_read_b64_tr_b16 v[66:67], v18 offset:4608
  v_mfma_f32_16x16x32_bf16 v[92:95], v[76:79], v[48:51], v[92:95]
  v_mfma_f32_16x16x32_bf16 v[96:99], v[80:83], v[48:51], v[96:99]
  s_waitcnt lgkmcnt(0)
  v_mfma_f32_16x16x32_bf16 v[84:87], v[52:55], v[20:23], v[84:87]
  ds_read_b128 v[36:39], v12 offset:0
  ds_read_b64_tr_b16 v[68:69], v16 offset:8192
  v_mfma_f32_16x16x32_bf16 v[88:91], v[56:59], v[20:23], v[88:91]
  ds_read_b64_tr_b16 v[70:71], v16 offset:8704
  ds_read_b128 v[40:43], v12 offset:4096
  v_mfma_f32_16x16x32_bf16 v[92:95], v[52:55], v[24:27], v[92:95]
  ds_read_b64_tr_b16 v[72:73], v18 offset:8192
  ds_read_b64_tr_b16 v[74:75], v18 offset:8704
  v_mfma_f32_16x16x32_bf16 v[96:99], v[56:59], v[24:27], v[96:99]
  ds_read_b128 v[44:47], v14 offset:0
  ds_read_b64_tr_b16 v[76:77], v16 offset:12288
  v_mfma_f32_16x16x32_bf16 v[84:87], v[60:63], v[28:31], v[84:87]
  ds_read_b64_tr_b16 v[78:79], v16 offset:12800
  ds_read_b128 v[48:51], v14 offset:4096
  v_mfma_f32_16x16x32_bf16 v[88:91], v[64:67], v[28:31], v[88:91]
  ds_read_b64_tr_b16 v[80:81], v18 offset:12288
  ds_read_b64_tr_b16 v[82:83], v18 offset:12800
  v_mfma_f32_16x16x32_bf16 v[92:95], v[60:63], v[32:35], v[92:95]
  v_mfma_f32_16x16x32_bf16 v[96:99], v[64:67], v[32:35], v[96:99]
  s_waitcnt lgkmcnt(0)
  s_barrier
  v_mfma_f32_16x16x32_bf16 v[84:87], v[68:71], v[36:39], v[84:87]
  ds_read_b128 v[20:23], v8 offset:32768
  ds_read_b64_tr_b16 v[52:53], v16 offset:32768
  v_mfma_f32_16x16x32_bf16 v[88:91], v[72:75], v[36:39], v[88:91]
  ds_read_b64_tr_b16 v[54:55], v16 offset:33280
  ds_read_b128 v[24:27], v8 offset:36864
  v_mfma_f32_16x16x32_bf16 v[92:95], v[68:71], v[40:43], v[92:95]
  ds_read_b64_tr_b16 v[56:57], v18 offset:32768
  ds_read_b64_tr_b16 v[58:59], v18 offset:33280
  v_mfma_f32_16x16x32_bf16 v[96:99], v[72:75], v[40:43], v[96:99]
  ds_read_b128 v[28:31], v10 offset:32768
  ds_read_b64_tr_b16 v[60:61], v16 offset:36864
  v_mfma_f32_16x16x32_bf16 v[84:87], v[76:79], v[44:47], v[84:87]
  ds_read_b64_tr_b16 v[62:63], v16 offset:37376
  ds_read_b128 v[32:35], v10 offset:36864
  v_mfma_f32_16x16x32_bf16 v[88:91], v[80:83], v[44:47], v[88:91]
  ds_read_b64_tr_b16 v[64:65], v18 offset:36864
  ds_read_b64_tr_b16 v[66:67], v18 offset:37376
  v_mfma_f32_16x16x32_bf16 v[92:95], v[76:79], v[48:51], v[92:95]
  v_mfma_f32_16x16x32_bf16 v[96:99], v[80:83], v[48:51], v[96:99]
  s_waitcnt lgkmcnt(0)
  v_mfma_f32_16x16x32_bf16 v[84:87], v[52:55], v[20:23], v[84:87]
  ds_read_b128 v[36:39], v12 offset:32768
  ds_read_b64_tr_b16 v[68:69], v16 offset:40960
  v_mfma_f32_16x16x32_bf16 v[88:91], v[56:59], v[20:23], v[88:91]
  ds_read_b64_tr_b16 v[70:71], v16 offset:41472
  ds_read_b128 v[40:43], v12 offset:36864
  v_mfma_f32_16x16x32_bf16 v[92:95], v[52:55], v[24:27], v[92:95]
  ds_read_b64_tr_b16 v[72:73], v18 offset:40960
  ds_read_b64_tr_b16 v[74:75], v18 offset:41472
  v_mfma_f32_16x16x32_bf16 v[96:99], v[56:59], v[24:27], v[96:99]
  ds_read_b128 v[44:47], v14 offset:32768
  ds_read_b64_tr_b16 v[76:77], v16 offset:45056
  v_mfma_f32_16x16x32_bf16 v[84:87], v[60:63], v[28:31], v[84:87]
  ds_read_b64_tr_b16 v[78:79], v16 offset:45568
  ds_read_b128 v[48:51], v14 offset:36864
  v_mfma_f32_16x16x32_bf16 v[88:91], v[64:67], v[28:31], v[88:91]
  ds_read_b64_tr_b16 v[80:81], v18 offset:45056
  ds_read_b64_tr_b16 v[82:83], v18 offset:45568
  v_mfma_f32_16x16x32_bf16 v[92:95], v[60:63], v[32:35], v[92:95]
  v_mfma_f32_16x16x32_bf16 v[96:99], v[64:67], v[32:35], v[96:99]
  s_waitcnt lgkmcnt(0)
  s_barrier
  v_mfma_f32_16x16x32_bf16 v[84:87], v[68:71], v[36:39], v[84:87]
  ds_read_b128 v[20:23], v9 offset:0
  ds_read_b64_tr_b16 v[52:53], v17 offset:0
  v_mfma_f32_16x16x32_bf16 v[88:91], v[72:75], v[36:39], v[88:91]
  ds_read_b64_tr_b16 v[54:55], v17 offset:512
  ds_read_b128 v[24:27], v9 offset:4096
  v_mfma_f32_16x16x32_bf16 v[92:95], v[68:71], v[40:43], v[92:95]
  ds_read_b64_tr_b16 v[56:57], v19 offset:0
  ds_read_b64_tr_b16 v[58:59], v19 offset:512
  v_mfma_f32_16x16x32_bf16 v[96:99], v[72:75], v[40:43], v[96:99]
  ds_read_b128 v[28:31], v11 offset:0
  ds_read_b64_tr_b16 v[60:61], v17 offset:4096
  v_mfma_f32_16x16x32_bf16 v[84:87], v[76:79], v[44:47], v[84:87]
  ds_read_b64_tr_b16 v[62:63], v17 offset:4608
  ds_read_b128 v[32:35], v11 offset:4096
  v_mfma_f32_16x16x32_bf16 v[88:91], v[80:83], v[44:47], v[88:91]
  ds_read_b64_tr_b16 v[64:65], v19 offset:4096
  ds_read_b64_tr_b16 v[66:67], v19 offset:4608
  v_mfma_f32_16x16x32_bf16 v[92:95], v[76:79], v[48:51], v[92:95]
  v_mfma_f32_16x16x32_bf16 v[96:99], v[80:83], v[48:51], v[96:99]
  s_waitcnt lgkmcnt(0)
  v_mfma_f32_16x16x32_bf16 v[84:87], v[52:55], v[20:23], v[84:87]
  ds_read_b128 v[36:39], v13 offset:0
  ds_read_b64_tr_b16 v[68:69], v17 offset:8192
  v_mfma_f32_16x16x32_bf16 v[88:91], v[56:59], v[20:23], v[88:91]
  ds_read_b64_tr_b16 v[70:71], v17 offset:8704
  ds_read_b128 v[40:43], v13 offset:4096
  v_mfma_f32_16x16x32_bf16 v[92:95], v[52:55], v[24:27], v[92:95]
  ds_read_b64_tr_b16 v[72:73], v19 offset:8192
  ds_read_b64_tr_b16 v[74:75], v19 offset:8704
  v_mfma_f32_16x16x32_bf16 v[96:99], v[56:59], v[24:27], v[96:99]
  ds_read_b128 v[44:47], v15 offset:0
  ds_read_b64_tr_b16 v[76:77], v17 offset:12288
  v_mfma_f32_16x16x32_bf16 v[84:87], v[60:63], v[28:31], v[84:87]
  ds_read_b64_tr_b16 v[78:79], v17 offset:12800
  ds_read_b128 v[48:51], v15 offset:4096
  v_mfma_f32_16x16x32_bf16 v[88:91], v[64:67], v[28:31], v[88:91]
  ds_read_b64_tr_b16 v[80:81], v19 offset:12288
  ds_read_b64_tr_b16 v[82:83], v19 offset:12800
  v_mfma_f32_16x16x32_bf16 v[92:95], v[60:63], v[32:35], v[92:95]
  v_mfma_f32_16x16x32_bf16 v[96:99], v[64:67], v[32:35], v[96:99]
  s_waitcnt lgkmcnt(0)
  s_barrier
  v_mfma_f32_16x16x32_bf16 v[84:87], v[68:71], v[36:39], v[84:87]
  ds_read_b128 v[20:23], v9 offset:32768
  ds_read_b64_tr_b16 v[52:53], v17 offset:32768
  v_mfma_f32_16x16x32_bf16 v[88:91], v[72:75], v[36:39], v[88:91]
  ds_read_b64_tr_b16 v[54:55], v17 offset:33280
  ds_read_b128 v[24:27], v9 offset:36864
  v_mfma_f32_16x16x32_bf16 v[92:95], v[68:71], v[40:43], v[92:95]
  ds_read_b64_tr_b16 v[56:57], v19 offset:32768
  ds_read_b64_tr_b16 v[58:59], v19 offset:33280
  v_mfma_f32_16x16x32_bf16 v[96:99], v[72:75], v[40:43], v[96:99]
  ds_read_b128 v[28:31], v11 offset:32768
  ds_read_b64_tr_b16 v[60:61], v17 offset:36864
  v_mfma_f32_16x16x32_bf16 v[84:87], v[76:79], v[44:47], v[84:87]
  ds_read_b64_tr_b16 v[62:63], v17 offset:37376
  ds_read_b128 v[32:35], v11 offset:36864
  v_mfma_f32_16x16x32_bf16 v[88:91], v[80:83], v[44:47], v[88:91]
  ds_read_b64_tr_b16 v[64:65], v19 offset:36864
  ds_read_b64_tr_b16 v[66:67], v19 offset:37376
  v_mfma_f32_16x16x32_bf16 v[92:95], v[76:79], v[48:51], v[92:95]
  v_mfma_f32_16x16x32_bf16 v[96:99], v[80:83], v[48:51], v[96:99]
  s_waitcnt lgkmcnt(0)
  v_mfma_f32_16x16x32_bf16 v[84:87], v[52:55], v[20:23], v[84:87]
  ds_read_b128 v[36:39], v13 offset:32768
  ds_read_b64_tr_b16 v[68:69], v17 offset:40960
  v_mfma_f32_16x16x32_bf16 v[88:91], v[56:59], v[20:23], v[88:91]
  ds_read_b64_tr_b16 v[70:71], v17 offset:41472
  ds_read_b128 v[40:43], v13 offset:36864
  v_mfma_f32_16x16x32_bf16 v[92:95], v[52:55], v[24:27], v[92:95]
  ds_read_b64_tr_b16 v[72:73], v19 offset:40960
  ds_read_b64_tr_b16 v[74:75], v19 offset:41472
  v_mfma_f32_16x16x32_bf16 v[96:99], v[56:59], v[24:27], v[96:99]
  ds_read_b128 v[44:47], v15 offset:32768
  ds_read_b64_tr_b16 v[76:77], v17 offset:45056
  v_mfma_f32_16x16x32_bf16 v[84:87], v[60:63], v[28:31], v[84:87]
  ds_read_b64_tr_b16 v[78:79], v17 offset:45568
  ds_read_b128 v[48:51], v15 offset:36864
  v_mfma_f32_16x16x32_bf16 v[88:91], v[64:67], v[28:31], v[88:91]
  ds_read_b64_tr_b16 v[80:81], v19 offset:45056
  ds_read_b64_tr_b16 v[82:83], v19 offset:45568
  v_mfma_f32_16x16x32_bf16 v[92:95], v[60:63], v[32:35], v[92:95]
  v_mfma_f32_16x16x32_bf16 v[96:99], v[64:67], v[32:35], v[96:99]
  s_waitcnt lgkmcnt(0)
  s_barrier
  v_mfma_f32_16x16x32_bf16 v[84:87], v[68:71], v[36:39], v[84:87]
  ds_read_b128 v[20:23], v8 offset:0
  ds_read_b64_tr_b16 v[52:53], v16 offset:0
  v_mfma_f32_16x16x32_bf16 v[88:91], v[72:75], v[36:39], v[88:91]
  ds_read_b64_tr_b16 v[54:55], v16 offset:512
  ds_read_b128 v[24:27], v8 offset:4096
  v_mfma_f32_16x16x32_bf16 v[92:95], v[68:71], v[40:43], v[92:95]
  ds_read_b64_tr_b16 v[56:57], v18 offset:0
  ds_read_b64_tr_b16 v[58:59], v18 offset:512
  v_mfma_f32_16x16x32_bf16 v[96:99], v[72:75], v[40:43], v[96:99]
  ds_read_b128 v[28:31], v10 offset:0
  ds_read_b64_tr_b16 v[60:61], v16 offset:4096
  v_mfma_f32_16x16x32_bf16 v[84:87], v[76:79], v[44:47], v[84:87]
  ds_read_b64_tr_b16 v[62:63], v16 offset:4608
  ds_read_b128 v[32:35], v10 offset:4096
  v_mfma_f32_16x16x32_bf16 v[88:91], v[80:83], v[44:47], v[88:91]
  ds_read_b64_tr_b16 v[64:65], v18 offset:4096
  ds_read_b64_tr_b16 v[66:67], v18 offset:4608
  v_mfma_f32_16x16x32_bf16 v[92:95], v[76:79], v[48:51], v[92:95]
  v_mfma_f32_16x16x32_bf16 v[96:99], v[80:83], v[48:51], v[96:99]
  s_waitcnt lgkmcnt(0)
  v_mfma_f32_16x16x32_bf16 v[84:87], v[52:55], v[20:23], v[84:87]
  ds_read_b128 v[36:39], v12 offset:0
  ds_read_b64_tr_b16 v[68:69], v16 offset:8192
  v_mfma_f32_16x16x32_bf16 v[88:91], v[56:59], v[20:23], v[88:91]
  ds_read_b64_tr_b16 v[70:71], v16 offset:8704
  ds_read_b128 v[40:43], v12 offset:4096
  v_mfma_f32_16x16x32_bf16 v[92:95], v[52:55], v[24:27], v[92:95]
  ds_read_b64_tr_b16 v[72:73], v18 offset:8192
  ds_read_b64_tr_b16 v[74:75], v18 offset:8704
  v_mfma_f32_16x16x32_bf16 v[96:99], v[56:59], v[24:27], v[96:99]
  ds_read_b128 v[44:47], v14 offset:0
  ds_read_b64_tr_b16 v[76:77], v16 offset:12288
  v_mfma_f32_16x16x32_bf16 v[84:87], v[60:63], v[28:31], v[84:87]
  ds_read_b64_tr_b16 v[78:79], v16 offset:12800
  ds_read_b128 v[48:51], v14 offset:4096
  v_mfma_f32_16x16x32_bf16 v[88:91], v[64:67], v[28:31], v[88:91]
  ds_read_b64_tr_b16 v[80:81], v18 offset:12288
  ds_read_b64_tr_b16 v[82:83], v18 offset:12800
  v_mfma_f32_16x16x32_bf16 v[92:95], v[60:63], v[32:35], v[92:95]
  v_mfma_f32_16x16x32_bf16 v[96:99], v[64:67], v[32:35], v[96:99]
  s_waitcnt lgkmcnt(0)
  s_barrier
  v_mfma_f32_16x16x32_bf16 v[84:87], v[68:71], v[36:39], v[84:87]
  ds_read_b128 v[20:23], v8 offset:32768
  ds_read_b64_tr_b16 v[52:53], v16 offset:32768
  v_mfma_f32_16x16x32_bf16 v[88:91], v[72:75], v[36:39], v[88:91]
  ds_read_b64_tr_b16 v[54:55], v16 offset:33280
  ds_read_b128 v[24:27], v8 offset:36864
  v_mfma_f32_16x16x32_bf16 v[92:95], v[68:71], v[40:43], v[92:95]
  ds_read_b64_tr_b16 v[56:57], v18 offset:32768
  ds_read_b64_tr_b16 v[58:59], v18 offset:33280
  v_mfma_f32_16x16x32_bf16 v[96:99], v[72:75], v[40:43], v[96:99]
  ds_read_b128 v[28:31], v10 offset:32768
  ds_read_b64_tr_b16 v[60:61], v16 offset:36864
  v_mfma_f32_16x16x32_bf16 v[84:87], v[76:79], v[44:47], v[84:87]
  ds_read_b64_tr_b16 v[62:63], v16 offset:37376
  ds_read_b128 v[32:35], v10 offset:36864
  v_mfma_f32_16x16x32_bf16 v[88:91], v[80:83], v[44:47], v[88:91]
  ds_read_b64_tr_b16 v[64:65], v18 offset:36864
  ds_read_b64_tr_b16 v[66:67], v18 offset:37376
  v_mfma_f32_16x16x32_bf16 v[92:95], v[76:79], v[48:51], v[92:95]
  v_mfma_f32_16x16x32_bf16 v[96:99], v[80:83], v[48:51], v[96:99]
  s_waitcnt lgkmcnt(0)
  v_mfma_f32_16x16x32_bf16 v[84:87], v[52:55], v[20:23], v[84:87]
  ds_read_b128 v[36:39], v12 offset:32768
  ds_read_b64_tr_b16 v[68:69], v16 offset:40960
  v_mfma_f32_16x16x32_bf16 v[88:91], v[56:59], v[20:23], v[88:91]
  ds_read_b64_tr_b16 v[70:71], v16 offset:41472
  ds_read_b128 v[40:43], v12 offset:36864
  v_mfma_f32_16x16x32_bf16 v[92:95], v[52:55], v[24:27], v[92:95]
  ds_read_b64_tr_b16 v[72:73], v18 offset:40960
  ds_read_b64_tr_b16 v[74:75], v18 offset:41472
  v_mfma_f32_16x16x32_bf16 v[96:99], v[56:59], v[24:27], v[96:99]
  ds_read_b128 v[44:47], v14 offset:32768
  ds_read_b64_tr_b16 v[76:77], v16 offset:45056
  v_mfma_f32_16x16x32_bf16 v[84:87], v[60:63], v[28:31], v[84:87]
  ds_read_b64_tr_b16 v[78:79], v16 offset:45568
  ds_read_b128 v[48:51], v14 offset:36864
  v_mfma_f32_16x16x32_bf16 v[88:91], v[64:67], v[28:31], v[88:91]
  ds_read_b64_tr_b16 v[80:81], v18 offset:45056
  ds_read_b64_tr_b16 v[82:83], v18 offset:45568
  v_mfma_f32_16x16x32_bf16 v[92:95], v[60:63], v[32:35], v[92:95]
  v_mfma_f32_16x16x32_bf16 v[96:99], v[64:67], v[32:35], v[96:99]
  s_waitcnt lgkmcnt(0)
  s_barrier
  v_mfma_f32_16x16x32_bf16 v[84:87], v[68:71], v[36:39], v[84:87]
  ds_read_b128 v[20:23], v9 offset:0
  ds_read_b64_tr_b16 v[52:53], v17 offset:0
  v_mfma_f32_16x16x32_bf16 v[88:91], v[72:75], v[36:39], v[88:91]
  ds_read_b64_tr_b16 v[54:55], v17 offset:512
  ds_read_b128 v[24:27], v9 offset:4096
  v_mfma_f32_16x16x32_bf16 v[92:95], v[68:71], v[40:43], v[92:95]
  ds_read_b64_tr_b16 v[56:57], v19 offset:0
  ds_read_b64_tr_b16 v[58:59], v19 offset:512
  v_mfma_f32_16x16x32_bf16 v[96:99], v[72:75], v[40:43], v[96:99]
  ds_read_b128 v[28:31], v11 offset:0
  ds_read_b64_tr_b16 v[60:61], v17 offset:4096
  v_mfma_f32_16x16x32_bf16 v[84:87], v[76:79], v[44:47], v[84:87]
  ds_read_b64_tr_b16 v[62:63], v17 offset:4608
  ds_read_b128 v[32:35], v11 offset:4096
  v_mfma_f32_16x16x32_bf16 v[88:91], v[80:83], v[44:47], v[88:91]
  ds_read_b64_tr_b16 v[64:65], v19 offset:4096
  ds_read_b64_tr_b16 v[66:67], v19 offset:4608
  v_mfma_f32_16x16x32_bf16 v[92:95], v[76:79], v[48:51], v[92:95]
  v_mfma_f32_16x16x32_bf16 v[96:99], v[80:83], v[48:51], v[96:99]
  s_waitcnt lgkmcnt(0)
  v_mfma_f32_16x16x32_bf16 v[84:87], v[52:55], v[20:23], v[84:87]
  ds_read_b128 v[36:39], v13 offset:0
  ds_read_b64_tr_b16 v[68:69], v17 offset:8192
  v_mfma_f32_16x16x32_bf16 v[88:91], v[56:59], v[20:23], v[88:91]
  ds_read_b64_tr_b16 v[70:71], v17 offset:8704
  ds_read_b128 v[40:43], v13 offset:4096
  v_mfma_f32_16x16x32_bf16 v[92:95], v[52:55], v[24:27], v[92:95]
  ds_read_b64_tr_b16 v[72:73], v19 offset:8192
  ds_read_b64_tr_b16 v[74:75], v19 offset:8704
  v_mfma_f32_16x16x32_bf16 v[96:99], v[56:59], v[24:27], v[96:99]
  ds_read_b128 v[44:47], v15 offset:0
  ds_read_b64_tr_b16 v[76:77], v17 offset:12288
  v_mfma_f32_16x16x32_bf16 v[84:87], v[60:63], v[28:31], v[84:87]
  ds_read_b64_tr_b16 v[78:79], v17 offset:12800
  ds_read_b128 v[48:51], v15 offset:4096
  v_mfma_f32_16x16x32_bf16 v[88:91], v[64:67], v[28:31], v[88:91]
  ds_read_b64_tr_b16 v[80:81], v19 offset:12288
  ds_read_b64_tr_b16 v[82:83], v19 offset:12800
  v_mfma_f32_16x16x32_bf16 v[92:95], v[60:63], v[32:35], v[92:95]
  v_mfma_f32_16x16x32_bf16 v[96:99], v[64:67], v[32:35], v[96:99]
  s_waitcnt lgkmcnt(0)
  v_mfma_f32_16x16x32_bf16 v[84:87], v[68:71], v[36:39], v[84:87]
  v_mfma_f32_16x16x32_bf16 v[88:91], v[72:75], v[36:39], v[88:91]
  v_mfma_f32_16x16x32_bf16 v[92:95], v[68:71], v[40:43], v[92:95]
  v_mfma_f32_16x16x32_bf16 v[96:99], v[72:75], v[40:43], v[96:99]
  v_mfma_f32_16x16x32_bf16 v[84:87], v[76:79], v[44:47], v[84:87]
  v_mfma_f32_16x16x32_bf16 v[88:91], v[80:83], v[44:47], v[88:91]
  v_mfma_f32_16x16x32_bf16 v[92:95], v[76:79], v[48:51], v[92:95]
  v_mfma_f32_16x16x32_bf16 v[96:99], v[80:83], v[48:51], v[96:99]
  ds_read_b64 v[104:105], v102 offset:0
  ds_read_b64 v[106:107], v103 offset:0
  ds_read_b64 v[108:109], v102 offset:2048
  ds_read_b64 v[110:111], v103 offset:2048
  ds_read_b64 v[112:113], v102 offset:8192
  ds_read_b64 v[114:115], v103 offset:8192
  ds_read_b64 v[116:117], v102 offset:10240
  ds_read_b64 v[118:119], v103 offset:10240
  s_nop 7
  s_nop 3
  s_waitcnt lgkmcnt(0)
  v_lshlrev_b32 v120, 16, v104
  v_and_b32 v121, 0xffff0000, v104
  v_lshlrev_b32 v122, 16, v105
  v_and_b32 v123, 0xffff0000, v105
  v_lshlrev_b32 v124, 16, v112
  v_and_b32 v125, 0xffff0000, v112
  v_lshlrev_b32 v126, 16, v113
  v_and_b32 v127, 0xffff0000, v113
  v_pk_add_f32 v[120:121], v[120:121], v[124:125]
  v_pk_add_f32 v[122:123], v[122:123], v[126:127]
  v_pk_add_f32 v[84:85], v[84:85], v[120:121]
  v_pk_add_f32 v[86:87], v[86:87], v[122:123]
  v_lshlrev_b32 v120, 16, v106
  v_and_b32 v121, 0xffff0000, v106
  v_lshlrev_b32 v122, 16, v107
  v_and_b32 v123, 0xffff0000, v107
  v_lshlrev_b32 v124, 16, v114
  v_and_b32 v125, 0xffff0000, v114
  v_lshlrev_b32 v126, 16, v115
  v_and_b32 v127, 0xffff0000, v115
  v_pk_add_f32 v[120:121], v[120:121], v[124:125]
  v_pk_add_f32 v[122:123], v[122:123], v[126:127]
  v_pk_add_f32 v[88:89], v[88:89], v[120:121]
  v_pk_add_f32 v[90:91], v[90:91], v[122:123]
  v_lshlrev_b32 v120, 16, v108
  v_and_b32 v121, 0xffff0000, v108
  v_lshlrev_b32 v122, 16, v109
  v_and_b32 v123, 0xffff0000, v109
  v_lshlrev_b32 v124, 16, v116
  v_and_b32 v125, 0xffff0000, v116
  v_lshlrev_b32 v126, 16, v117
  v_and_b32 v127, 0xffff0000, v117
  v_pk_add_f32 v[120:121], v[120:121], v[124:125]
  v_pk_add_f32 v[122:123], v[122:123], v[126:127]
  v_pk_add_f32 v[92:93], v[92:93], v[120:121]
  v_pk_add_f32 v[94:95], v[94:95], v[122:123]
  v_lshlrev_b32 v120, 16, v110
  v_and_b32 v121, 0xffff0000, v110
  v_lshlrev_b32 v122, 16, v111
  v_and_b32 v123, 0xffff0000, v111
  v_lshlrev_b32 v124, 16, v118
  v_and_b32 v125, 0xffff0000, v118
  v_lshlrev_b32 v126, 16, v119
  v_and_b32 v127, 0xffff0000, v119
  v_pk_add_f32 v[120:121], v[120:121], v[124:125]
  v_pk_add_f32 v[122:123], v[122:123], v[126:127]
  v_pk_add_f32 v[96:97], v[96:97], v[120:121]
  v_pk_add_f32 v[98:99], v[98:99], v[122:123]
  v_cvt_pk_bf16_f32 v20, v84, v85
  v_cvt_pk_bf16_f32 v21, v86, v87
  v_cvt_pk_bf16_f32 v22, v88, v89
  v_cvt_pk_bf16_f32 v23, v90, v91
  v_cvt_pk_bf16_f32 v24, v92, v93
  v_cvt_pk_bf16_f32 v25, v94, v95
  v_cvt_pk_bf16_f32 v26, v96, v97
  v_cvt_pk_bf16_f32 v27, v98, v99
  s_nop 1
  v_permlane16_swap_b32 v20, v22
  v_permlane16_swap_b32 v21, v23
  buffer_store_dwordx4 v[20:23], v100, s[24:27], s72 offen
  v_permlane16_swap_b32 v24, v26
  v_permlane16_swap_b32 v25, v27
  buffer_store_dwordx4 v[24:27], v101, s[24:27], s72 offen
  s_endpgm
parallel_sum__linear_attn_block__mixer_s_mlp__prompt_kernel_exit:
  s_endpgm
.section .rodata,"a"
.p2align 6
.amdhsa_kernel parallel_sum__linear_attn_block__mixer_s_mlp__prompt_kernel
  .amdhsa_next_free_vgpr 256
  .amdhsa_next_free_sgpr 100
  .amdhsa_accum_offset 256
  .amdhsa_group_segment_fixed_size 0
  .amdhsa_kernarg_size 88
  .amdhsa_user_sgpr_count 2
  .amdhsa_user_sgpr_kernarg_segment_ptr 1
  .amdhsa_system_sgpr_workgroup_id_x 1
  .amdhsa_float_denorm_mode_32 3
.end_amdhsa_kernel
```
